```python
import torch

def _softmax(x, axis=-1):
    return torch.softmax(x, dim=axis)
def _gelu(x):
    return torch.nn.functional.gelu(x, approximate="tanh")
def _silu(x):
    return torch.nn.functional.silu(x)
def _sigmoid(x):
    return torch.sigmoid(x)
def _layernorm(x, axis=-1, eps=1e-5):
    m = x.mean(dim=axis, keepdim=True)
    v = x.var(dim=axis, keepdim=True, unbiased=False)
    return (x - m) / torch.sqrt(v + eps)
def _scatter_add(tgt, idx, src, axis=0):
    return tgt.clone().index_add_(axis, idx, src)
def _segment_sum(src, seg, n):
    out = torch.zeros((n,) + src.shape[1:], dtype=src.dtype)
    return out.index_add_(0, seg, src)
def _pad(x, pw):
    flat = tuple(v for pair in reversed(pw) for v in pair)
    return torch.nn.functional.pad(x, flat)

kernel_name = 'interleave_layers__linear_attn_block__linear_kernel_hedgehog__prompt'

def setup_inputs():

    _w = (lambda a: (lambda t: t.to(torch.bfloat16) if t.is_floating_point() else t)(torch.as_tensor(a)))
    def _A_setup():
        B, S, D = 1, 2048, 512
        return {
            "x": _w((lambda *s: torch.randn(*s, dtype=torch.bfloat16) * 0.1)(B, S, D)),
            "wqkv": _w((lambda *s: torch.randn(*s, dtype=torch.bfloat16) * 0.2)(D, 3 * D)),
            "wo": _w((lambda *s: torch.randn(*s, dtype=torch.bfloat16) * 0.2)(D, D)),
        }
    _A_in = _A_setup()

    def _B_setup():
        B, S, D, H = 1, 2048, 512, 32
        Dh = D // H
        return {
            "x": _w((lambda *s: torch.randn(*s, dtype=torch.bfloat16) * 0.1)(B, S, D)),
            "wqkv": _w((lambda *s: torch.randn(*s, dtype=torch.bfloat16) * 0.8)(D, 3 * D)),
            "w_phi": _w((lambda *s: torch.randn(*s, dtype=torch.bfloat16) * 0.8)(H, Dh, Dh) * (Dh ** -0.5)),
            "wo": _w((lambda *s: torch.randn(*s, dtype=torch.bfloat16) * 0.1)(D, D)),
        }
    _B_in = _B_setup()

    return {
        "A_x": _A_in["x"],
        "A_wqkv": _A_in["wqkv"],
        "A_wo": _A_in["wo"],
        "B_x": _B_in["x"],
        "B_wqkv": _B_in["wqkv"],
        "B_w_phi": _B_in["w_phi"],
        "B_wo": _B_in["wo"],
    }

def reference(A_x, A_wqkv, A_wo, B_x, B_wqkv, B_w_phi, B_wo):
    def _A_ref(x, wqkv, wo):
        B, S, D = x.shape
        H = 32; Dh = D // H
        qkv = (lambda x, *d: x.permute(*d))((x @ wqkv).reshape(B, S, 3, H, Dh), 2, 0, 3, 1, 4)
        q, k, v = qkv[0], qkv[1], qkv[2]
        phi = lambda t: torch.where(t > 0, t + 1, torch.exp(t)) + 1e-6
        pq, pk = phi(q), phi(k)
        kv = torch.einsum("bhsd,bhse->bhde", pk, v)
        z = torch.einsum("bhsd->bhd", pk)
        num = torch.einsum("bhqd,bhde->bhqe", pq, kv)
        den = torch.einsum("bhqd,bhd->bhq", pq, z)[..., None] + 1e-6
        o = num / den
        return (lambda x, *d: x.permute(*d))(o, 0, 2, 1, 3).reshape(B, S, D) @ wo

    def _B_ref(x, wqkv, w_phi, wo):
        B, S, D = x.shape
        H = 32; Dh = D // H
        qkv = (lambda x, *d: x.permute(*d))((x @ wqkv).reshape(B, S, 3, H, Dh), 2, 0, 3, 1, 4)
        q, k, v = qkv[0], qkv[1], qkv[2]
        pq = torch.einsum("bhsd,hdf->bhsf", q, w_phi)
        pk = torch.einsum("bhsd,hdf->bhsf", k, w_phi)
        phi_q = torch.concatenate([_softmax(pq, axis=-1), _softmax(-pq, axis=-1)], axis=-1)
        phi_k = torch.concatenate([_softmax(pk, axis=-1), _softmax(-pk, axis=-1)], axis=-1)
        kv = torch.einsum("bhsf,bhsd->bhfd", phi_k, v)
        z  = torch.einsum("bhsf->bhf", phi_k)
        num = torch.einsum("bhqf,bhfd->bhqd", phi_q, kv)
        den = torch.einsum("bhqf,bhf->bhq", phi_q, z)[..., None] + 1e-6
        o = num / den
        return (lambda x, *d: x.permute(*d))(o, 0, 2, 1, 3).reshape(B, S, D) @ wo

    x = A_x
    x = x + _A_ref(_layernorm(x, axis=-1), A_wqkv, A_wo)
    x = x + _B_ref(_layernorm(x, axis=-1), B_wqkv, B_w_phi, B_wo)
    x = x + _A_ref(_layernorm(x, axis=-1), A_wqkv, A_wo)
    x = x + _B_ref(_layernorm(x, axis=-1), B_wqkv, B_w_phi, B_wo)
    return x
```

```asm
; @launch grid=(256,1,1) block=(256,1,1) lds=163840
.amdgcn_target "amdgcn-amd-amdhsa--gfx950"
.text
.globl interleave_layers__linear_attn_block__linear_kernel_hedgehog__prompt_kernel
.p2align 8
.type interleave_layers__linear_attn_block__linear_kernel_hedgehog__prompt_kernel,@function
interleave_layers__linear_attn_block__linear_kernel_hedgehog__prompt_kernel:
    s_cmp_ge_u32 s2, 256
    s_cbranch_scc1 L_end
    s_load_dwordx16 s[4:19], s[0:1], 0
    s_load_dwordx4 s[20:23], s[0:1], 64
    s_getpc_b64 s[70:71]
L_pc:
    s_bfe_u32 s55, s2, 196611
    s_mul_i32 s55, s55, 12
    v_min_u32 v1, 11, v0
    v_add_u32 v1, s55, v1
    v_lshlrev_b32 v1, 7, v1
    v_add_u32 v1, L_page0-L_pc, v1
    v_lshlrev_b32 v2, 12, v0
    v_add_u32 v2, L_page0-L_pc-64*4096, v2
    v_cmp_le_u32 vcc, 64, v0
    s_nop 1
    v_cndmask_b32 v1, v1, v2, vcc
    v_and_b32_e64 v2, 15, v0
    v_lshl_add_u32 v2, v2, 7, 64
    v_add_u32 v2, 0x340, v2
    v_cmp_le_u32 vcc, 128, v0
    s_nop 1
    v_cndmask_b32 v1, v1, v2, vcc
    v_min_u32 v1, L_codeend-L_pc, v1
    global_load_dword v2, v1, s[70:71]
    v_lshrrev_b32 v1, 6, v0
    v_and_b32 v3, 63, v0
    v_readfirstlane_b32 s36, v1
    v_lshlrev_b32 v240, 4, v3
    s_bfe_u32 s37, s2, 262147
    s_lshr_b32 s55, s2, 7
    s_and_b32 s38, s2, 7
    s_lshl1_add_u32 s38, s38, s55
    s_and_b32 s52, s38, 0
    s_lshr_b32 s55, s37, 3
    s_lshr_b32 s58, s36, 1
    s_lshl1_add_u32 s55, s55, s58
    s_lshl2_add_u32 s99, s38, s55
    s_lshl2_add_u32 s59, s38, s36
    s_and_b32 s100, s36, 1
    s_and_b32 s101, s37, 7
    s_lshl1_add_u32 s55, s99, s100
    s_lshl_b32 s44, s55, 14
    s_lshl_b32 s55, s101, 7
    s_add_u32 s67, s44, s55
    s_lshl3_add_u32 s55, s99, s101
    s_lshl4_add_u32 s55, s55, s100
    s_lshl_b32 s46, s55, 8
    s_lshl4_add_u32 s56, s38, s37
    s_lshl_b32 s56, s56, 5
    s_add_u32 s56, s56, s36
    s_lshl_b32 s56, s56, 8
    v_and_b32 v52, 7, v3
    v_lshrrev_b32 v53, 3, v3
    v_lshlrev_b32 v4, 4, v53
    v_lshl_add_u32 v4, v52, 10, v4
    s_lshl_b32 s55, s37, 6
    s_mul_i32 s60, s58, 49152
    s_add_u32 s60, s60, s55
    s_lshl_b32 s55, s100, 10
    s_add_u32 s60, s60, s55
    s_add_u32 s60, s60, 1024
    v_lshrrev_b32 v5, 6, v240
    v_mul_u32_u24 v5, 3008, v5
    v_add_u32_e64 v5, v5, v240
    s_mov_b32 s35, 0x20000
    s_mov_b32 s83, 0x20000
    s_mov_b32 s34, 0x200000
    s_mov_b32 s82, 1572864
    s_lshr_b32 s57, s2, 3
    s_lshl_b32 s40, s59, 11
    s_lshl_b32 s55, s59, 7
    s_add_u32 s41, s55, 4096
    s_add_u32 s43, s55, 12288
    s_lshl_b32 s63, s37, 7
    s_add_u32 s63, s63, s40
    s_waitcnt lgkmcnt(0)
    s_mov_b64 s[32:33], s[4:5]
    s_mov_b64 s[80:81], s[6:7]
    buffer_load_dwordx4 v[8:11], v4, s[32:35], s56 offen offset:0
    buffer_load_dwordx4 v[12:15], v4, s[32:35], s56 offen offset:128
    s_lshl2_add_u32 s0, s57, s36
    s_add_u32 s10, s22, s63
    s_addc_u32 s11, s23, 0
    s_load_dword s53, s[22:23], 0
    s_load_dword s1, s[22:23], s41
    s_load_dword s1, s[22:23], s43
    s_load_dword s1, s[10:11], 65536
    s_load_dword s1, s[10:11], 65600
    s_cmp_eq_u32 s100, 0
    s_cbranch_scc0 L_skip_1
    s_cmp_eq_u32 s100, 0
    s_cselect_b64 s[32:33], s[6:7], s[12:13]
    s_cselect_b64 s[64:65], s[8:9], s[16:17]
    s_cmp_lt_u32 s36, 2
    s_cselect_b64 s[32:33], s[32:33], s[64:65]
    s_cselect_b32 s56, 3, 1
    s_lshl_b32 s56, s56, 11
    s_mul_i32 s57, s2, s56
    s_sub_u32 s55, s56, 128
    v_lshlrev_b32 v7, 3, v240
    v_min_u32 v7, s55, v7
    s_lshl_b32 s34, s56, 8
    buffer_load_dword v7, v7, s[32:35], s57 offen
L_skip_1:
    s_sub_u32 s55, 0x180, s80
    s_and_b32 s55, s55, 0x380
    s_mul_i32 s56, s0, 12288
    s_add_u32 s55, s55, s56
    v_lshlrev_b32 v6, 6, v240
    s_mov_b64 exec, 0xfff
    buffer_load_dword v6, v6, s[80:83], s55 offen
    s_mov_b64 exec, -1
    s_mov_b32 s32, s14
    s_mov_b32 s33, s15
    s_mov_b32 s34, 16384
    s_lshl_b32 s55, s37, 10
    buffer_load_dwordx4 v[16:19], v240, s[32:35], s55 offen
    s_add_u32 s55, s60, 0
    buffer_load_dwordx4 a[0:3], v5, s[80:83], s55 offen
    s_add_u32 s55, s60, 98304
    buffer_load_dwordx4 a[4:7], v5, s[80:83], s55 offen
    s_add_u32 s55, s60, 196608
    buffer_load_dwordx4 a[8:11], v5, s[80:83], s55 offen
    s_mov_b64 s[24:25], s[22:23]
    s_mov_b64 s[28:29], s[18:19]
    s_mov_b32 s27, 0x20000
    s_mov_b32 s31, 0x20000
    s_mov_b32 s26, 0x8000000
    s_mov_b32 s30, 0x200000
    s_mov_b32 s96, 0xffff
    s_mov_b32 s97, 0xffff
    s_mov_b32 s51, 0
    s_lshr_b32 s55, s101, 2
    s_lshl2_add_u32 s55, s99, s55
    s_lshl1_add_u32 s55, s55, s100
    s_lshl_b32 s55, s55, 8
    s_and_b32 s56, s101, 3
    s_lshl2_add_u32 s47, s56, s55
    s_add_u32 s47, s47, 65536
    s_lshl4_add_u32 s55, s36, s37
    s_lshl_b32 s49, s55, 10
    s_add_u32 s49, s49, 786432
    s_lshl_b32 s63, s55, 11
    s_add_u32 s63, s63, 655360
    s_mov_b32 s68, 0
    s_mov_b32 s69, -1
    s_lshl_b32 s39, s59, 15
    v_and_b32 v20, 15, v3
    v_lshrrev_b32 v21, 4, v3
    v_lshrrev_b32 v22, 5, v3
    v_and_b32 v23, 3, v3
    v_bfe_u32 v24, v3, 2, 2
    v_lshlrev_b32 v250, 2, v20
    v_lshlrev_b32 v25, 4, v20
    v_lshl_add_u32 v247, v21, 10, v25
    v_lshl_add_u32 v248, v22, 10, v25
    v_lshl_add_u32 v249, v22, 9, v240
    s_lshr_b32 s55, s38, 1
    s_lshl_b32 s55, s55, 7
    s_and_b32 s56, s38, 1
    s_add_u32 s55, s55, s56
    s_lshl_b32 s55, s55, 9
    v_lshl_add_u32 v186, v22, 8, v25
    v_add_u32_e64 v186, s55, v186
    s_lshl_b32 s56, s38, 6
    s_add_u32 s56, s56, 524288
    v_lshl_add_u32 v187, v21, 4, s56
    v_add_u32_e64 v49, s55, v240
    v_lshl_add_u32 v27, v23, 4, s56
    v_cndmask_b32 v49, v49, v27, s[68:69]
    v_mov_b32 v28, -1
    v_mov_b32 v29, -1
    v_mov_b32 v30, -1
    v_mov_b32 v31, -1
    s_getreg_b32 s54, hwreg(HW_REG_XCC_ID, 0, 4)
    s_lshl_b32 s98, s36, 13
    s_mov_b32 s59, 0x200000
    s_lshl_b32 s55, s37, 10
    s_add_u32 s42, s39, s55
    s_add_u32 s42, s42, 4194304
    s_add_u32 s44, s44, 4194304
    s_add_u32 s40, s40, 65536
    s_lshl2_add_u32 s43, s37, s43
    s_lshl_b32 s55, s99, 7
    s_add_u32 s45, s55, 12288
    s_lshl1_add_u32 s56, s101, s100
    s_lshl2_add_u32 s48, s56, s55
    s_add_u32 s48, s48, 4096
    s_lshl_b32 s55, s37, 6
    s_mul_i32 s61, s36, 393216
    s_add_u32 s61, s61, s55
    s_lshl_b32 s62, s36, 13
    s_lshl_b32 s55, s101, 7
    s_add_u32 s62, s62, s55
    s_mov_b64 s[84:85], s[12:13]
    s_mov_b32 s86, 1572864
    s_mov_b32 s87, 0x20000
    s_mov_b64 s[88:89], s[8:9]
    s_mov_b32 s90, 524288
    s_mov_b32 s91, 0x20000
    s_mov_b64 s[92:93], s[16:17]
    s_mov_b32 s94, 524288
    s_mov_b32 s95, 0x20000
    s_mov_b32 s10, 0x10001
    s_mov_b32 s11, 0x10001
    s_mov_b32 s64, 0x3f317218
    s_mov_b32 s65, 0x3f317218
    s_mov_b32 s66, 0x358637bd
    s_lshl_b32 s77, s38, 7
    s_add_u32 s77, s77, 36864
    s_lshl4_add_u32 s75, s38, s37
    s_lshl2_add_u32 s75, s75, s36
    v_and_b32 v26, 1, v21
    v_lshl_add_u32 v191, v26, 14, v25
    v_lshl_add_u32 v191, v22, 9, v191
    v_lshlrev_b32_e64 v241, 9, v22
    v_lshl_add_u32 v241, v24, 6, v241
    v_lshl_add_u32 v241, v26, 4, v241
    v_and_b32 v27, 1, v23
    v_lshrrev_b32 v32, 1, v23
    v_lshl_add_u32 v241, v27, 5, v241
    v_lshl_add_u32 v241, v32, 3, v241
    v_lshlrev_b32_e64 v184, 8, v22
    v_lshl_add_u32 v184, v32, 7, v184
    v_lshl_add_u32 v184, v26, 6, v184
    v_lshl_add_u32 v184, v24, 4, v184
    v_lshl_add_u32 v184, v27, 3, v184
    s_lshl_b32 s55, s100, 12
    s_add_u32 s55, s55, 147456
    v_add_u32 v185, s55, v184
    s_lshl_b32 s55, s36, 12
    s_add_u32 s55, s55, 131072
    v_add_u32 v184, s55, v184
    v_bfe_u32 v33, v3, 3, 2
    v_and_b32 v242, 0x70, v240
    v_lshl_add_u32 v242, v33, 8, v242
    v_lshl_add_u32 v242, v22, 12, v242
    s_lshl_b32 s55, s36, 10
    s_add_u32 s55, s55, 131072
    v_add_u32 v242, s55, v242
    v_bfe_u32 v34, v3, 1, 2
    v_xor_b32 v33, v33, v34
    v_lshlrev_b32 v252, 14, v34
    v_lshl_add_u32 v252, v33, 5, v252
    v_lshl_add_u32 v252, v22, 9, v252
    v_lshl_add_u32 v252, v27, 4, v252
    s_lshl_b32 s55, s36, 7
    v_add_u32 v252, s55, v252
    v_lshlrev_b32 v251, 3, v3
    s_lshl_b32 s55, s100, 15
    s_and_b32 s56, s36, 2
    s_lshl_b32 s57, s56, 9
    s_add_u32 s55, s55, s57
    v_add_u32 v253, s55, v240
    v_and_b32 v33, 0x1f0, v240
    v_add_u32 v254, 0x26e60, v33
    v_and_b32 v34, 1, v24
    v_cmp_eq_u32 vcc, v34, v22
    v_lshlrev_b32 v35, 6, v22
    v_sub_u32 v35, 576, v35
    v_cndmask_b32 v243, v35, v33, vcc
    v_add_u32 v243, 0x26000, v243
    s_mul_i32 s55, s56, 592
    s_lshl_b32 s57, s100, 6
    s_add_u32 s55, s55, s57
    s_add_u32 s55, s55, 155648
    v_mul_u32_u24 v188, 592, v22
    v_lshl_add_u32 v188, v23, 4, v188
    v_lshl_add_u32 v188, v24, 7, v188
    v_lshl_add_u32 v188, v26, 3, v188
    v_add_u32 v188, s55, v188
    s_lshl_b32 s55, s36, 5
    s_add_u32 s55, s55, 159200
    v_lshl_add_u32 v189, v23, 2, v21
    v_lshl_add_u32 v189, v189, 1, s55
    v_mov_b32 v35, 0x26de0
    v_lshl_add_u32 v190, v22, 5, v35
    v_mov_b32 v36, 0x3f80
    v_lshlrev_b32 v37, 4, v27
    v_lshlrev_b32 v36, v37, v36
    v_lshrrev_b32 v37, 1, v20
    v_lshlrev_b32 v38, 2, v26
    v_sub_u32 v37, v37, v38
    v_cmp_eq_u32 vcc, 0, v37
    s_nop 1
    v_cndmask_b32 v40, 0, v36, vcc
    v_cmp_eq_u32 vcc, 1, v37
    s_nop 1
    v_cndmask_b32 v41, 0, v36, vcc
    v_cmp_eq_u32 vcc, 2, v37
    s_nop 1
    v_cndmask_b32 v42, 0, v36, vcc
    v_cmp_eq_u32_e64 vcc, 3, v37
    s_nop 1
    v_cndmask_b32 v43, 0, v36, vcc
    v_add_u32 v33, 0x27a60, v33
    ds_write_b128 v33, v[40:43]
    v_mov_b32 v44, 0
    v_mov_b32 v45, 0
    v_mov_b32 v46, 0
    v_mov_b32 v47, 0
    v_min_u32_e64 v33, 5, v20
    v_mul_u32_u24 v33, 592, v33
    v_lshl_add_u32 v33, v22, 6, v33
    v_add_u32 v33, 0x26200, v33
    ds_write_b128 v33, v[44:47]
    v_lshlrev_b32 v54, 5, v52
    v_add_u32 v54, 0x20000, v54
    s_lshl_b32 s55, s36, 2
    v_lshl_add_u32 v55, v22, 4, s55
    v_add_u32 v55, v55, v54
    v_lshlrev_b32 v53, 9, v53
    v_lshl_add_u32 v53, v52, 4, v53
    s_lshr_b32 s55, s37, 2
    s_lshl2_add_u32 s55, s38, s55
    s_and_b32 s56, s37, 3
    s_lshl3_add_u32 s3, s55, s56
    s_lshl2_add_u32 s3, s3, s36
    s_lshl2_add_u32 s3, s3, 4096
    s_lshl2_add_u32 s55, s55, s36
    s_lshl_b32 s55, s55, 6
    s_add_u32 s55, s55, s56
    s_lshl_b32 s55, s55, 7
    s_add_u32 s56, s55, 4096
    s_waitcnt vmcnt(5)
    v_lshlrev_b32 v128, 16, v8
    v_and_b32 v129, 0xffff0000, v8
    v_lshlrev_b32 v130, 16, v9
    v_and_b32 v131, 0xffff0000, v9
    v_lshlrev_b32 v132, 16, v10
    v_and_b32 v133, 0xffff0000, v10
    v_lshlrev_b32 v134, 16, v11
    v_and_b32 v135, 0xffff0000, v11
    v_lshlrev_b32 v136, 16, v12
    v_and_b32 v137, 0xffff0000, v12
    v_lshlrev_b32 v138, 16, v13
    v_and_b32 v139, 0xffff0000, v13
    v_lshlrev_b32 v140, 16, v14
    v_and_b32 v141, 0xffff0000, v14
    v_lshlrev_b32 v142, 16, v15
    v_and_b32 v143, 0xffff0000, v15
    v_pk_add_f32 v[144:145], v[128:129], v[130:131]
    v_pk_mul_f32 v[146:147], v[128:129], v[128:129]
    v_pk_fma_f32 v[146:147], v[130:131], v[130:131], v[146:147]
    v_pk_add_f32 v[144:145], v[144:145], v[132:133]
    v_pk_fma_f32 v[146:147], v[132:133], v[132:133], v[146:147]
    v_pk_add_f32 v[144:145], v[144:145], v[134:135]
    v_pk_fma_f32 v[146:147], v[134:135], v[134:135], v[146:147]
    v_pk_add_f32 v[144:145], v[144:145], v[136:137]
    v_pk_fma_f32 v[146:147], v[136:137], v[136:137], v[146:147]
    v_pk_add_f32 v[144:145], v[144:145], v[138:139]
    v_pk_fma_f32 v[146:147], v[138:139], v[138:139], v[146:147]
    v_pk_add_f32 v[144:145], v[144:145], v[140:141]
    v_pk_fma_f32 v[146:147], v[140:141], v[140:141], v[146:147]
    v_pk_add_f32 v[144:145], v[144:145], v[142:143]
    v_pk_fma_f32 v[146:147], v[142:143], v[142:143], v[146:147]
    v_add_f32 v144, v144, v145
    v_add_f32 v146, v146, v147
    s_nop 1
    v_permlane32_swap_b32 v144, v146
    v_add_f32 v144, v144, v146
    v_mov_b32 v145, v144
    s_nop 1
    v_permlane16_swap_b32 v144, v145
    v_add_f32 v144, v144, v145
    s_nop 1
    v_add_f32 v144, v144, v144 row_ror:8
    ds_write_b32 v55, v144
    s_add_u32 s58, s60, 294912
    buffer_load_dwordx4 a[12:15], v5, s[80:83], s58 offen
    s_add_u32 s58, s60, 393216
    buffer_load_dwordx4 a[16:19], v5, s[80:83], s58 offen
    s_waitcnt lgkmcnt(0)
    s_barrier
    ds_read_b128 v[144:147], v54
    ds_read_b128 v[148:151], v54 offset:16
    s_add_u32 s58, s60, 491520
    buffer_load_dwordx4 a[20:23], v5, s[80:83], s58 offen
    s_add_u32 s58, s60, 589824
    buffer_load_dwordx4 a[24:27], v5, s[80:83], s58 offen
    s_waitcnt lgkmcnt(0)
    v_pk_add_f32 v[144:145], v[144:145], v[146:147]
    v_pk_add_f32 v[148:149], v[148:149], v[150:151]
    v_add_f32 v144, v144, v145
    v_add_f32_e64 v148, v148, v149
    v_mul_f32 v144, 0x3b000000, v144
    v_mul_f32 v148, 0x3b000000, v148
    v_fma_f32 v148, -v144, v144, v148
    v_max_f32 v148, 0, v148
    v_cvt_pk_bf16_f32 v148, v144, v148
    v_lshlrev_b32 v144, 16, v148
    v_and_b32 v148, 0xffff0000, v148
    v_add_f32 v148, 0x3727c5ac, v148
    v_cvt_pk_bf16_f32 v148, v148, v148
    v_and_b32 v148, 0xffff0000, v148
    v_sqrt_f32_e64 v148, v148
    v_pk_add_f32 v[128:129], v[128:129], v[144:145] op_sel_hi:[1,0] neg_lo:[0,1] neg_hi:[0,1]
    v_pk_add_f32 v[130:131], v[130:131], v[144:145] op_sel_hi:[1,0] neg_lo:[0,1] neg_hi:[0,1]
    v_pk_add_f32 v[132:133], v[132:133], v[144:145] op_sel_hi:[1,0] neg_lo:[0,1] neg_hi:[0,1]
    v_pk_add_f32 v[134:135], v[134:135], v[144:145] op_sel_hi:[1,0] neg_lo:[0,1] neg_hi:[0,1]
    v_pk_add_f32 v[136:137], v[136:137], v[144:145] op_sel_hi:[1,0] neg_lo:[0,1] neg_hi:[0,1]
    v_pk_add_f32 v[138:139], v[138:139], v[144:145] op_sel_hi:[1,0] neg_lo:[0,1] neg_hi:[0,1]
    v_pk_add_f32 v[140:141], v[140:141], v[144:145] op_sel_hi:[1,0] neg_lo:[0,1] neg_hi:[0,1]
    v_pk_add_f32 v[142:143], v[142:143], v[144:145] op_sel_hi:[1,0] neg_lo:[0,1] neg_hi:[0,1]
    v_cvt_pk_bf16_f32 v148, v148, v148
    v_and_b32 v148, 0xffff0000, v148
    v_rcp_f32_e64 v148, v148
    v_cvt_pk_bf16_f32 v8, v128, v129
    v_cvt_pk_bf16_f32 v9, v130, v131
    v_cvt_pk_bf16_f32 v10, v132, v133
    v_cvt_pk_bf16_f32 v11, v134, v135
    v_lshlrev_b32 v128, 16, v8
    v_and_b32 v129, 0xffff0000, v8
    v_lshlrev_b32 v130, 16, v9
    v_and_b32 v131, 0xffff0000, v9
    v_lshlrev_b32 v132, 16, v10
    v_and_b32 v133, 0xffff0000, v10
    v_lshlrev_b32 v134, 16, v11
    v_and_b32 v135, 0xffff0000, v11
    v_pk_mul_f32 v[128:129], v[128:129], v[148:149] op_sel_hi:[1,0]
    v_pk_mul_f32 v[130:131], v[130:131], v[148:149] op_sel_hi:[1,0]
    v_pk_mul_f32 v[132:133], v[132:133], v[148:149] op_sel_hi:[1,0]
    v_pk_mul_f32 v[134:135], v[134:135], v[148:149] op_sel_hi:[1,0]
    v_cvt_pk_bf16_f32 v8, v128, v129
    v_cvt_pk_bf16_f32 v9, v130, v131
    v_cvt_pk_bf16_f32 v10, v132, v133
    v_cvt_pk_bf16_f32 v11, v134, v135
    buffer_store_dwordx4 v[8:11], v53, s[28:31], s55 offen sc1
    v_cvt_pk_bf16_f32 v12, v136, v137
    v_cvt_pk_bf16_f32 v13, v138, v139
    v_cvt_pk_bf16_f32 v14, v140, v141
    v_cvt_pk_bf16_f32 v15, v142, v143
    v_lshlrev_b32 v136, 16, v12
    v_and_b32 v137, 0xffff0000, v12
    v_lshlrev_b32 v138, 16, v13
    v_and_b32 v139, 0xffff0000, v13
    v_lshlrev_b32 v140, 16, v14
    v_and_b32 v141, 0xffff0000, v14
    v_lshlrev_b32 v142, 16, v15
    v_and_b32 v143, 0xffff0000, v15
    v_pk_mul_f32 v[136:137], v[136:137], v[148:149] op_sel_hi:[1,0]
    v_pk_mul_f32 v[138:139], v[138:139], v[148:149] op_sel_hi:[1,0]
    v_pk_mul_f32 v[140:141], v[140:141], v[148:149] op_sel_hi:[1,0]
    v_pk_mul_f32 v[142:143], v[142:143], v[148:149] op_sel_hi:[1,0]
    v_cvt_pk_bf16_f32 v12, v136, v137
    v_cvt_pk_bf16_f32 v13, v138, v139
    v_cvt_pk_bf16_f32 v14, v140, v141
    v_cvt_pk_bf16_f32 v15, v142, v143
    buffer_store_dwordx4 v[12:15], v53, s[28:31], s56 offen sc1
    s_cmp_lt_u32 s36, 2
    s_cbranch_scc0 L_skip_2
    s_mov_b32 exec_hi, 15
    buffer_store_dwordx4 v[28:31], v49, s[24:27], s49 offen sc1
    s_mov_b32 exec_hi, -1
L_skip_2:
    s_branch L_page0
L_stub_7:
    s_mov_b64 exec, 0
    s_cmp_eq_u32 s36, 2
    s_cbranch_scc1 L_pad4
    s_branch L_pad5
L_stub_17:
    s_mov_b64 exec, 0
    s_cmp_eq_u32 s36, 2
    s_cbranch_scc1 L_pad6
    s_branch L_pad9
.p2align 12
L_page0:
    s_waitcnt lgkmcnt(0)
    s_waitcnt vmcnt(8)
    ds_write_b128 v253, a[0:3] offset:0
    s_waitcnt vmcnt(7)
    ds_write_b128 v253, a[4:7] offset:2048
    s_add_u32 s55, s60, 688128
    buffer_load_dwordx4 a[28:31], v5, s[80:83], s55 offen
    s_waitcnt vmcnt(7)
    ds_write_b128 v253, a[8:11] offset:4096
    s_add_u32 s55, s60, 786432
    buffer_load_dwordx4 a[32:35], v5, s[80:83], s55 offen
    s_waitcnt vmcnt(7)
    ds_write_b128 v253, a[12:15] offset:6144
    s_add_u32 s55, s60, 884736
    buffer_load_dwordx4 a[36:39], v5, s[80:83], s55 offen
    s_waitcnt vmcnt(7)
    ds_write_b128 v253, a[16:19] offset:8192
    s_add_u32 s55, s60, 983040
    buffer_load_dwordx4 a[40:43], v5, s[80:83], s55 offen
    s_waitcnt vmcnt(7)
    ds_write_b128 v253, a[20:23] offset:10240
    s_add_u32 s55, s60, 1081344
    buffer_load_dwordx4 a[44:47], v5, s[80:83], s55 offen
    s_waitcnt vmcnt(7)
    ds_write_b128 v253, a[24:27] offset:12288
    s_mul_i32 s50, s53, 0x9e3779b1
    s_add_u32 s50, s50, 0x7f4a7c15
    s_and_b32 s50, s50, 0xffffff00
    s_or_b32 s54, s50, s54
    v_mov_b32 v34, s54
    s_mov_b64 exec, 1
    s_waitcnt vmcnt(5)
    buffer_store_dword v34, off, s[24:27], s3
    s_mov_b64 exec, -1
    s_cmp_lt_u32 s36, 2
    s_cbranch_scc0 L_skip_3
    s_or_b32 s56, s50, 0xf0
    v_mov_b32 v35, s56
    v_lshrrev_b32 v37, 2, v240
    s_lshl_b32 s55, s38, 7
    s_add_u32 s55, s55, s63
    s_mov_b32 exec_hi, 0
    buffer_store_dword v35, v37, s[24:27], s55 offen sc1
    s_mov_b32 exec_hi, -1
L_skip_3:
    v_lshl_add_u32 v38, v21, 7, v250
    s_and_b32 s57, s41, 0xfffffe7f
    s_add_u32 s55, s60, 1179648
    buffer_load_dwordx4 a[48:51], v5, s[80:83], s55 offen
    s_waitcnt vmcnt(6)
    ds_write_b128 v253, a[28:31] offset:14336
    s_add_u32 s55, s60, 1277952
    buffer_load_dwordx4 a[52:55], v5, s[80:83], s55 offen
    s_waitcnt vmcnt(6)
    ds_write_b128 v253, a[32:35] offset:16384
    s_add_u32 s55, s60, 1376256
    buffer_load_dwordx4 a[56:59], v5, s[80:83], s55 offen
    s_waitcnt vmcnt(6)
    ds_write_b128 v253, a[36:39] offset:18432
    s_add_u32 s55, s60, 1474560
    buffer_load_dwordx4 a[60:63], v5, s[80:83], s55 offen
    s_waitcnt vmcnt(6)
    ds_write_b128 v253, a[40:43] offset:20480
    buffer_load_dword v34, v38, s[24:27], s57 offen sc1
    s_mov_b64 exec, 0
    s_cmp_eq_u32 s36, 0
    s_cbranch_scc1 L_pad0
    s_cmp_eq_u32 s36, 1
    s_cbranch_scc1 L_pad1
    s_cmp_eq_u32 s36, 2
    s_cbranch_scc1 L_pad2
    s_branch L_pad3
L_warmed0:
    s_mov_b64 exec, -1
    s_waitcnt vmcnt(6)
    ds_write_b128 v253, a[44:47] offset:22528
    s_lshl_b32 s55, s36, 10
    s_add_u32 s55, s55, 143360
    v_add_u32 v33, s55, v240
    ds_write_b128 v33, v[16:19]
    v_lshlrev_b32 v33, 9, v27
    v_lshl_add_u32 v33, v22, 8, v33
    v_lshl_add_u32 v33, v24, 5, v33
    v_lshl_add_u32 v33, v26, 4, v33
    v_lshl_add_u32 v33, v32, 3, v33
    v_add_u32 v33, s55, v33
    v_mul_u32_u24 v39, 80, v22
    v_add_u32 v39, v39, v240
    v_add_u32 v39, 0x26940, v39
    s_waitcnt lgkmcnt(0)
    ds_read_b64_tr_b16 v[16:17], v33
    ds_read_b64_tr_b16 v[18:19], v33 offset:128
    s_waitcnt vmcnt(4)
    ds_write_b128 v253, a[48:51] offset:24576
    s_waitcnt lgkmcnt(1)
    ds_write_b128 v39, v[16:19]
    s_waitcnt vmcnt(3)
    ds_write_b128 v253, a[52:55] offset:26624
    s_waitcnt vmcnt(2)
    ds_write_b128 v253, a[56:59] offset:28672
    s_waitcnt vmcnt(1)
    ds_write_b128 v253, a[60:63] offset:30720
    s_waitcnt vmcnt(0)
    v_cmp_ne_u32 vcc, s54, v34
    s_nop 0
    s_cbranch_vccnz L_poll0
L_enter:
L_layer0:
    buffer_load_dwordx4 v[0:3], v240, s[28:31], s39 offen offset:0 sc1
    buffer_load_dwordx4 v[4:7], v240, s[28:31], s39 offen offset:1024 sc1
    buffer_load_dwordx4 v[8:11], v240, s[28:31], s39 offen offset:2048 sc1
    buffer_load_dwordx4 v[12:15], v240, s[28:31], s39 offen offset:3072 sc1
    s_waitcnt lgkmcnt(0)
    s_barrier
    ds_read_b64_tr_b16 v[160:161], v241 offset:0
    ds_read_b64_tr_b16 v[162:163], v241 offset:256
    ds_read_b64_tr_b16 v[164:165], v241 offset:32768
    ds_read_b64_tr_b16 v[166:167], v241 offset:33024
    s_xor_b32 s58, s39, 4096
    buffer_load_dwordx4 v[16:19], v240, s[28:31], s58 offen offset:0 sc1
    ds_read_b64_tr_b16 v[168:169], v241 offset:1024
    ds_read_b64_tr_b16 v[170:171], v241 offset:1280
    ds_read_b64_tr_b16 v[172:173], v241 offset:33792
    ds_read_b64_tr_b16 v[174:175], v241 offset:34048
    buffer_load_dwordx4 v[20:23], v240, s[28:31], s58 offen offset:1024 sc1
    ds_read_b64_tr_b16 v[176:177], v241 offset:2048
    ds_read_b64_tr_b16 v[178:179], v241 offset:2304
    ds_read_b64_tr_b16 v[180:181], v241 offset:34816
    ds_read_b64_tr_b16 v[182:183], v241 offset:35072
    buffer_load_dwordx4 v[24:27], v240, s[28:31], s58 offen offset:2048 sc1
    buffer_load_dwordx4 v[28:31], v240, s[28:31], s58 offen offset:3072 sc1
    v_and_b32 v224, 0x1f0, v240
    v_add_u32 v224, 0x27a60, v224
    ds_read_b128 v[224:227], v224
    s_waitcnt vmcnt(7) lgkmcnt(9)
    v_mfma_f32_32x32x16_bf16 v[128:143], v[160:163], v[0:3], 0
    s_xor_b32 s58, s39, 8192
    buffer_load_dwordx4 v[32:35], v240, s[28:31], s58 offen offset:0 sc1
    ds_read_b64_tr_b16 v[160:161], v241 offset:3072
    ds_read_b64_tr_b16 v[162:163], v241 offset:3328
    v_mfma_f32_32x32x16_bf16 v[144:159], v[164:167], v[0:3], 0
    v_mov_b32 v236, -1
    ds_read_b64_tr_b16 v[164:165], v241 offset:35840
    ds_read_b64_tr_b16 v[166:167], v241 offset:36096
    v_mov_b32 v237, -1
    s_waitcnt vmcnt(7) lgkmcnt(9)
    v_mfma_f32_32x32x16_bf16 v[128:143], v[168:171], v[4:7], v[128:143]
    buffer_load_dwordx4 v[36:39], v240, s[28:31], s58 offen offset:1024 sc1
    ds_read_b64_tr_b16 v[168:169], v241 offset:4096
    ds_read_b64_tr_b16 v[170:171], v241 offset:4352
    v_mfma_f32_32x32x16_bf16 v[144:159], v[172:175], v[4:7], v[144:159]
    v_mov_b32_e64 v238, -1
    ds_read_b64_tr_b16 v[172:173], v241 offset:36864
    ds_read_b64_tr_b16 v[174:175], v241 offset:37120
    v_mov_b32 v239, -1
    s_waitcnt vmcnt(7) lgkmcnt(9)
    v_mfma_f32_32x32x16_bf16 v[128:143], v[176:179], v[8:11], v[128:143]
    buffer_load_dwordx4 v[40:43], v240, s[28:31], s58 offen offset:2048 sc1
    ds_read_b64_tr_b16 v[176:177], v241 offset:5120
    ds_read_b64_tr_b16 v[178:179], v241 offset:5376
    v_mfma_f32_32x32x16_bf16 v[144:159], v[180:183], v[8:11], v[144:159]
    v_lshrrev_b32_e64 v202, 6, v240
    ds_read_b64_tr_b16 v[180:181], v241 offset:37888
    ds_read_b64_tr_b16 v[182:183], v241 offset:38144
    v_mul_u32_u24 v202, 3008, v202
    s_waitcnt vmcnt(7) lgkmcnt(8)
    v_mfma_f32_32x32x16_bf16 v[128:143], v[160:163], v[12:15], v[128:143]
    buffer_load_dwordx4 v[44:47], v240, s[28:31], s58 offen offset:3072 sc1
    ds_read_b64_tr_b16 v[160:161], v241 offset:6144
    ds_read_b64_tr_b16 v[162:163], v241 offset:6400
    v_mfma_f32_32x32x16_bf16 v[144:159], v[164:167], v[12:15], v[144:159]
    v_add_u32 v202, v202, v240
    ds_read_b64_tr_b16 v[164:165], v241 offset:38912
    ds_read_b64_tr_b16 v[166:167], v241 offset:39168
    v_mov_b32 v244, 0x3fb8aa3b
    s_waitcnt vmcnt(7) lgkmcnt(8)
    v_mfma_f32_32x32x16_bf16 v[128:143], v[168:171], v[16:19], v[128:143]
    s_xor_b32 s58, s39, 12288
    buffer_load_dwordx4 v[48:51], v240, s[28:31], s58 offen offset:0 sc1
    ds_read_b64_tr_b16 v[168:169], v241 offset:7168
    ds_read_b64_tr_b16 v[170:171], v241 offset:7424
    v_mfma_f32_32x32x16_bf16 v[144:159], v[172:175], v[16:19], v[144:159]
    s_and_b32 s57, s36, 1
    ds_read_b64_tr_b16 v[172:173], v241 offset:39936
    ds_read_b64_tr_b16 v[174:175], v241 offset:40192
    v_mfma_f32_16x16x32_bf16 v[228:231], v[224:227], a[0:3], 0
    s_waitcnt vmcnt(7) lgkmcnt(8)
    v_mfma_f32_32x32x16_bf16 v[128:143], v[176:179], v[20:23], v[128:143]
    buffer_load_dwordx4 v[52:55], v240, s[28:31], s58 offen offset:1024 sc1
    ds_read_b64_tr_b16 v[176:177], v241 offset:8192
    ds_read_b64_tr_b16 v[178:179], v241 offset:8448
    v_mfma_f32_32x32x16_bf16 v[144:159], v[180:183], v[20:23], v[144:159]
    s_lshl_b32 s57, s57, 9
    ds_read_b64_tr_b16 v[180:181], v241 offset:40960
    ds_read_b64_tr_b16 v[182:183], v241 offset:41216
    v_mfma_f32_16x16x32_bf16 v[228:231], v[224:227], a[4:7], v[228:231]
    s_waitcnt vmcnt(7) lgkmcnt(8)
    v_mfma_f32_32x32x16_bf16 v[128:143], v[160:163], v[24:27], v[128:143]
    buffer_load_dwordx4 v[56:59], v240, s[28:31], s58 offen offset:2048 sc1
    ds_read_b64_tr_b16 v[160:161], v241 offset:9216
    ds_read_b64_tr_b16 v[162:163], v241 offset:9472
    v_mfma_f32_32x32x16_bf16 v[144:159], v[164:167], v[24:27], v[144:159]
    s_and_b32 s56, s36, 2
    ds_read_b64_tr_b16 v[164:165], v241 offset:41984
    ds_read_b64_tr_b16 v[166:167], v241 offset:42240
    v_mfma_f32_16x16x32_bf16 v[228:231], v[224:227], a[8:11], v[228:231]
    s_waitcnt vmcnt(7) lgkmcnt(8)
    v_mfma_f32_32x32x16_bf16 v[128:143], v[168:171], v[28:31], v[128:143]
    buffer_load_dwordx4 v[60:63], v240, s[28:31], s58 offen offset:3072 sc1
    ds_read_b64_tr_b16 v[168:169], v241 offset:10240
    ds_read_b64_tr_b16 v[170:171], v241 offset:10496
    v_mfma_f32_32x32x16_bf16 v[144:159], v[172:175], v[28:31], v[144:159]
    s_lshl2_add_u32 s57, s56, s57
    ds_read_b64_tr_b16 v[172:173], v241 offset:43008
    ds_read_b64_tr_b16 v[174:175], v241 offset:43264
    v_mfma_f32_16x16x32_bf16 v[228:231], v[224:227], a[12:15], v[228:231]
    s_waitcnt vmcnt(7) lgkmcnt(8)
    v_mfma_f32_32x32x16_bf16 v[128:143], v[176:179], v[32:35], v[128:143]
    s_xor_b32 s58, s39, 16384
    buffer_load_dwordx4 v[64:67], v240, s[28:31], s58 offen offset:0 sc1
    ds_read_b64_tr_b16 v[176:177], v241 offset:11264
    ds_read_b64_tr_b16 v[178:179], v241 offset:11520
    v_mfma_f32_32x32x16_bf16 v[144:159], v[180:183], v[32:35], v[144:159]
    s_add_u32 s57, s57, 159328
    ds_read_b64_tr_b16 v[180:181], v241 offset:44032
    ds_read_b64_tr_b16 v[182:183], v241 offset:44288
    v_mfma_f32_16x16x32_bf16 v[228:231], v[224:227], a[16:19], v[228:231]
    s_waitcnt vmcnt(7) lgkmcnt(8)
    v_mfma_f32_32x32x16_bf16 v[128:143], v[160:163], v[36:39], v[128:143]
    buffer_load_dwordx4 v[68:71], v240, s[28:31], s58 offen offset:1024 sc1
    ds_read_b64_tr_b16 v[160:161], v241 offset:12288
    ds_read_b64_tr_b16 v[162:163], v241 offset:12544
    v_mfma_f32_32x32x16_bf16 v[144:159], v[164:167], v[36:39], v[144:159]
    v_lshrrev_b32_e64 v192, 9, v240
    ds_read_b64_tr_b16 v[164:165], v241 offset:45056
    ds_read_b64_tr_b16 v[166:167], v241 offset:45312
    v_mfma_f32_16x16x32_bf16 v[228:231], v[224:227], a[20:23], v[228:231]
    s_waitcnt vmcnt(7) lgkmcnt(8)
    v_mfma_f32_32x32x16_bf16 v[128:143], v[168:171], v[40:43], v[128:143]
    buffer_load_dwordx4 v[72:75], v240, s[28:31], s58 offen offset:2048 sc1
    ds_read_b64_tr_b16 v[168:169], v241 offset:13312
    ds_read_b64_tr_b16 v[170:171], v241 offset:13568
    v_mfma_f32_32x32x16_bf16 v[144:159], v[172:175], v[40:43], v[144:159]
    v_lshl_add_u32 v192, v192, 2, s57
    ds_read_b64_tr_b16 v[172:173], v241 offset:46080
    ds_read_b64_tr_b16 v[174:175], v241 offset:46336
    v_mfma_f32_16x16x32_bf16 v[228:231], v[224:227], a[24:27], v[228:231]
    s_waitcnt vmcnt(7) lgkmcnt(8)
    v_mfma_f32_32x32x16_bf16 v[128:143], v[176:179], v[44:47], v[128:143]
    buffer_load_dwordx4 v[76:79], v240, s[28:31], s58 offen offset:3072 sc1
    ds_read_b64_tr_b16 v[176:177], v241 offset:14336
    ds_read_b64_tr_b16 v[178:179], v241 offset:14592
    v_mfma_f32_32x32x16_bf16 v[144:159], v[180:183], v[44:47], v[144:159]
    v_bfe_u32 v193, v240, 4, 1
    ds_read_b64_tr_b16 v[180:181], v241 offset:47104
    ds_read_b64_tr_b16 v[182:183], v241 offset:47360
    v_mfma_f32_16x16x32_bf16 v[228:231], v[224:227], a[28:31], v[228:231]
    s_waitcnt vmcnt(7) lgkmcnt(8)
    v_mfma_f32_32x32x16_bf16 v[128:143], v[160:163], v[48:51], v[128:143]
    s_xor_b32 s58, s39, 20480
    buffer_load_dwordx4 v[80:83], v240, s[28:31], s58 offen offset:0 sc1
    ds_read_b64_tr_b16 v[160:161], v241 offset:15360
    ds_read_b64_tr_b16 v[162:163], v241 offset:15616
    v_mfma_f32_32x32x16_bf16 v[144:159], v[164:167], v[48:51], v[144:159]
    v_lshl_add_u32 v192, v193, 8, v192
    ds_read_b64_tr_b16 v[164:165], v241 offset:48128
    ds_read_b64_tr_b16 v[166:167], v241 offset:48384
    v_mfma_f32_16x16x32_bf16 v[228:231], v[224:227], a[32:35], v[228:231]
    s_waitcnt vmcnt(7) lgkmcnt(8)
    v_mfma_f32_32x32x16_bf16 v[128:143], v[168:171], v[52:55], v[128:143]
    buffer_load_dwordx4 v[84:87], v240, s[28:31], s58 offen offset:1024 sc1
    ds_read_b64_tr_b16 v[168:169], v241 offset:16384
    ds_read_b64_tr_b16 v[170:171], v241 offset:16640
    v_mfma_f32_32x32x16_bf16 v[144:159], v[172:175], v[52:55], v[144:159]
    v_bfe_u32 v193, v240, 8, 1
    ds_read_b64_tr_b16 v[172:173], v241 offset:49152
    ds_read_b64_tr_b16 v[174:175], v241 offset:49408
    v_mfma_f32_16x16x32_bf16 v[228:231], v[224:227], a[36:39], v[228:231]
    s_waitcnt vmcnt(7) lgkmcnt(8)
    v_mfma_f32_32x32x16_bf16 v[128:143], v[176:179], v[56:59], v[128:143]
    buffer_load_dwordx4 v[88:91], v240, s[28:31], s58 offen offset:2048 sc1
    ds_read_b64_tr_b16 v[176:177], v241 offset:17408
    ds_read_b64_tr_b16 v[178:179], v241 offset:17664
    v_mfma_f32_32x32x16_bf16 v[144:159], v[180:183], v[56:59], v[144:159]
    v_lshl_add_u32 v192, v193, 7, v192
    ds_read_b64_tr_b16 v[180:181], v241 offset:50176
    ds_read_b64_tr_b16 v[182:183], v241 offset:50432
    v_mfma_f32_16x16x32_bf16 v[228:231], v[224:227], a[40:43], v[228:231]
    s_waitcnt vmcnt(7) lgkmcnt(8)
    v_mfma_f32_32x32x16_bf16 v[128:143], v[160:163], v[60:63], v[128:143]
    buffer_load_dwordx4 v[92:95], v240, s[28:31], s58 offen offset:3072 sc1
    ds_read_b64_tr_b16 v[160:161], v241 offset:18432
    ds_read_b64_tr_b16 v[162:163], v241 offset:18688
    v_mfma_f32_32x32x16_bf16 v[144:159], v[164:167], v[60:63], v[144:159]
    v_bfe_u32 v193, v240, 5, 1
    ds_read_b64_tr_b16 v[164:165], v241 offset:51200
    ds_read_b64_tr_b16 v[166:167], v241 offset:51456
    v_mfma_f32_16x16x32_bf16 v[228:231], v[224:227], a[44:47], v[228:231]
    s_waitcnt vmcnt(7) lgkmcnt(8)
    v_mfma_f32_32x32x16_bf16 v[128:143], v[168:171], v[64:67], v[128:143]
    s_xor_b32 s58, s39, 24576
    buffer_load_dwordx4 v[96:99], v240, s[28:31], s58 offen offset:0 sc1
    ds_read_b64_tr_b16 v[168:169], v241 offset:19456
    ds_read_b64_tr_b16 v[170:171], v241 offset:19712
    v_mfma_f32_32x32x16_bf16 v[144:159], v[172:175], v[64:67], v[144:159]
    v_lshl_add_u32 v192, v193, 6, v192
    ds_read_b64_tr_b16 v[172:173], v241 offset:52224
    ds_read_b64_tr_b16 v[174:175], v241 offset:52480
    v_mfma_f32_16x16x32_bf16 v[228:231], v[224:227], a[48:51], v[228:231]
    s_waitcnt vmcnt(7) lgkmcnt(8)
    v_mfma_f32_32x32x16_bf16 v[128:143], v[176:179], v[68:71], v[128:143]
    buffer_load_dwordx4 v[100:103], v240, s[28:31], s58 offen offset:1024 sc1
    ds_read_b64_tr_b16 v[176:177], v241 offset:20480
    ds_read_b64_tr_b16 v[178:179], v241 offset:20736
    v_mfma_f32_32x32x16_bf16 v[144:159], v[180:183], v[68:71], v[144:159]
    ds_read_b64_tr_b16 v[180:181], v241 offset:53248
    ds_read_b64_tr_b16 v[182:183], v241 offset:53504
    v_mfma_f32_16x16x32_bf16 v[228:231], v[224:227], a[52:55], v[228:231]
    s_waitcnt vmcnt(7) lgkmcnt(8)
    v_mfma_f32_32x32x16_bf16 v[128:143], v[160:163], v[72:75], v[128:143]
    buffer_load_dwordx4 v[104:107], v240, s[28:31], s58 offen offset:2048 sc1
    ds_read_b64_tr_b16 v[160:161], v241 offset:21504
    ds_read_b64_tr_b16 v[162:163], v241 offset:21760
    v_mfma_f32_32x32x16_bf16 v[144:159], v[164:167], v[72:75], v[144:159]
    ds_read_b64_tr_b16 v[164:165], v241 offset:54272
    ds_read_b64_tr_b16 v[166:167], v241 offset:54528
    v_mfma_f32_16x16x32_bf16 v[228:231], v[224:227], a[56:59], v[228:231]
    s_waitcnt vmcnt(7) lgkmcnt(8)
    v_mfma_f32_32x32x16_bf16 v[128:143], v[168:171], v[76:79], v[128:143]
    buffer_load_dwordx4 v[108:111], v240, s[28:31], s58 offen offset:3072 sc1
    ds_read_b64_tr_b16 v[168:169], v241 offset:22528
    ds_read_b64_tr_b16 v[170:171], v241 offset:22784
    v_mfma_f32_32x32x16_bf16 v[144:159], v[172:175], v[76:79], v[144:159]
    ds_read_b64_tr_b16 v[172:173], v241 offset:55296
    ds_read_b64_tr_b16 v[174:175], v241 offset:55552
    v_mfma_f32_16x16x32_bf16 v[228:231], v[224:227], a[60:63], v[228:231]
    s_waitcnt vmcnt(7) lgkmcnt(8)
    v_mfma_f32_32x32x16_bf16 v[128:143], v[176:179], v[80:83], v[128:143]
    s_xor_b32 s58, s39, 28672
    buffer_load_dwordx4 v[112:115], v240, s[28:31], s58 offen offset:0 sc1
    ds_read_b64_tr_b16 v[176:177], v241 offset:23552
    ds_read_b64_tr_b16 v[178:179], v241 offset:23808
    v_mfma_f32_32x32x16_bf16 v[144:159], v[180:183], v[80:83], v[144:159]
    ds_read_b64_tr_b16 v[180:181], v241 offset:56320
    ds_read_b64_tr_b16 v[182:183], v241 offset:56576
    s_waitcnt vmcnt(7) lgkmcnt(8)
    v_mfma_f32_32x32x16_bf16 v[128:143], v[160:163], v[84:87], v[128:143]
    buffer_load_dwordx4 v[116:119], v240, s[28:31], s58 offen offset:1024 sc1
    ds_read_b64_tr_b16 v[160:161], v241 offset:24576
    ds_read_b64_tr_b16 v[162:163], v241 offset:24832
    v_mfma_f32_32x32x16_bf16 v[144:159], v[164:167], v[84:87], v[144:159]
    ds_read_b64_tr_b16 v[164:165], v241 offset:57344
    ds_read_b64_tr_b16 v[166:167], v241 offset:57600
    s_waitcnt vmcnt(7) lgkmcnt(8)
    v_mfma_f32_32x32x16_bf16 v[128:143], v[168:171], v[88:91], v[128:143]
    buffer_load_dwordx4 v[120:123], v240, s[28:31], s58 offen offset:2048 sc1
    ds_read_b64_tr_b16 v[168:169], v241 offset:25600
    ds_read_b64_tr_b16 v[170:171], v241 offset:25856
    v_mfma_f32_32x32x16_bf16 v[144:159], v[172:175], v[88:91], v[144:159]
    v_add_f32 v228, v228, v228 row_ror:4
    ds_read_b64_tr_b16 v[172:173], v241 offset:58368
    ds_read_b64_tr_b16 v[174:175], v241 offset:58624
    v_add_f32 v229, v229, v229 row_ror:4
    s_waitcnt vmcnt(7) lgkmcnt(8)
    v_mfma_f32_32x32x16_bf16 v[128:143], v[176:179], v[92:95], v[128:143]
    buffer_load_dwordx4 v[124:127], v240, s[28:31], s58 offen offset:3072 sc1
    ds_read_b64_tr_b16 v[176:177], v241 offset:26624
    ds_read_b64_tr_b16 v[178:179], v241 offset:26880
    v_mfma_f32_32x32x16_bf16 v[144:159], v[180:183], v[92:95], v[144:159]
    v_add_f32 v230, v230, v230 row_ror:4
    ds_read_b64_tr_b16 v[180:181], v241 offset:59392
    ds_read_b64_tr_b16 v[182:183], v241 offset:59648
    v_add_f32 v231, v231, v231 row_ror:4
    s_waitcnt vmcnt(7) lgkmcnt(8)
    v_mfma_f32_32x32x16_bf16 v[128:143], v[160:163], v[96:99], v[128:143]
    s_add_u32 s57, s49, 589824
    s_mov_b64 exec, s[96:97]
    buffer_store_dwordx4 v[236:239], v186, s[24:27], s57 offen sc1
    s_mov_b64 exec, s[10:11]
    buffer_store_dwordx4 v[236:239], v187, s[24:27], s57 offen sc1
    s_mov_b64 exec, -1
    s_add_u32 m0, s98, 65536
    s_add_u32 s55, s61, 0
    buffer_load_dwordx4 v202, s[80:83], s55 offen lds
    ds_read_b64_tr_b16 v[160:161], v241 offset:27648
    ds_read_b64_tr_b16 v[162:163], v241 offset:27904
    v_mfma_f32_32x32x16_bf16 v[144:159], v[164:167], v[96:99], v[144:159]
    v_add_f32 v228, v228, v228 row_ror:8
    ds_read_b64_tr_b16 v[164:165], v241 offset:60416
    ds_read_b64_tr_b16 v[166:167], v241 offset:60672
    v_add_f32 v229, v229, v229 row_ror:8
    s_waitcnt vmcnt(9) lgkmcnt(8)
    v_mfma_f32_32x32x16_bf16 v[128:143], v[168:171], v[100:103], v[128:143]
    s_add_u32 m0, s98, 66560
    s_add_u32 s55, s61, 49152
    buffer_load_dwordx4 v202, s[80:83], s55 offen lds
    ds_read_b64_tr_b16 v[168:169], v241 offset:28672
    ds_read_b64_tr_b16 v[170:171], v241 offset:28928
    v_mfma_f32_32x32x16_bf16 v[144:159], v[172:175], v[100:103], v[144:159]
    v_add_f32 v230, v230, v230 row_ror:8
    ds_read_b64_tr_b16 v[172:173], v241 offset:61440
    ds_read_b64_tr_b16 v[174:175], v241 offset:61696
    v_add_f32 v231, v231, v231 row_ror:8
    s_waitcnt vmcnt(9) lgkmcnt(8)
    v_mfma_f32_32x32x16_bf16 v[128:143], v[176:179], v[104:107], v[128:143]
    s_add_u32 m0, s98, 67584
    s_add_u32 s55, s61, 98304
    buffer_load_dwordx4 v202, s[80:83], s55 offen lds
    ds_read_b64_tr_b16 v[176:177], v241 offset:29696
    ds_read_b64_tr_b16 v[178:179], v241 offset:29952
    v_mfma_f32_32x32x16_bf16 v[144:159], v[180:183], v[104:107], v[144:159]
    ds_write2_b32 v192, v228, v229 offset0:0 offset1:4
    ds_read_b64_tr_b16 v[180:181], v241 offset:62464
    ds_read_b64_tr_b16 v[182:183], v241 offset:62720
    ds_write2_b32 v192, v230, v231 offset0:8 offset1:12
    s_waitcnt vmcnt(9) lgkmcnt(10)
    v_mfma_f32_32x32x16_bf16 v[128:143], v[160:163], v[108:111], v[128:143]
    ds_read_b64_tr_b16 v[160:161], v241 offset:30720
    ds_read_b64_tr_b16 v[162:163], v241 offset:30976
    v_mfma_f32_32x32x16_bf16 v[144:159], v[164:167], v[108:111], v[144:159]
    ds_read_b64_tr_b16 v[164:165], v241 offset:63488
    ds_read_b64_tr_b16 v[166:167], v241 offset:63744
    s_waitcnt vmcnt(8) lgkmcnt(10)
    v_mfma_f32_32x32x16_bf16 v[128:143], v[168:171], v[112:115], v[128:143]
    s_add_u32 m0, s98, 68608
    s_add_u32 s55, s61, 147456
    buffer_load_dwordx4 v202, s[80:83], s55 offen lds
    ds_read_b64_tr_b16 v[168:169], v241 offset:31744
    ds_read_b64_tr_b16 v[170:171], v241 offset:32000
    v_mfma_f32_32x32x16_bf16 v[144:159], v[172:175], v[112:115], v[144:159]
    ds_read_b64_tr_b16 v[172:173], v241 offset:64512
    ds_read_b64_tr_b16 v[174:175], v241 offset:64768
    s_waitcnt vmcnt(8) lgkmcnt(9)
    v_mfma_f32_32x32x16_bf16 v[128:143], v[176:179], v[116:119], v[128:143]
    s_add_u32 m0, s98, 69632
    s_add_u32 s55, s61, 196608
    buffer_load_dwordx4 v202, s[80:83], s55 offen lds
    v_mfma_f32_32x32x16_bf16 v[144:159], v[180:183], v[116:119], v[144:159]
    s_waitcnt vmcnt(8) lgkmcnt(4)
    v_mfma_f32_32x32x16_bf16 v[128:143], v[160:163], v[120:123], v[128:143]
    s_add_u32 m0, s98, 70656
    s_add_u32 s55, s61, 245760
    buffer_load_dwordx4 v202, s[80:83], s55 offen lds
    v_mov_b32 v180, v202
    v_lshrrev_b32 v181, 7, v240
    v_mul_u32_u24 v181, 896, v181
    v_add_u32 v181, v181, v240
    v_mfma_f32_32x32x16_bf16 v[144:159], v[164:167], v[120:123], v[144:159]
    s_waitcnt vmcnt(8) lgkmcnt(0)
    v_mfma_f32_32x32x16_bf16 v[128:143], v[168:171], v[124:127], v[128:143]
    v_mfma_f32_32x32x16_bf16 v[144:159], v[172:175], v[124:127], v[144:159]
    s_sub_u32 s55, 0x180, s88
    s_and_b32 s55, s55, 0x380
    s_mul_i32 s56, s0, 4096
    s_add_u32 s55, s55, s56
    v_lshlrev_b32 v183, 6, v240
    s_mov_b64 exec, 0xf
    buffer_load_dword v183, v183, s[88:91], s55 offen
    s_mov_b64 exec, -1
    s_add_u32 m0, s98, 71680
    s_add_u32 s55, s61, 294912
    buffer_load_dwordx4 v180, s[80:83], s55 offen lds
    v_cvt_pk_bf16_f32 v224, v128, v129
    v_cvt_pk_bf16_f32 v225, v130, v131
    v_cvt_pk_bf16_f32 v226, v132, v133
    v_cvt_pk_bf16_f32 v227, v134, v135
    v_cvt_pk_bf16_f32 v228, v136, v137
    v_cvt_pk_bf16_f32 v229, v138, v139
    v_cvt_pk_bf16_f32 v230, v140, v141
    v_cvt_pk_bf16_f32 v231, v142, v143
    v_lshlrev_b32 v128, 16, v224
    v_and_b32 v129, 0xffff0000, v224
    v_lshlrev_b32 v130, 16, v225
    v_and_b32 v131, 0xffff0000, v225
    v_lshlrev_b32 v132, 16, v226
    v_and_b32 v133, 0xffff0000, v226
    v_lshlrev_b32 v134, 16, v227
    v_and_b32 v135, 0xffff0000, v227
    v_lshlrev_b32 v136, 16, v228
    v_and_b32 v137, 0xffff0000, v228
    s_add_u32 m0, s98, 72704
    s_add_u32 s55, s61, 344064
    buffer_load_dwordx4 v180, s[80:83], s55 offen lds
    v_lshlrev_b32 v138, 16, v229
    v_and_b32 v139, 0xffff0000, v229
    v_lshlrev_b32 v140, 16, v230
    v_and_b32 v141, 0xffff0000, v230
    v_lshlrev_b32_e64 v142, 16, v231
    v_and_b32 v143, 0xffff0000, v231
    v_pk_mul_f32 v[192:193], v[128:129], v[244:245] op_sel_hi:[1,0]
    v_pk_mul_f32 v[194:195], v[130:131], v[244:245] op_sel_hi:[1,0]
    v_pk_mul_f32 v[196:197], v[132:133], v[244:245] op_sel_hi:[1,0]
    v_pk_mul_f32 v[198:199], v[134:135], v[244:245] op_sel_hi:[1,0]
    v_pk_mul_f32 v[200:201], v[136:137], v[244:245] op_sel_hi:[1,0]
    v_pk_mul_f32 v[202:203], v[138:139], v[244:245] op_sel_hi:[1,0]
    v_pk_mul_f32 v[204:205], v[140:141], v[244:245] op_sel_hi:[1,0]
    v_pk_mul_f32 v[206:207], v[142:143], v[244:245] op_sel_hi:[1,0]
    v_exp_f32_e64 v192, v192 clamp
    v_max_f32 v128, s66, v128
    v_exp_f32_e64 v193, v193 clamp
    v_max_f32 v129, s66, v129
    s_lshl2_add_u32 s55, s2, s36
    s_mul_i32 s55, s55, 1536
    v_lshlrev_b32 v183, 3, v240
    s_mov_b64 exec, 0xfff
    buffer_load_dword a255, v183, s[84:87], s55 offen
    s_mov_b64 exec, -1
    s_lshl2_add_u32 s55, s2, s36
    s_mul_i32 s55, s55, 512
    v_lshlrev_b32 v183, 3, v240
    s_mov_b64 exec, 0xf
    buffer_load_dword a255, v183, s[92:95], s55 offen
    s_mov_b64 exec, -1
    s_xor_b32 s55, s62, 0
    buffer_load_dwordx4 a[128:131], v181, s[88:91], s55 offen
    v_exp_f32_e64 v194, v194 clamp
    v_max_f32 v130, s66, v130
    v_exp_f32_e64 v195, v195 clamp
    v_max_f32 v131, s66, v131
    v_exp_f32_e64 v196, v196 clamp
    v_max_f32 v132, s66, v132
    v_exp_f32_e64 v197, v197 clamp
    v_max_f32 v133, s66, v133
    v_exp_f32_e64 v198, v198 clamp
    v_max_f32 v134, s66, v134
    v_exp_f32_e64 v199, v199 clamp
    v_max_f32 v135, s66, v135
    v_exp_f32_e64 v200, v200 clamp
    v_max_f32 v136, s66, v136
    v_exp_f32_e64 v201, v201 clamp
    v_max_f32 v137, s66, v137
    v_exp_f32_e64 v202, v202 clamp
    v_max_f32_e64 v138, s66, v138
    s_xor_b32 s55, s62, 32768
    buffer_load_dwordx4 a[132:135], v181, s[88:91], s55 offen
    v_exp_f32_e64 v203, v203 clamp
    v_max_f32 v139, s66, v139
    v_exp_f32_e64 v204, v204 clamp
    v_max_f32 v140, s66, v140
    v_exp_f32_e64 v205, v205 clamp
    v_max_f32 v141, s66, v141
    v_exp_f32_e64 v206, v206 clamp
    v_max_f32 v142, s66, v142
    v_exp_f32_e64 v207, v207 clamp
    v_max_f32_e64 v143, s66, v143
    v_pk_add_f32 v[128:129], v[128:129], v[192:193]
    v_pk_add_f32 v[130:131], v[130:131], v[194:195]
    v_pk_add_f32 v[132:133], v[132:133], v[196:197]
    v_pk_add_f32 v[134:135], v[134:135], v[198:199]
    v_cvt_pk_bf16_f32 v224, v128, v129
    v_cvt_pk_bf16_f32 v225, v130, v131
    v_cvt_pk_bf16_f32 v226, v132, v133
    v_cvt_pk_bf16_f32 v227, v134, v135
    ds_write_b128 v242, v[224:227] offset:0
    v_pk_add_f32 v[136:137], v[136:137], v[200:201]
    v_pk_add_f32 v[138:139], v[138:139], v[202:203]
    v_pk_add_f32 v[140:141], v[140:141], v[204:205]
    v_pk_add_f32 v[142:143], v[142:143], v[206:207]
    v_cvt_pk_bf16_f32 v228, v136, v137
    v_cvt_pk_bf16_f32 v229, v138, v139
    v_cvt_pk_bf16_f32 v230, v140, v141
    v_cvt_pk_bf16_f32 v231, v142, v143
    ds_write_b128 v242, v[228:231] offset:128
    v_cvt_pk_bf16_f32 v144, v144, v145
    v_cvt_pk_bf16_f32 v145, v146, v147
    v_cvt_pk_bf16_f32 v146, v148, v149
    v_cvt_pk_bf16_f32 v147, v150, v151
    ds_write_b128 v242, v[144:147] offset:16384
    v_cvt_pk_bf16_f32 v148, v152, v153
    v_cvt_pk_bf16_f32 v149, v154, v155
    v_cvt_pk_bf16_f32 v150, v156, v157
    v_cvt_pk_bf16_f32 v151, v158, v159
    ds_write_b128 v242, v[148:151] offset:16512
    v_mov_b32 v128, 0x3f803f80
    v_mov_b32 v129, 0x3f803f80
    v_mov_b32 v130, 0x3f803f80
    v_mov_b32 v131, 0x3f803f80
    s_waitcnt vmcnt(13) lgkmcnt(0)
    s_barrier
    s_cmp_lt_u32 s36, 2
    s_cbranch_scc0 L_stub_7
    ds_read_b64_tr_b16 v[192:193], v184 offset:0
    ds_read_b64_tr_b16 v[194:195], v184 offset:512
    ds_read_b64_tr_b16 v[224:225], v185 offset:0
L_pad0:
    s_cbranch_execz L_warmed0
    ds_read_b64_tr_b16 v[226:227], v185 offset:512
    ds_read_b64_tr_b16 v[196:197], v184 offset:1024
    ds_read_b64_tr_b16 v[198:199], v184 offset:1536
    ds_read_b64_tr_b16 v[228:229], v185 offset:1024
    ds_read_b64_tr_b16 v[230:231], v185 offset:1536
    s_waitcnt lgkmcnt(4)
    v_mfma_f32_16x16x32_bf16 v[152:155], v[192:195], v[224:227], 0
    ds_read_b64_tr_b16 v[200:201], v184 offset:2048
    ds_read_b64_tr_b16 v[202:203], v184 offset:2560
    v_mfma_f32_16x16x32_bf16 v[156:159], v[192:195], v[128:131], 0
    ds_read_b64_tr_b16 v[232:233], v185 offset:2048
    ds_read_b64_tr_b16 v[234:235], v185 offset:2560
    s_waitcnt lgkmcnt(4)
    v_mfma_f32_16x16x32_bf16 v[152:155], v[196:199], v[228:231], v[152:155]
    ds_read_b64_tr_b16 v[204:205], v184 offset:3072
    ds_read_b64_tr_b16 v[206:207], v184 offset:3584
    v_mfma_f32_16x16x32_bf16 v[156:159], v[196:199], v[128:131], v[156:159]
    ds_read_b64_tr_b16 v[236:237], v185 offset:3072
    ds_read_b64_tr_b16 v[238:239], v185 offset:3584
    s_waitcnt lgkmcnt(4)
    v_mfma_f32_16x16x32_bf16 v[152:155], v[200:203], v[232:235], v[152:155]
    v_mfma_f32_16x16x32_bf16 v[156:159], v[200:203], v[128:131], v[156:159]
    s_waitcnt lgkmcnt(0)
    v_mfma_f32_16x16x32_bf16 v[152:155], v[204:207], v[236:239], v[152:155]
    v_mfma_f32_16x16x32_bf16 v[156:159], v[204:207], v[128:131], v[156:159]
    s_nop 6
    v_cvt_pk_bf16_f32 v148, v152, v153
    v_cvt_pk_bf16_f32 v149, v154, v155
    v_cvt_pk_bf16_f32 v150, v152, v153
    v_cvt_pk_bf16_f32 v151, v154, v155
    v_min_u32 v156, -2, v156
    v_permlane16_swap_b32 v148, v150
    v_permlane16_swap_b32 v149, v151
    v_min_u32 v148, -2, v148
    s_mov_b64 exec, s[96:97]
    buffer_store_dwordx4 v[148:151], v186, s[24:27], s49 offen sc1
    s_mov_b64 exec, s[10:11]
    buffer_store_dwordx4 v[156:159], v187, s[24:27], s49 offen sc1
L_back_8:
    s_mov_b64 exec, -1
    v_lshlrev_b32 v182, 5, v250
    s_or_b32 s1, s50, 0xf0
    v_mov_b32_e64 v153, s1
    s_cmp_lt_u32 s36, 2
    s_cbranch_scc0 L_skip_9
    s_mov_b64 exec, 0xffff
    buffer_load_dword v153, v182, s[24:27], s63 offen sc1
    s_mov_b64 exec, -1
L_skip_9:
    s_sub_u32 s55, 0x180, s84
    s_and_b32 s55, s55, 0x380
    s_mul_i32 s56, s0, 12288
    s_add_u32 s55, s55, s56
    v_lshlrev_b32_e64 v154, 6, v240
    s_mov_b64 exec, 0xfff
    buffer_load_dword v154, v154, s[84:87], s55 offen
    s_mov_b64 exec, -1
    s_cmp_ge_u32 s36, 2
    s_cbranch_scc0 L_skip_10
    s_waitcnt vmcnt(5)
L_skip_10:
    s_waitcnt vmcnt(8)
    s_barrier
    v_add_u32 v147, 0x10000, v241
    ds_read_b64_tr_b16 v[160:161], v147 offset:0
    ds_read_b64_tr_b16 v[162:163], v147 offset:256
    ds_read_b64_tr_b16 v[164:165], v147 offset:1024
    ds_read_b64_tr_b16 v[166:167], v147 offset:1280
    ds_read_b64_tr_b16 v[168:169], v147 offset:2048
    ds_read_b64_tr_b16 v[170:171], v147 offset:2304
    ds_read_b64_tr_b16 v[172:173], v147 offset:3072
    ds_read_b64_tr_b16 v[174:175], v147 offset:3328
    ds_read_b64_tr_b16 v[176:177], v147 offset:4096
    ds_read_b64_tr_b16 v[178:179], v147 offset:4352
    v_and_b32 v224, 0x1f0, v240
    v_add_u32 v224, 0x27a60, v224
    ds_read_b128 v[224:227], v224
    s_add_u32 s57, s98, 65536
    v_add_u32_e64 v194, s57, v240
    ds_read_b128 v[232:235], v194 offset:0
    ds_read_b128 v[236:239], v194 offset:1024
    s_waitcnt lgkmcnt(11)
    v_mfma_f32_32x32x16_bf16 v[128:143], v[160:163], v[0:3], 0
    s_mov_b32 s32, s4
    s_mov_b32 s33, s5
    s_mov_b32 s34, 2097152
    s_add_u32 s55, s67, 8192
    buffer_load_dwordx4 v[208:211], v181, s[32:35], s67 offen
    buffer_load_dwordx4 v[212:215], v181, s[32:35], s55 offen
    s_xor_b32 s55, s62, 65536
    buffer_load_dwordx4 a[136:139], v181, s[88:91], s55 offen
    ds_read_b64_tr_b16 v[160:161], v147 offset:5120
    ds_read_b64_tr_b16 v[162:163], v147 offset:5376
    s_waitcnt lgkmcnt(3)
    v_mfma_f32_16x16x32_bf16 v[228:231], v[224:227], v[232:235], 0
    ds_read_b128 v[232:235], v194 offset:2048
    s_lshl_b32 s57, s36, 2
    s_add_u32 s57, s57, 160352
    v_mfma_f32_32x32x16_bf16 v[128:143], v[164:167], v[4:7], v[128:143]
    s_xor_b32 s55, s62, 98304
    buffer_load_dwordx4 a[140:143], v181, s[88:91], s55 offen
    ds_read_b64_tr_b16 v[164:165], v147 offset:6144
    ds_read_b64_tr_b16 v[166:167], v147 offset:6400
    s_waitcnt lgkmcnt(5)
    v_mfma_f32_16x16x32_bf16 v[228:231], v[224:227], v[236:239], v[228:231]
    ds_read_b128 v[236:239], v194 offset:3072
    v_lshrrev_b32 v192, 9, v240
    v_lshl_add_u32 v192, v192, 5, s57
    v_mfma_f32_32x32x16_bf16 v[128:143], v[168:171], v[8:11], v[128:143]
    ds_read_b64_tr_b16 v[168:169], v147 offset:7168
    ds_read_b64_tr_b16 v[170:171], v147 offset:7424
    s_waitcnt lgkmcnt(5)
    v_mfma_f32_16x16x32_bf16 v[228:231], v[224:227], v[232:235], v[228:231]
    ds_read_b128 v[232:235], v194 offset:4096
    v_bfe_u32 v193, v240, 4, 1
    v_lshl_add_u32 v192, v193, 8, v192
    v_mfma_f32_32x32x16_bf16 v[128:143], v[172:175], v[12:15], v[128:143]
    s_xor_b32 s55, s62, 131072
    buffer_load_dwordx4 a[144:147], v181, s[88:91], s55 offen
    ds_read_b64_tr_b16 v[172:173], v147 offset:8192
    ds_read_b64_tr_b16 v[174:175], v147 offset:8448
    s_waitcnt lgkmcnt(5)
    v_mfma_f32_16x16x32_bf16 v[228:231], v[224:227], v[236:239], v[228:231]
    ds_read_b128 v[236:239], v194 offset:5120
    v_bfe_u32 v193, v240, 8, 1
    v_lshl_add_u32 v192, v193, 7, v192
    v_mfma_f32_32x32x16_bf16 v[128:143], v[176:179], v[16:19], v[128:143]
    ds_read_b64_tr_b16 v[176:177], v147 offset:9216
    ds_read_b64_tr_b16 v[178:179], v147 offset:9472
    s_waitcnt lgkmcnt(5)
    v_mfma_f32_16x16x32_bf16 v[228:231], v[224:227], v[232:235], v[228:231]
    ds_read_b128 v[232:235], v194 offset:6144
    v_bfe_u32 v193, v240, 5, 1
    v_lshl_add_u32 v192, v193, 6, v192
    v_mfma_f32_32x32x16_bf16 v[128:143], v[160:163], v[20:23], v[128:143]
    s_xor_b32 s55, s62, 163840
    buffer_load_dwordx4 a[148:151], v181, s[88:91], s55 offen
    ds_read_b64_tr_b16 v[160:161], v147 offset:10240
    ds_read_b64_tr_b16 v[162:163], v147 offset:10496
    s_waitcnt lgkmcnt(5)
    v_mfma_f32_16x16x32_bf16 v[228:231], v[224:227], v[236:239], v[228:231]
    ds_read_b128 v[236:239], v194 offset:7168
    v_mfma_f32_32x32x16_bf16 v[128:143], v[164:167], v[24:27], v[128:143]
    ds_read_b64_tr_b16 v[164:165], v147 offset:11264
    ds_read_b64_tr_b16 v[166:167], v147 offset:11520
    s_waitcnt lgkmcnt(5)
    v_mfma_f32_16x16x32_bf16 v[228:231], v[224:227], v[232:235], v[228:231]
    v_mfma_f32_32x32x16_bf16 v[128:143], v[168:171], v[28:31], v[128:143]
    s_xor_b32 s55, s62, 196608
    buffer_load_dwordx4 a[152:155], v181, s[88:91], s55 offen
    ds_read_b64_tr_b16 v[168:169], v147 offset:12288
    ds_read_b64_tr_b16 v[170:171], v147 offset:12544
    s_waitcnt lgkmcnt(4)
    v_mfma_f32_16x16x32_bf16 v[228:231], v[224:227], v[236:239], v[228:231]
    v_mfma_f32_32x32x16_bf16 v[128:143], v[172:175], v[32:35], v[128:143]
    ds_read_b64_tr_b16 v[172:173], v147 offset:13312
    ds_read_b64_tr_b16 v[174:175], v147 offset:13568
    v_mov_b32 v204, -1
    v_mov_b32 v205, -1
    v_mov_b32 v206, -1
    v_mov_b32 v207, -1
    v_mfma_f32_32x32x16_bf16 v[128:143], v[176:179], v[36:39], v[128:143]
    s_xor_b32 s55, s62, 229376
    buffer_load_dwordx4 a[156:159], v181, s[88:91], s55 offen
    ds_read_b64_tr_b16 v[176:177], v147 offset:14336
    ds_read_b64_tr_b16 v[178:179], v147 offset:14592
    s_cmp_lt_u32 s36, 2
    s_cbranch_scc0 L_skip_11
    s_add_u32 s57, s49, 1179648
    s_mov_b64 exec, s[96:97]
    buffer_store_dwordx4 v[204:207], v186, s[24:27], s57 offen sc1
    s_mov_b64 exec, s[10:11]
    buffer_store_dwordx4 v[204:207], v187, s[24:27], s57 offen sc1
    s_mov_b64 exec, -1
L_skip_11:
    v_mfma_f32_32x32x16_bf16 v[128:143], v[160:163], v[40:43], v[128:143]
    ds_read_b64_tr_b16 v[160:161], v147 offset:15360
    ds_read_b64_tr_b16 v[162:163], v147 offset:15616
    v_permlane32_swap_b32 v228, v230
    s_waitcnt lgkmcnt(8)
    v_mfma_f32_32x32x16_bf16 v[128:143], v[164:167], v[44:47], v[128:143]
    s_xor_b32 s55, s62, 262144
    buffer_load_dwordx4 a[160:163], v181, s[88:91], s55 offen
    ds_read_b64_tr_b16 v[164:165], v147 offset:16384
    ds_read_b64_tr_b16 v[166:167], v147 offset:16640
    v_permlane32_swap_b32 v229, v231
    s_waitcnt lgkmcnt(8)
    v_mfma_f32_32x32x16_bf16 v[128:143], v[168:171], v[48:51], v[128:143]
    ds_read_b64_tr_b16 v[168:169], v147 offset:17408
    ds_read_b64_tr_b16 v[170:171], v147 offset:17664
    v_add_f32 v228, v228, v230
    v_add_f32 v229, v229, v231
    s_waitcnt lgkmcnt(8)
    v_mfma_f32_32x32x16_bf16 v[128:143], v[172:175], v[52:55], v[128:143]
    s_xor_b32 s55, s62, 294912
    buffer_load_dwordx4 a[164:167], v181, s[88:91], s55 offen
    ds_read_b64_tr_b16 v[172:173], v147 offset:18432
    ds_read_b64_tr_b16 v[174:175], v147 offset:18688
    v_add_f32 v228, v228, v228 row_ror:4
    v_add_f32 v229, v229, v229 row_ror:4
    s_waitcnt lgkmcnt(8)
    v_mfma_f32_32x32x16_bf16 v[128:143], v[176:179], v[56:59], v[128:143]
    s_xor_b32 s55, s62, 327680
    buffer_load_dwordx4 a[168:171], v181, s[88:91], s55 offen
    ds_read_b64_tr_b16 v[176:177], v147 offset:19456
    ds_read_b64_tr_b16 v[178:179], v147 offset:19712
    v_add_f32 v228, v228, v228 row_ror:8
    v_add_f32 v229, v229, v229 row_ror:8
    s_waitcnt lgkmcnt(8)
    v_mfma_f32_32x32x16_bf16 v[128:143], v[160:163], v[60:63], v[128:143]
    ds_read_b64_tr_b16 v[160:161], v147 offset:20480
    ds_read_b64_tr_b16 v[162:163], v147 offset:20736
    ds_write2_b32 v192, v228, v229 offset0:0 offset1:4
    s_waitcnt lgkmcnt(9)
    v_mfma_f32_32x32x16_bf16 v[128:143], v[164:167], v[64:67], v[128:143]
    s_xor_b32 s55, s62, 360448
    buffer_load_dwordx4 a[172:175], v181, s[88:91], s55 offen
    ds_read_b64_tr_b16 v[164:165], v147 offset:21504
    ds_read_b64_tr_b16 v[166:167], v147 offset:21760
    s_waitcnt lgkmcnt(9)
    v_mfma_f32_32x32x16_bf16 v[128:143], v[168:171], v[68:71], v[128:143]
    ds_read_b64_tr_b16 v[168:169], v147 offset:22528
    ds_read_b64_tr_b16 v[170:171], v147 offset:22784
    s_waitcnt lgkmcnt(9)
    v_mfma_f32_32x32x16_bf16 v[128:143], v[172:175], v[72:75], v[128:143]
    s_xor_b32 s55, s62, 393216
    buffer_load_dwordx4 a[176:179], v181, s[88:91], s55 offen
    ds_read_b64_tr_b16 v[172:173], v147 offset:23552
    ds_read_b64_tr_b16 v[174:175], v147 offset:23808
    s_waitcnt lgkmcnt(9)
    v_mfma_f32_32x32x16_bf16 v[128:143], v[176:179], v[76:79], v[128:143]
    ds_read_b64_tr_b16 v[176:177], v147 offset:24576
    ds_read_b64_tr_b16 v[178:179], v147 offset:24832
    s_waitcnt lgkmcnt(9)
    v_mfma_f32_32x32x16_bf16 v[128:143], v[160:163], v[80:83], v[128:143]
    s_xor_b32 s55, s62, 425984
    buffer_load_dwordx4 a[180:183], v181, s[88:91], s55 offen
    ds_read_b64_tr_b16 v[160:161], v147 offset:25600
    ds_read_b64_tr_b16 v[162:163], v147 offset:25856
    s_waitcnt lgkmcnt(8)
    v_mfma_f32_32x32x16_bf16 v[128:143], v[164:167], v[84:87], v[128:143]
    ds_read_b64_tr_b16 v[164:165], v147 offset:26624
    ds_read_b64_tr_b16 v[166:167], v147 offset:26880
    s_waitcnt lgkmcnt(8)
    v_mfma_f32_32x32x16_bf16 v[128:143], v[168:171], v[88:91], v[128:143]
    s_xor_b32 s55, s62, 458752
    buffer_load_dwordx4 a[184:187], v181, s[88:91], s55 offen
    ds_read_b64_tr_b16 v[168:169], v147 offset:27648
    ds_read_b64_tr_b16 v[170:171], v147 offset:27904
    s_waitcnt lgkmcnt(8)
    v_mfma_f32_32x32x16_bf16 v[128:143], v[172:175], v[92:95], v[128:143]
    ds_read_b64_tr_b16 v[172:173], v147 offset:28672
    ds_read_b64_tr_b16 v[174:175], v147 offset:28928
    s_waitcnt lgkmcnt(8)
    v_mfma_f32_32x32x16_bf16 v[128:143], v[176:179], v[96:99], v[128:143]
    s_xor_b32 s55, s62, 491520
    buffer_load_dwordx4 a[188:191], v181, s[88:91], s55 offen
    ds_read_b64_tr_b16 v[176:177], v147 offset:29696
    ds_read_b64_tr_b16 v[178:179], v147 offset:29952
    s_waitcnt lgkmcnt(8)
    v_mfma_f32_32x32x16_bf16 v[128:143], v[160:163], v[100:103], v[128:143]
    s_waitcnt vmcnt(16)
    v_cmp_ne_u32_e64 vcc, s1, v153
    s_nop 0
    s_cbranch_vccnz L_hello
L_hello_ok:
    ds_read_b64_tr_b16 v[160:161], v147 offset:30720
    ds_read_b64_tr_b16 v[162:163], v147 offset:30976
    s_waitcnt lgkmcnt(8)
    v_mfma_f32_32x32x16_bf16 v[128:143], v[164:167], v[104:107], v[128:143]
    s_cmp_lt_u32 s36, 2
    s_cbranch_scc0 L_skip_13
    s_add_u32 s56, s49, 524288
    buffer_load_dwordx4 v[32:35], v240, s[24:27], s56 offen sc1
    s_add_u32 s56, s49, 0
    buffer_load_dwordx4 v[0:3], v240, s[24:27], s56 offen sc1
    s_add_u32 s56, s49, 65536
    buffer_load_dwordx4 v[4:7], v240, s[24:27], s56 offen sc1
L_skip_13:
    ds_read_b64_tr_b16 v[164:165], v147 offset:31744
    ds_read_b64_tr_b16 v[166:167], v147 offset:32000
    s_waitcnt lgkmcnt(8)
    v_mfma_f32_32x32x16_bf16 v[128:143], v[168:171], v[108:111], v[128:143]
    v_and_b32 v36, 0x1f0, v240
    v_add_u32 v36, 0x27a60, v36
    ds_read_b128 v[36:39], v36
    s_waitcnt lgkmcnt(7)
    v_mfma_f32_32x32x16_bf16 v[128:143], v[172:175], v[112:115], v[128:143]
    s_waitcnt lgkmcnt(5)
    v_mfma_f32_32x32x16_bf16 v[128:143], v[176:179], v[116:119], v[128:143]
    s_cmp_lt_u32 s36, 2
    s_cbranch_scc0 L_skip_14
    s_add_u32 s56, s49, 131072
    buffer_load_dwordx4 v[8:11], v240, s[24:27], s56 offen sc1
    s_add_u32 s56, s49, 196608
    buffer_load_dwordx4 v[12:15], v240, s[24:27], s56 offen sc1
    s_add_u32 s56, s49, 262144
    buffer_load_dwordx4 v[16:19], v240, s[24:27], s56 offen sc1
L_skip_14:
    s_waitcnt lgkmcnt(3)
    v_mfma_f32_32x32x16_bf16 v[128:143], v[160:163], v[120:123], v[128:143]
    s_waitcnt lgkmcnt(1)
    v_mfma_f32_32x32x16_bf16 v[128:143], v[164:167], v[124:127], v[128:143]
    s_cmp_lt_u32 s36, 2
    s_cbranch_scc0 L_skip_15
    s_add_u32 s56, s49, 327680
    buffer_load_dwordx4 v[20:23], v240, s[24:27], s56 offen sc1
    s_add_u32 s56, s49, 393216
    buffer_load_dwordx4 v[24:27], v240, s[24:27], s56 offen sc1
    s_add_u32 s56, s49, 458752
    buffer_load_dwordx4 v[28:31], v240, s[24:27], s56 offen sc1
L_skip_15:
    s_waitcnt vmcnt(17)
    s_cmp_ge_u32 s36, 2
    s_cbranch_scc0 L_skip_16
    s_waitcnt vmcnt(8)
L_skip_16:
    ds_write_b128 v252, a[128:131] offset:0
    ds_write_b128 v252, a[132:135] offset:1024
    s_add_u32 s55, s60, 0
    buffer_load_dwordx4 a[64:67], v180, s[84:87], s55 offen
    s_nop 1
    s_nop 0
    v_cvt_pk_bf16_f32 v224, v128, v129
    v_cvt_pk_bf16_f32 v225, v130, v131
    v_cvt_pk_bf16_f32 v226, v132, v133
    v_cvt_pk_bf16_f32 v227, v134, v135
    v_cvt_pk_bf16_f32 v228, v136, v137
    v_cvt_pk_bf16_f32 v229, v138, v139
    v_cvt_pk_bf16_f32 v230, v140, v141
    s_add_u32 s55, s60, 98304
    buffer_load_dwordx4 a[68:71], v180, s[84:87], s55 offen
    v_cvt_pk_bf16_f32 v231, v142, v143
    ds_write_b128 v252, a[136:139] offset:2048
    v_lshlrev_b32 v128, 16, v224
    v_and_b32 v129, 0xffff0000, v224
    v_lshlrev_b32 v130, 16, v225
    v_and_b32 v131, 0xffff0000, v225
    v_lshlrev_b32_e64 v132, 16, v226
    v_and_b32 v133, 0xffff0000, v226
    s_add_u32 s55, s60, 196608
    buffer_load_dwordx4 a[72:75], v180, s[84:87], s55 offen
    v_lshlrev_b32_e64 v134, 16, v227
    v_and_b32 v135, 0xffff0000, v227
    ds_write_b128 v252, a[140:143] offset:3072
    v_lshlrev_b32 v136, 16, v228
    v_and_b32 v137, 0xffff0000, v228
    v_lshlrev_b32 v138, 16, v229
    v_and_b32 v139, 0xffff0000, v229
    v_lshlrev_b32_e64 v140, 16, v230
    s_add_u32 s55, s60, 294912
    buffer_load_dwordx4 a[76:79], v180, s[84:87], s55 offen
    v_and_b32 v141, 0xffff0000, v230
    v_lshlrev_b32_e64 v142, 16, v231
    v_and_b32 v143, 0xffff0000, v231
    ds_write_b128 v252, a[144:147] offset:4096
    v_pk_mul_f32 v[192:193], v[128:129], v[244:245] op_sel_hi:[1,0]
    v_pk_mul_f32 v[194:195], v[130:131], v[244:245] op_sel_hi:[1,0]
    v_pk_mul_f32 v[196:197], v[132:133], v[244:245] op_sel_hi:[1,0]
    v_pk_mul_f32 v[198:199], v[134:135], v[244:245] op_sel_hi:[1,0]
    s_add_u32 s55, s60, 393216
    buffer_load_dwordx4 a[80:83], v180, s[84:87], s55 offen
    v_pk_mul_f32 v[200:201], v[136:137], v[244:245] op_sel_hi:[1,0]
    v_pk_mul_f32 v[202:203], v[138:139], v[244:245] op_sel_hi:[1,0]
    v_pk_mul_f32 v[204:205], v[140:141], v[244:245] op_sel_hi:[1,0]
    v_pk_mul_f32 v[206:207], v[142:143], v[244:245] op_sel_hi:[1,0]
    ds_write_b128 v252, a[148:151] offset:5120
    v_exp_f32_e64 v192, v192 clamp
    v_max_f32_e64 v128, s66, v128
    v_exp_f32_e64 v193, v193 clamp
    s_add_u32 s55, s60, 491520
    buffer_load_dwordx4 a[84:87], v180, s[84:87], s55 offen
    v_max_f32 v129, s66, v129
    v_exp_f32_e64 v194, v194 clamp
    v_max_f32 v130, s66, v130
    v_exp_f32_e64 v195, v195 clamp
    v_max_f32_e64 v131, s66, v131
    ds_write_b128 v252, a[152:155] offset:6144
    v_exp_f32_e64 v196, v196 clamp
    v_max_f32_e64 v132, s66, v132
    s_add_u32 s55, s60, 589824
    buffer_load_dwordx4 a[88:91], v180, s[84:87], s55 offen
    v_exp_f32_e64 v197, v197 clamp
    v_max_f32 v133, s66, v133
    v_exp_f32_e64 v198, v198 clamp
    v_max_f32 v134, s66, v134
    v_exp_f32_e64 v199, v199 clamp
    v_max_f32_e64 v135, s66, v135
    ds_write_b128 v252, a[156:159] offset:7168
    v_exp_f32_e64 v200, v200 clamp
    s_add_u32 s55, s60, 688128
    buffer_load_dwordx4 a[92:95], v180, s[84:87], s55 offen
    v_max_f32 v136, s66, v136
    v_exp_f32_e64 v201, v201 clamp
    v_max_f32 v137, s66, v137
    v_exp_f32_e64 v202, v202 clamp
    v_max_f32 v138, s66, v138
    v_exp_f32_e64 v203, v203 clamp
    v_max_f32 v139, s66, v139
    v_exp_f32_e64 v204, v204 clamp
    v_max_f32 v140, s66, v140
    v_exp_f32_e64 v205, v205 clamp
    v_max_f32 v141, s66, v141
    v_exp_f32_e64 v206, v206 clamp
    v_max_f32 v142, s66, v142
    v_exp_f32_e64 v207, v207 clamp
    v_max_f32 v143, s66, v143
    v_pk_add_f32 v[128:129], v[128:129], v[192:193]
    v_pk_add_f32 v[130:131], v[130:131], v[194:195]
    v_pk_add_f32 v[132:133], v[132:133], v[196:197]
    v_pk_add_f32 v[134:135], v[134:135], v[198:199]
    v_cvt_pk_bf16_f32 v224, v128, v129
    v_cvt_pk_bf16_f32 v225, v130, v131
    v_cvt_pk_bf16_f32 v226, v132, v133
    v_cvt_pk_bf16_f32 v227, v134, v135
    v_pk_add_f32 v[136:137], v[136:137], v[200:201]
    v_pk_add_f32 v[138:139], v[138:139], v[202:203]
    v_pk_add_f32 v[140:141], v[140:141], v[204:205]
    v_pk_add_f32 v[142:143], v[142:143], v[206:207]
    v_cvt_pk_bf16_f32 v228, v136, v137
    v_cvt_pk_bf16_f32 v229, v138, v139
    v_cvt_pk_bf16_f32 v230, v140, v141
    v_cvt_pk_bf16_f32 v231, v142, v143
    v_mov_b32 v166, 0x0
    s_mov_b32 s66, 0x35c1a2a0
    v_lshrrev_b32 v192, 9, v240
    v_mul_u32_u24 v192, 1536, v192
    v_add_u32 v241, v241, v192
    v_xor_b32 v176, 32, v251
    v_xor_b32 v177, 64, v251
    v_xor_b32 v178, 96, v251
    s_add_u32 s1, s50, 16
    v_mov_b32_e64 v179, s1
    s_waitcnt lgkmcnt(8)
    s_cmp_lt_u32 s36, 2
    s_cbranch_scc0 L_stub_17
L_chk0:
    s_waitcnt vmcnt(14)
    v_mfma_f32_16x16x32_bf16 v[40:43], v[36:39], v[0:3], 0
    v_max3_u32 v44, v32, v0, v4
    v_permlane16_swap_b32 v32, v33
    v_mfma_f32_16x16x32_bf16 v[40:43], v[36:39], v[4:7], v[40:43]
    v_permlane16_swap_b32 v34, v35
    s_waitcnt vmcnt(12)
    v_mfma_f32_16x16x32_bf16 v[40:43], v[36:39], v[8:11], v[40:43]
    v_add_f32 v32, v32, v33
    v_add_f32_e64 v34, v34, v35
    v_mfma_f32_16x16x32_bf16 v[40:43], v[36:39], v[12:15], v[40:43]
    v_max3_u32 v44, v44, v8, v12
    v_permlane32_swap_b32 v32, v34
    s_waitcnt vmcnt(10)
    v_mfma_f32_16x16x32_bf16 v[40:43], v[36:39], v[16:19], v[40:43]
    v_add_f32_e64 v32, v32, v34
    v_max3_u32 v44, v44, v16, v20
    v_mfma_f32_16x16x32_bf16 v[40:43], v[36:39], v[20:23], v[40:43]
    v_add_f32 v32, v32, v32 row_ror:4
    s_waitcnt vmcnt(8)
    v_mfma_f32_16x16x32_bf16 v[40:43], v[36:39], v[24:27], v[40:43]
    v_add_f32 v32, v32, v32 row_ror:8
    v_max3_u32 v44, v44, v24, v28
    v_mfma_f32_16x16x32_bf16 v[40:43], v[36:39], v[28:31], v[40:43]
    v_cmp_eq_u32 vcc, -1, v44
    v_cvt_pk_bf16_f32 v32, v32, v32
    ds_write_b16 v189, v32
    s_cbranch_vccnz L_again0
    s_nop 3
    v_cvt_pk_bf16_f32 v40, v40, v41
    v_cvt_pk_bf16_f32 v41, v42, v43
    ds_write_b64 v188, v[40:41]
L_back_18:
    s_mov_b64 exec, -1
    s_waitcnt vmcnt(8)
    s_waitcnt lgkmcnt(0)
    s_barrier
    ds_read_b128 v[0:3], v243 offset:0
    ds_read_b128 v[4:7], v243 offset:592
    ds_read_b128 v[16:19], v190 offset:0
    s_waitcnt lgkmcnt(2)
    v_mfma_f32_32x32x16_bf16 v[144:159], v[0:3], v[224:227], 0
    ds_read_b128 v[20:23], v190 offset:16
    s_waitcnt lgkmcnt(2)
    v_mfma_f32_32x32x16_bf16 v[144:159], v[4:7], v[228:231], v[144:159]
    s_waitcnt lgkmcnt(0)
    v_dot2c_f32_bf16 v166, v16, v224
    v_dot2c_f32_bf16 v166, v17, v225
    v_dot2c_f32_bf16 v166, v18, v226
    v_dot2c_f32_bf16 v166, v19, v227
    v_dot2c_f32_bf16 v166, v20, v228
    v_dot2c_f32_bf16 v166, v21, v229
    v_dot2c_f32_bf16 v166, v22, v230
    v_dot2c_f32_bf16 v166, v23, v231
    s_nop 2
    v_cvt_pk_bf16_f32 v192, v144, v145
    v_cvt_pk_bf16_f32 v193, v146, v147
    v_cvt_pk_bf16_f32 v194, v148, v149
    v_cvt_pk_bf16_f32 v195, v150, v151
    v_cvt_pk_bf16_f32 v196, v152, v153
    v_cvt_pk_bf16_f32 v197, v154, v155
    v_cvt_pk_bf16_f32 v198, v156, v157
    v_cvt_pk_bf16_f32 v199, v158, v159
    v_cvt_pk_bf16_f32 v166, v166, v166
    v_and_b32 v166, 0xffff0000, v166
    v_add_f32 v166, 0x358637bd, v166
    v_cvt_pk_bf16_f32 v166, v166, v166
    v_and_b32 v166, 0xffff0000, v166
    v_rcp_f32 v166, v166
    v_lshlrev_b32 v144, 16, v192
    v_and_b32 v145, 0xffff0000, v192
    v_lshlrev_b32 v146, 16, v193
    v_and_b32 v147, 0xffff0000, v193
    v_lshlrev_b32 v148, 16, v194
    v_and_b32 v149, 0xffff0000, v194
    v_lshlrev_b32 v150, 16, v195
    v_and_b32 v151, 0xffff0000, v195
    v_lshlrev_b32 v152, 16, v196
    v_and_b32 v153, 0xffff0000, v196
    v_lshlrev_b32 v154, 16, v197
    v_and_b32 v155, 0xffff0000, v197
    v_lshlrev_b32 v156, 16, v198
    v_and_b32 v157, 0xffff0000, v198
    v_lshlrev_b32_e64 v158, 16, v199
    v_and_b32 v159, 0xffff0000, v199
    v_pk_mul_f32 v[144:145], v[144:145], v[166:167] op_sel_hi:[1,0]
    v_pk_mul_f32 v[146:147], v[146:147], v[166:167] op_sel_hi:[1,0]
    v_pk_mul_f32 v[148:149], v[148:149], v[166:167] op_sel_hi:[1,0]
    v_pk_mul_f32 v[150:151], v[150:151], v[166:167] op_sel_hi:[1,0]
    v_cvt_pk_bf16_f32 v192, v144, v145
    v_cvt_pk_bf16_f32 v193, v146, v147
    v_cvt_pk_bf16_f32 v194, v148, v149
    v_cvt_pk_bf16_f32 v195, v150, v151
    buffer_store_dwordx4 v[192:195], v191, s[24:27], s42 offen offset:0 sc1
    v_pk_mul_f32 v[152:153], v[152:153], v[166:167] op_sel_hi:[1,0]
    v_pk_mul_f32 v[154:155], v[154:155], v[166:167] op_sel_hi:[1,0]
    v_pk_mul_f32 v[156:157], v[156:157], v[166:167] op_sel_hi:[1,0]
    v_pk_mul_f32 v[158:159], v[158:159], v[166:167] op_sel_hi:[1,0]
    v_cvt_pk_bf16_f32 v196, v152, v153
    v_cvt_pk_bf16_f32 v197, v154, v155
    v_cvt_pk_bf16_f32 v198, v156, v157
    v_cvt_pk_bf16_f32 v199, v158, v159
    buffer_store_dwordx4 v[196:199], v191, s[24:27], s42 offen offset:256 sc1
    s_mul_i32 s55, s36, 2304
    s_add_u32 s55, s55, 131072
    v_bfe_u32 v227, v240, 4, 4
    v_mul_u32_u24 v224, 144, v227
    v_lshrrev_b32 v227, 8, v240
    v_lshl_add_u32 v224, v227, 3, v224
    v_add_u32 v224, s55, v224
    v_lshrrev_b32 v227, 7, v240
    v_lshl_add_u32 v225, v227, 4, v240
    v_add_u32_e64 v225, s55, v225
    s_waitcnt vmcnt(24)
    ds_write_b128 v225, v[208:211] offset:0
    ds_write_b128 v225, v[212:215] offset:1152
    ds_read2_b64 v[0:3], v224 offset0:0 offset1:4
    ds_read2_b64 v[4:7], v224 offset0:8 offset1:12
    s_waitcnt lgkmcnt(0)
    v_lshlrev_b32 v208, 16, v0
    v_and_b32 v209, 0xffff0000, v0
    v_lshlrev_b32 v210, 16, v1
    v_and_b32 v211, 0xffff0000, v1
    v_lshlrev_b32 v212, 16, v2
    v_and_b32 v213, 0xffff0000, v2
    v_lshlrev_b32 v214, 16, v3
    v_and_b32 v215, 0xffff0000, v3
    v_lshlrev_b32 v216, 16, v4
    v_and_b32 v217, 0xffff0000, v4
    v_lshlrev_b32 v218, 16, v5
    v_and_b32 v219, 0xffff0000, v5
    v_lshlrev_b32 v220, 16, v6
    v_and_b32 v221, 0xffff0000, v6
    v_lshlrev_b32_e64 v222, 16, v7
    v_and_b32 v223, 0xffff0000, v7
    ds_read_b64_tr_b16 v[64:65], v251 offset:0
    ds_read_b64_tr_b16 v[66:67], v251 offset:512
    ds_read_b64_tr_b16 v[68:69], v176 offset:16384
    ds_read_b64_tr_b16 v[70:71], v176 offset:16896
    ds_read_b64_tr_b16 v[72:73], v177 offset:32768
    ds_read_b64_tr_b16 v[74:75], v177 offset:33280
    ds_read_b64_tr_b16 v[76:77], v178 offset:49152
    ds_read_b64_tr_b16 v[78:79], v178 offset:49664
    ds_read_b64_tr_b16 v[80:81], v251 offset:1024
    ds_read_b64_tr_b16 v[82:83], v251 offset:1536
    ds_read_b64_tr_b16 v[84:85], v176 offset:17408
    ds_read_b64_tr_b16 v[86:87], v176 offset:17920
    ds_read_b64_tr_b16 v[88:89], v177 offset:33792
    ds_read_b64_tr_b16 v[90:91], v177 offset:34304
    ds_read_b64_tr_b16 v[92:93], v178 offset:50176
    ds_read_b64_tr_b16 v[94:95], v178 offset:50688
    ds_read_b64_tr_b16 v[96:97], v251 offset:2048
    ds_read_b64_tr_b16 v[98:99], v251 offset:2560
    ds_read_b64_tr_b16 v[100:101], v176 offset:18432
    ds_read_b64_tr_b16 v[102:103], v176 offset:18944
    ds_read_b64_tr_b16 v[104:105], v177 offset:34816
    ds_read_b64_tr_b16 v[106:107], v177 offset:35328
    ds_read_b64_tr_b16 v[108:109], v178 offset:51200
    ds_read_b64_tr_b16 v[110:111], v178 offset:51712
    ds_read_b64_tr_b16 v[112:113], v251 offset:3072
    ds_read_b64_tr_b16 v[114:115], v251 offset:3584
    ds_read_b64_tr_b16 v[116:117], v176 offset:19456
    ds_read_b64_tr_b16 v[118:119], v176 offset:19968
    ds_read_b64_tr_b16 v[120:121], v177 offset:35840
    ds_read_b64_tr_b16 v[122:123], v177 offset:36352
L_pad1:
    s_cbranch_execz L_warmed0
    ds_read_b64_tr_b16 v[124:125], v178 offset:52224
    ds_read_b64_tr_b16 v[126:127], v178 offset:52736
    s_mov_b64 exec, 1
    s_cmp_eq_u32 s51, 0
    s_cbranch_scc0 L_glob_19
    s_waitcnt vmcnt(0)
    buffer_store_dword v179, off, s[24:27], s43
L_join_20:
    s_mov_b64 exec, -1
    s_branch L_overo0
L_moreo0:
    buffer_load_dword v234, v250, s[24:27], s45 offen offset:0 sc1
    s_sub_u32 s59, s59, 1
    s_cbranch_scc1 L_timeout
    s_waitcnt vmcnt(1)
    v_cmp_ne_u32 vcc, s1, v235
    s_nop 0
    s_cbranch_vccz L_goo0
    s_branch L_spino0
L_overo0:
    ds_write_b128 v252, a[160:163] offset:8192
    ds_write_b128 v252, a[164:167] offset:9216
    ds_write_b128 v252, a[168:171] offset:10240
    ds_write_b128 v252, a[172:175] offset:11264
    s_mov_b64 exec, 0xffff
    buffer_load_dword v234, v250, s[24:27], s45 offen offset:0 sc1
    s_mov_b64 exec, -1
    ds_write_b128 v252, a[176:179] offset:12288
    ds_write_b128 v252, a[180:183] offset:13312
    ds_write_b128 v252, a[184:187] offset:14336
    ds_write_b128 v252, a[188:191] offset:15360
    s_mov_b64 exec, 0xffff
L_spino0:
    buffer_load_dword v235, v250, s[24:27], s45 offen offset:0 sc1
    s_waitcnt vmcnt(1)
    v_cmp_ne_u32 vcc, s1, v234
    s_nop 0
    s_cbranch_vccnz L_moreo0
L_goo0:
    s_mov_b64 exec, -1
    buffer_load_dwordx4 v[0:3], v240, s[24:27], s44 offen offset:0 sc1
    buffer_load_dwordx4 v[4:7], v240, s[24:27], s44 offen offset:1024 sc1
    buffer_load_dwordx4 v[8:11], v240, s[24:27], s44 offen offset:2048 sc1
    buffer_load_dwordx4 v[12:15], v240, s[24:27], s44 offen offset:3072 sc1
    s_waitcnt lgkmcnt(0)
    s_barrier
    ds_read_b64_tr_b16 v[128:129], v251 offset:4096
    ds_read_b64_tr_b16 v[130:131], v251 offset:4608
    ds_read_b64_tr_b16 v[132:133], v176 offset:20480
    ds_read_b64_tr_b16 v[134:135], v176 offset:20992
    ds_read_b64_tr_b16 v[136:137], v177 offset:36864
    ds_read_b64_tr_b16 v[138:139], v177 offset:37376
    s_xor_b32 s58, s44, 4096
    buffer_load_dwordx4 v[16:19], v240, s[24:27], s58 offen offset:0 sc1
    ds_read_b64_tr_b16 v[140:141], v178 offset:53248
    ds_read_b64_tr_b16 v[142:143], v178 offset:53760
    ds_read_b64_tr_b16 v[144:145], v251 offset:5120
    ds_read_b64_tr_b16 v[146:147], v251 offset:5632
    ds_read_b64_tr_b16 v[148:149], v176 offset:21504
    ds_read_b64_tr_b16 v[150:151], v176 offset:22016
    buffer_load_dwordx4 v[20:23], v240, s[24:27], s58 offen offset:1024 sc1
    ds_read_b64_tr_b16 v[152:153], v177 offset:37888
    ds_read_b64_tr_b16 v[154:155], v177 offset:38400
    ds_read_b64_tr_b16 v[156:157], v178 offset:54272
    ds_read_b64_tr_b16 v[158:159], v178 offset:54784
    ds_read_b64_tr_b16 v[160:161], v251 offset:6144
    ds_read_b64_tr_b16 v[162:163], v251 offset:6656
    buffer_load_dwordx4 v[24:27], v240, s[24:27], s58 offen offset:2048 sc1
    ds_read_b64_tr_b16 v[164:165], v176 offset:22528
    ds_read_b64_tr_b16 v[166:167], v176 offset:23040
    ds_read_b64_tr_b16 v[168:169], v177 offset:38912
    ds_read_b64_tr_b16 v[170:171], v177 offset:39424
    ds_read_b64_tr_b16 v[172:173], v178 offset:55296
    ds_read_b64_tr_b16 v[174:175], v178 offset:55808
    buffer_load_dwordx4 v[28:31], v240, s[24:27], s58 offen offset:3072 sc1
    s_waitcnt vmcnt(7)
    v_mfma_f32_16x16x32_bf16 v[192:195], v[64:67], v[0:3], 0
    s_xor_b32 s58, s44, 8192
    buffer_load_dwordx4 v[32:35], v240, s[24:27], s58 offen offset:0 sc1
    v_mfma_f32_16x16x32_bf16 v[196:199], v[68:71], v[0:3], 0
    ds_read_b64_tr_b16 v[64:65], v251 offset:7168
    ds_read_b64_tr_b16 v[66:67], v251 offset:7680
    v_mfma_f32_16x16x32_bf16 v[200:203], v[72:75], v[0:3], 0
    ds_read_b64_tr_b16 v[68:69], v176 offset:23552
    v_mfma_f32_16x16x32_bf16 v[204:207], v[76:79], v[0:3], 0
    ds_read_b64_tr_b16 v[70:71], v176 offset:24064
    s_waitcnt vmcnt(7)
    v_mfma_f32_16x16x32_bf16 v[192:195], v[80:83], v[4:7], v[192:195]
    buffer_load_dwordx4 v[36:39], v240, s[24:27], s58 offen offset:1024 sc1
    v_mfma_f32_16x16x32_bf16 v[196:199], v[84:87], v[4:7], v[196:199]
    ds_read_b64_tr_b16 v[72:73], v177 offset:39936
    ds_read_b64_tr_b16 v[74:75], v177 offset:40448
    v_mfma_f32_16x16x32_bf16 v[200:203], v[88:91], v[4:7], v[200:203]
    ds_read_b64_tr_b16 v[76:77], v178 offset:56320
    v_mfma_f32_16x16x32_bf16 v[204:207], v[92:95], v[4:7], v[204:207]
    ds_read_b64_tr_b16 v[78:79], v178 offset:56832
    s_waitcnt vmcnt(7)
    v_mfma_f32_16x16x32_bf16 v[192:195], v[96:99], v[8:11], v[192:195]
    buffer_load_dwordx4 v[40:43], v240, s[24:27], s58 offen offset:2048 sc1
    v_mfma_f32_16x16x32_bf16 v[196:199], v[100:103], v[8:11], v[196:199]
    ds_read_b64_tr_b16 v[80:81], v251 offset:8192
    ds_read_b64_tr_b16 v[82:83], v251 offset:8704
    v_mfma_f32_16x16x32_bf16 v[200:203], v[104:107], v[8:11], v[200:203]
    ds_read_b64_tr_b16 v[84:85], v176 offset:24576
    v_mfma_f32_16x16x32_bf16 v[204:207], v[108:111], v[8:11], v[204:207]
    ds_read_b64_tr_b16 v[86:87], v176 offset:25088
    s_waitcnt vmcnt(7)
    v_mfma_f32_16x16x32_bf16 v[192:195], v[112:115], v[12:15], v[192:195]
    buffer_load_dwordx4 v[44:47], v240, s[24:27], s58 offen offset:3072 sc1
    v_mfma_f32_16x16x32_bf16 v[196:199], v[116:119], v[12:15], v[196:199]
    ds_read_b64_tr_b16 v[88:89], v177 offset:40960
    ds_read_b64_tr_b16 v[90:91], v177 offset:41472
    v_mfma_f32_16x16x32_bf16 v[200:203], v[120:123], v[12:15], v[200:203]
    ds_read_b64_tr_b16 v[92:93], v178 offset:57344
    v_mfma_f32_16x16x32_bf16 v[204:207], v[124:127], v[12:15], v[204:207]
    ds_read_b64_tr_b16 v[94:95], v178 offset:57856
    s_waitcnt vmcnt(7) lgkmcnt(15)
    v_mfma_f32_16x16x32_bf16 v[192:195], v[128:131], v[16:19], v[192:195]
    s_xor_b32 s58, s44, 12288
    buffer_load_dwordx4 v[48:51], v240, s[24:27], s58 offen offset:0 sc1
    v_mfma_f32_16x16x32_bf16 v[196:199], v[132:135], v[16:19], v[196:199]
    ds_read_b64_tr_b16 v[96:97], v251 offset:9216
    ds_read_b64_tr_b16 v[98:99], v251 offset:9728
    v_mfma_f32_16x16x32_bf16 v[200:203], v[136:139], v[16:19], v[200:203]
    ds_read_b64_tr_b16 v[100:101], v176 offset:25600
    v_mfma_f32_16x16x32_bf16 v[204:207], v[140:143], v[16:19], v[204:207]
    ds_read_b64_tr_b16 v[102:103], v176 offset:26112
    s_waitcnt vmcnt(7)
    v_mfma_f32_16x16x32_bf16 v[192:195], v[144:147], v[20:23], v[192:195]
    buffer_load_dwordx4 v[52:55], v240, s[24:27], s58 offen offset:1024 sc1
    v_mfma_f32_16x16x32_bf16 v[196:199], v[148:151], v[20:23], v[196:199]
    ds_read_b64_tr_b16 v[104:105], v177 offset:41984
    ds_read_b64_tr_b16 v[106:107], v177 offset:42496
    v_mfma_f32_16x16x32_bf16 v[200:203], v[152:155], v[20:23], v[200:203]
    ds_read_b64_tr_b16 v[108:109], v178 offset:58368
    v_mfma_f32_16x16x32_bf16 v[204:207], v[156:159], v[20:23], v[204:207]
    ds_read_b64_tr_b16 v[110:111], v178 offset:58880
    s_waitcnt vmcnt(7)
    v_mfma_f32_16x16x32_bf16 v[192:195], v[160:163], v[24:27], v[192:195]
    buffer_load_dwordx4 v[56:59], v240, s[24:27], s58 offen offset:2048 sc1
    v_mfma_f32_16x16x32_bf16 v[196:199], v[164:167], v[24:27], v[196:199]
    ds_read_b64_tr_b16 v[112:113], v251 offset:10240
    ds_read_b64_tr_b16 v[114:115], v251 offset:10752
    v_mfma_f32_16x16x32_bf16 v[200:203], v[168:171], v[24:27], v[200:203]
    ds_read_b64_tr_b16 v[116:117], v176 offset:26624
    v_mfma_f32_16x16x32_bf16 v[204:207], v[172:175], v[24:27], v[204:207]
    ds_read_b64_tr_b16 v[118:119], v176 offset:27136
    s_waitcnt vmcnt(7) lgkmcnt(15)
    v_mfma_f32_16x16x32_bf16 v[192:195], v[64:67], v[28:31], v[192:195]
    buffer_load_dwordx4 v[60:63], v240, s[24:27], s58 offen offset:3072 sc1
    v_mfma_f32_16x16x32_bf16 v[196:199], v[68:71], v[28:31], v[196:199]
    ds_read_b64_tr_b16 v[120:121], v177 offset:43008
    ds_read_b64_tr_b16 v[122:123], v177 offset:43520
    v_mfma_f32_16x16x32_bf16 v[200:203], v[72:75], v[28:31], v[200:203]
    ds_read_b64_tr_b16 v[124:125], v178 offset:59392
    v_mfma_f32_16x16x32_bf16 v[204:207], v[76:79], v[28:31], v[204:207]
    ds_read_b64_tr_b16 v[126:127], v178 offset:59904
    s_waitcnt vmcnt(7) lgkmcnt(15)
    v_mfma_f32_16x16x32_bf16 v[192:195], v[80:83], v[32:35], v[192:195]
    s_add_u32 s55, s60, 786432
    buffer_load_dwordx4 a[96:99], v180, s[84:87], s55 offen
    ds_read_b64_tr_b16 v[128:129], v251 offset:11264
    ds_read_b64_tr_b16 v[130:131], v251 offset:11776
    v_mfma_f32_16x16x32_bf16 v[196:199], v[84:87], v[32:35], v[196:199]
    ds_read_b64_tr_b16 v[132:133], v176 offset:27648
    ds_read_b64_tr_b16 v[134:135], v176 offset:28160
    v_mfma_f32_16x16x32_bf16 v[200:203], v[88:91], v[32:35], v[200:203]
    ds_read_b64_tr_b16 v[136:137], v177 offset:44032
    ds_read_b64_tr_b16 v[138:139], v177 offset:44544
    v_mfma_f32_16x16x32_bf16 v[204:207], v[92:95], v[32:35], v[204:207]
    ds_read_b64_tr_b16 v[140:141], v178 offset:60416
    s_waitcnt vmcnt(7) lgkmcnt(15)
    v_mfma_f32_16x16x32_bf16 v[192:195], v[96:99], v[36:39], v[192:195]
    s_add_u32 s55, s60, 884736
    buffer_load_dwordx4 a[100:103], v180, s[84:87], s55 offen
    ds_read_b64_tr_b16 v[142:143], v178 offset:60928
    ds_read_b64_tr_b16 v[144:145], v251 offset:12288
    v_mfma_f32_16x16x32_bf16 v[196:199], v[100:103], v[36:39], v[196:199]
    ds_read_b64_tr_b16 v[146:147], v251 offset:12800
    ds_read_b64_tr_b16 v[148:149], v176 offset:28672
    v_mfma_f32_16x16x32_bf16 v[200:203], v[104:107], v[36:39], v[200:203]
    ds_read_b64_tr_b16 v[150:151], v176 offset:29184
    ds_read_b64_tr_b16 v[152:153], v177 offset:45056
    v_mfma_f32_16x16x32_bf16 v[204:207], v[108:111], v[36:39], v[204:207]
    ds_read_b64_tr_b16 v[154:155], v177 offset:45568
    s_waitcnt vmcnt(7) lgkmcnt(14)
    v_mfma_f32_16x16x32_bf16 v[192:195], v[112:115], v[40:43], v[192:195]
    s_add_u32 s55, s60, 983040
    buffer_load_dwordx4 a[104:107], v180, s[84:87], s55 offen
    ds_read_b64_tr_b16 v[156:157], v178 offset:61440
    ds_read_b64_tr_b16 v[158:159], v178 offset:61952
    v_mfma_f32_16x16x32_bf16 v[196:199], v[116:119], v[40:43], v[196:199]
    ds_read_b64_tr_b16 v[160:161], v251 offset:13312
    ds_read_b64_tr_b16 v[162:163], v251 offset:13824
    v_mfma_f32_16x16x32_bf16 v[200:203], v[120:123], v[40:43], v[200:203]
    ds_read_b64_tr_b16 v[164:165], v176 offset:29696
    ds_read_b64_tr_b16 v[166:167], v176 offset:30208
    v_mfma_f32_16x16x32_bf16 v[204:207], v[124:127], v[40:43], v[204:207]
    ds_read_b64_tr_b16 v[168:169], v177 offset:46080
    s_waitcnt vmcnt(7) lgkmcnt(13)
    v_mfma_f32_16x16x32_bf16 v[192:195], v[128:131], v[44:47], v[192:195]
    s_add_u32 s55, s60, 1081344
    buffer_load_dwordx4 a[108:111], v180, s[84:87], s55 offen
    ds_read_b64_tr_b16 v[170:171], v177 offset:46592
    ds_read_b64_tr_b16 v[172:173], v178 offset:62464
    v_mfma_f32_16x16x32_bf16 v[196:199], v[132:135], v[44:47], v[196:199]
    ds_read_b64_tr_b16 v[174:175], v178 offset:62976
    ds_read_b64_tr_b16 v[64:65], v251 offset:14336
    v_mfma_f32_16x16x32_bf16 v[200:203], v[136:139], v[44:47], v[200:203]
    ds_read_b64_tr_b16 v[66:67], v251 offset:14848
    ds_read_b64_tr_b16 v[68:69], v176 offset:30720
    v_mfma_f32_16x16x32_bf16 v[204:207], v[140:143], v[44:47], v[204:207]
    ds_read_b64_tr_b16 v[70:71], v176 offset:31232
    s_waitcnt vmcnt(7) lgkmcnt(12)
    v_mfma_f32_16x16x32_bf16 v[192:195], v[144:147], v[48:51], v[192:195]
    s_add_u32 s55, s60, 1179648
    buffer_load_dwordx4 a[112:115], v180, s[84:87], s55 offen
    ds_read_b64_tr_b16 v[72:73], v177 offset:47104
    ds_read_b64_tr_b16 v[74:75], v177 offset:47616
    v_mfma_f32_16x16x32_bf16 v[196:199], v[148:151], v[48:51], v[196:199]
    ds_read_b64_tr_b16 v[76:77], v178 offset:63488
    ds_read_b64_tr_b16 v[78:79], v178 offset:64000
    v_mfma_f32_16x16x32_bf16 v[200:203], v[152:155], v[48:51], v[200:203]
    ds_read_b64_tr_b16 v[80:81], v251 offset:15360
    ds_read_b64_tr_b16 v[82:83], v251 offset:15872
    v_mfma_f32_16x16x32_bf16 v[204:207], v[156:159], v[48:51], v[204:207]
    ds_read_b64_tr_b16 v[84:85], v176 offset:31744
    s_waitcnt vmcnt(7) lgkmcnt(11)
    v_mfma_f32_16x16x32_bf16 v[192:195], v[160:163], v[52:55], v[192:195]
    s_add_u32 s55, s60, 1277952
    buffer_load_dwordx4 a[116:119], v180, s[84:87], s55 offen
    ds_read_b64_tr_b16 v[86:87], v176 offset:32256
    ds_read_b64_tr_b16 v[88:89], v177 offset:48128
    v_mfma_f32_16x16x32_bf16 v[196:199], v[164:167], v[52:55], v[196:199]
    ds_read_b64_tr_b16 v[90:91], v177 offset:48640
    ds_read_b64_tr_b16 v[92:93], v178 offset:64512
    v_mfma_f32_16x16x32_bf16 v[200:203], v[168:171], v[52:55], v[200:203]
    ds_read_b64_tr_b16 v[94:95], v178 offset:65024
    v_mfma_f32_16x16x32_bf16 v[204:207], v[172:175], v[52:55], v[204:207]
    s_waitcnt vmcnt(7) lgkmcnt(8)
    v_mfma_f32_16x16x32_bf16 v[192:195], v[64:67], v[56:59], v[192:195]
    s_add_u32 s55, s60, 1376256
    buffer_load_dwordx4 a[120:123], v180, s[84:87], s55 offen
    v_mfma_f32_16x16x32_bf16 v[196:199], v[68:71], v[56:59], v[196:199]
    v_mfma_f32_16x16x32_bf16 v[200:203], v[72:75], v[56:59], v[200:203]
    v_mfma_f32_16x16x32_bf16 v[204:207], v[76:79], v[56:59], v[204:207]
    s_waitcnt vmcnt(7) lgkmcnt(0)
    v_mfma_f32_16x16x32_bf16 v[192:195], v[80:83], v[60:63], v[192:195]
    s_add_u32 s55, s60, 1474560
    buffer_load_dwordx4 a[124:127], v180, s[84:87], s55 offen
    v_mfma_f32_16x16x32_bf16 v[196:199], v[84:87], v[60:63], v[196:199]
    v_mfma_f32_16x16x32_bf16 v[200:203], v[88:91], v[60:63], v[200:203]
    v_mfma_f32_16x16x32_bf16 v[204:207], v[92:95], v[60:63], v[204:207]
    s_nop 1
    s_nop 0
    v_cvt_pk_bf16_f32 v144, v192, v193
    v_cvt_pk_bf16_f32 v145, v194, v195
    s_nop 0
    v_cvt_pk_bf16_f32 v146, v196, v197
    v_cvt_pk_bf16_f32 v147, v198, v199
    v_cvt_pk_bf16_f32 v148, v200, v201
    v_cvt_pk_bf16_f32 v149, v202, v203
    v_cvt_pk_bf16_f32 v150, v204, v205
    v_cvt_pk_bf16_f32 v151, v206, v207
    v_lshlrev_b32 v192, 16, v144
    v_and_b32 v193, 0xffff0000, v144
    v_lshlrev_b32 v194, 16, v145
    v_and_b32 v195, 0xffff0000, v145
    v_lshlrev_b32 v196, 16, v146
    v_and_b32 v197, 0xffff0000, v146
    v_lshlrev_b32 v198, 16, v147
    v_and_b32 v199, 0xffff0000, v147
    v_lshlrev_b32 v200, 16, v148
    v_and_b32 v201, 0xffff0000, v148
    v_lshlrev_b32 v202, 16, v149
    v_and_b32 v203, 0xffff0000, v149
    v_lshlrev_b32 v204, 16, v150
    v_and_b32 v205, 0xffff0000, v150
    v_lshlrev_b32_e64 v206, 16, v151
    v_and_b32 v207, 0xffff0000, v151
    v_pk_add_f32 v[208:209], v[208:209], v[192:193]
    v_pk_add_f32 v[210:211], v[210:211], v[194:195]
    v_pk_add_f32 v[212:213], v[212:213], v[196:197]
    v_pk_add_f32 v[214:215], v[214:215], v[198:199]
    v_pk_add_f32 v[216:217], v[216:217], v[200:201]
    v_pk_add_f32 v[218:219], v[218:219], v[202:203]
    v_pk_add_f32 v[220:221], v[220:221], v[204:205]
    v_pk_add_f32 v[222:223], v[222:223], v[206:207]
    s_cmp_eq_u32 s51, 0
    s_cbranch_scc0 L_glob_21
    v_cvt_pk_bf16_f32 v128, v208, v209
    v_cvt_pk_bf16_f32 v129, v210, v211
    v_cvt_pk_bf16_f32 v130, v212, v213
    v_cvt_pk_bf16_f32 v131, v214, v215
    buffer_store_dwordx4 v[128:131], v247, s[28:31], s46 offen offset:0
    v_cvt_pk_bf16_f32 v132, v216, v217
    v_cvt_pk_bf16_f32 v133, v218, v219
    v_cvt_pk_bf16_f32 v134, v220, v221
    v_cvt_pk_bf16_f32 v135, v222, v223
    buffer_store_dwordx4 v[132:135], v247, s[28:31], s46 offen offset:512
L_join_22:
    v_pk_add_f32 v[136:137], v[208:209], v[210:211]
    v_pk_mul_f32 v[138:139], v[208:209], v[208:209]
    v_pk_fma_f32 v[138:139], v[210:211], v[210:211], v[138:139]
    v_pk_add_f32 v[136:137], v[136:137], v[212:213]
    v_pk_fma_f32 v[138:139], v[212:213], v[212:213], v[138:139]
    v_pk_add_f32 v[136:137], v[136:137], v[214:215]
    v_pk_fma_f32 v[138:139], v[214:215], v[214:215], v[138:139]
    v_pk_add_f32 v[136:137], v[136:137], v[216:217]
    v_pk_fma_f32 v[138:139], v[216:217], v[216:217], v[138:139]
    v_pk_add_f32 v[136:137], v[136:137], v[218:219]
    v_pk_fma_f32 v[138:139], v[218:219], v[218:219], v[138:139]
    v_pk_add_f32 v[136:137], v[136:137], v[220:221]
    v_pk_fma_f32 v[138:139], v[220:221], v[220:221], v[138:139]
    v_pk_add_f32 v[136:137], v[136:137], v[222:223]
    v_pk_fma_f32 v[138:139], v[222:223], v[222:223], v[138:139]
    v_add_f32 v136, v136, v137
    v_add_f32 v138, v138, v139
    s_nop 1
    v_permlane32_swap_b32 v136, v138
    v_add_f32 v136, v136, v138
    v_mov_b32 v137, v136
    s_cmp_eq_u32 s51, 0
    s_cbranch_scc0 L_glob_23
    v_permlane16_swap_b32 v136, v137
    s_mov_b64 exec, s[96:97]
    v_add_f32 v136, v136, v137
    v_or_b32 v136, 1, v136
    buffer_store_dword v136, v248, s[24:27], s47 offen
L_join_24:
    s_mov_b64 exec, -1
    s_barrier
    v_and_b32 v144, 0x1f0, v240
    v_add_u32 v144, 0x27a60, v144
    ds_read_b128 v[144:147], v144
    s_and_b32 s57, s36, 1
    s_lshl_b32 s57, s57, 9
    s_and_b32 s56, s36, 2
    s_lshl2_add_u32 s57, s56, s57
    s_add_u32 s57, s57, 160864
    v_lshrrev_b32_e64 v152, 9, v240
    v_lshl_add_u32 v152, v152, 2, s57
    v_bfe_u32 v153, v240, 4, 1
    v_lshl_add_u32 v152, v153, 8, v152
    v_bfe_u32 v153, v240, 8, 1
    v_lshl_add_u32 v152, v153, 7, v152
    v_bfe_u32 v153, v240, 5, 1
    v_lshl_add_u32 v152, v153, 6, v152
    s_waitcnt lgkmcnt(0)
    ds_write_b128 v253, a[64:67] offset:0
    v_mfma_f32_16x16x32_bf16 v[148:151], v[144:147], a[64:67], 0
    ds_write_b128 v253, a[68:71] offset:2048
    v_mfma_f32_16x16x32_bf16 v[148:151], v[144:147], a[68:71], v[148:151]
    ds_write_b128 v253, a[72:75] offset:4096
    v_mfma_f32_16x16x32_bf16 v[148:151], v[144:147], a[72:75], v[148:151]
    ds_write_b128 v253, a[76:79] offset:6144
    v_mfma_f32_16x16x32_bf16 v[148:151], v[144:147], a[76:79], v[148:151]
    ds_write_b128 v253, a[80:83] offset:8192
    v_mfma_f32_16x16x32_bf16 v[148:151], v[144:147], a[80:83], v[148:151]
    ds_write_b128 v253, a[84:87] offset:10240
    v_mfma_f32_16x16x32_bf16 v[148:151], v[144:147], a[84:87], v[148:151]
    ds_write_b128 v253, a[88:91] offset:12288
    v_mfma_f32_16x16x32_bf16 v[148:151], v[144:147], a[88:91], v[148:151]
    ds_write_b128 v253, a[92:95] offset:14336
    v_mfma_f32_16x16x32_bf16 v[148:151], v[144:147], a[92:95], v[148:151]
    s_add_u32 s49, s49, 589824
    s_mov_b64 exec, 1
    s_cmp_eq_u32 s51, 0
    s_cbranch_scc0 L_glob_25
    s_waitcnt vmcnt(0)
    buffer_store_dword v179, off, s[24:27], s48
L_join_26:
    s_mov_b64 exec, -1
    s_branch L_overx1
L_morex1:
    buffer_load_dword v234, v250, s[24:27], s41 offen offset:0 sc1
    s_sub_u32 s59, s59, 1
    s_cbranch_scc1 L_timeout
    s_waitcnt vmcnt(1)
    v_cmp_ne_u32 vcc, s1, v235
    s_nop 0
    s_cbranch_vccz L_gox1
    s_branch L_spinx1
L_overx1:
    ds_write_b128 v253, a[96:99] offset:16384
    v_mfma_f32_16x16x32_bf16 v[148:151], v[144:147], a[96:99], v[148:151]
    v_mfma_f32_16x16x32_bf16 v[148:151], v[144:147], a[100:103], v[148:151]
    ds_write_b128 v253, a[100:103] offset:18432
    v_mfma_f32_16x16x32_bf16 v[148:151], v[144:147], a[104:107], v[148:151]
    v_mfma_f32_16x16x32_bf16 v[148:151], v[144:147], a[108:111], v[148:151]
    ds_write_b128 v253, a[104:107] offset:20480
    v_mfma_f32_16x16x32_bf16 v[148:151], v[144:147], a[112:115], v[148:151]
    v_mfma_f32_16x16x32_bf16 v[148:151], v[144:147], a[116:119], v[148:151]
    s_mov_b64 exec, 0xffff
    buffer_load_dword v234, v250, s[24:27], s41 offen offset:0 sc1
    s_mov_b64 exec, -1
    ds_write_b128 v253, a[108:111] offset:22528
    v_mfma_f32_16x16x32_bf16 v[148:151], v[144:147], a[120:123], v[148:151]
    v_mfma_f32_16x16x32_bf16 v[148:151], v[144:147], a[124:127], v[148:151]
    s_nop 7
    v_add_f32 v148, v148, v148 row_ror:4
    v_add_f32 v149, v149, v149 row_ror:4
    v_add_f32 v150, v150, v150 row_ror:4
    v_add_f32 v151, v151, v151 row_ror:4
    v_add_f32 v148, v148, v148 row_ror:8
    v_add_f32 v149, v149, v149 row_ror:8
    v_add_f32 v150, v150, v150 row_ror:8
    v_add_f32 v151, v151, v151 row_ror:8
    ds_write2_b32 v152, v148, v149 offset0:0 offset1:4
    ds_write2_b32 v152, v150, v151 offset0:8 offset1:12
L_layer1:
    s_mov_b64 exec, 0xffff
L_spinx1:
    buffer_load_dword v235, v250, s[24:27], s41 offen offset:0 sc1
    s_waitcnt vmcnt(1)
    v_cmp_ne_u32_e64 vcc, s1, v234
    s_nop 0
    s_cbranch_vccnz L_morex1
L_gox1:
    s_mov_b64 exec, -1
    buffer_load_dwordx4 v[0:3], v240, s[28:31], s39 offen offset:0 sc1
    buffer_load_dwordx4 v[4:7], v240, s[28:31], s39 offen offset:1024 sc1
    buffer_load_dwordx4 v[8:11], v240, s[28:31], s39 offen offset:2048 sc1
    buffer_load_dwordx4 v[12:15], v240, s[28:31], s39 offen offset:3072 sc1
    ds_write_b128 v253, a[112:115] offset:24576
    s_xor_b32 s58, s39, 4096
    buffer_load_dwordx4 v[16:19], v240, s[28:31], s58 offen offset:0 sc1
    ds_write_b128 v253, a[116:119] offset:26624
    buffer_load_dwordx4 v[20:23], v240, s[28:31], s58 offen offset:1024 sc1
    ds_write_b128 v253, a[120:123] offset:28672
    buffer_load_dwordx4 v[24:27], v240, s[28:31], s58 offen offset:2048 sc1
    ds_write_b128 v253, a[124:127] offset:30720
    buffer_load_dwordx4 v[28:31], v240, s[28:31], s58 offen offset:3072 sc1
    s_waitcnt lgkmcnt(0)
    s_barrier
    ds_read_b64_tr_b16 v[160:161], v241 offset:0
    ds_read_b64_tr_b16 v[162:163], v241 offset:1024
    ds_read_b64_tr_b16 v[164:165], v241 offset:32768
    ds_read_b64_tr_b16 v[166:167], v241 offset:33792
    ds_read_b64_tr_b16 v[168:169], v241 offset:256
    ds_read_b64_tr_b16 v[170:171], v241 offset:1280
    ds_read_b64_tr_b16 v[172:173], v241 offset:33024
    ds_read_b64_tr_b16 v[174:175], v241 offset:34048
    ds_read_b64_tr_b16 v[176:177], v241 offset:512
    ds_read_b64_tr_b16 v[178:179], v241 offset:1536
    ds_read_b64_tr_b16 v[180:181], v241 offset:33280
    ds_read_b64_tr_b16 v[182:183], v241 offset:34304
    ds_read_b128 v[200:203], v254 offset:1536
    ds_read_b128 v[204:207], v254 offset:2048
    s_waitcnt vmcnt(7) lgkmcnt(10)
    v_mfma_f32_32x32x16_bf16 v[128:143], v[160:163], v[0:3], 0
    s_xor_b32 s58, s39, 8192
    buffer_load_dwordx4 v[32:35], v240, s[28:31], s58 offen offset:0 sc1
    ds_read_b64_tr_b16 v[160:161], v241 offset:768
    ds_read_b64_tr_b16 v[162:163], v241 offset:1792
    v_mfma_f32_32x32x16_bf16 v[144:159], v[164:167], v[0:3], 0
    v_mov_b32 v227, 0
    ds_read_b64_tr_b16 v[164:165], v241 offset:33536
    ds_read_b64_tr_b16 v[166:167], v241 offset:34560
    v_mov_b32 v228, 0
    s_waitcnt vmcnt(7) lgkmcnt(10)
    v_mfma_f32_32x32x16_bf16 v[128:143], v[168:171], v[4:7], v[128:143]
    buffer_load_dwordx4 v[36:39], v240, s[28:31], s58 offen offset:1024 sc1
    buffer_load_dwordx4 v[192:195], v249, s[24:27], s40 offen sc1
    ds_read_b64_tr_b16 v[168:169], v241 offset:4096
    ds_read_b64_tr_b16 v[170:171], v241 offset:5120
    v_mfma_f32_32x32x16_bf16 v[144:159], v[172:175], v[4:7], v[144:159]
    ds_read_b64_tr_b16 v[172:173], v241 offset:36864
    ds_read_b64_tr_b16 v[174:175], v241 offset:37888
    s_waitcnt vmcnt(8) lgkmcnt(10)
    v_mfma_f32_32x32x16_bf16 v[128:143], v[176:179], v[8:11], v[128:143]
    buffer_load_dwordx4 v[40:43], v240, s[28:31], s58 offen offset:2048 sc1
    ds_read_b64_tr_b16 v[176:177], v241 offset:4352
    ds_read_b64_tr_b16 v[178:179], v241 offset:5376
    v_mfma_f32_32x32x16_bf16 v[144:159], v[180:183], v[8:11], v[144:159]
    ds_read_b64_tr_b16 v[180:181], v241 offset:37120
    ds_read_b64_tr_b16 v[182:183], v241 offset:38144
    s_waitcnt vmcnt(8) lgkmcnt(8)
    v_mfma_f32_32x32x16_bf16 v[128:143], v[160:163], v[12:15], v[128:143]
    buffer_load_dwordx4 v[44:47], v240, s[28:31], s58 offen offset:3072 sc1
    buffer_load_dwordx4 v[196:199], v249, s[24:27], s40 offen offset:512 sc1
    ds_read_b64_tr_b16 v[160:161], v241 offset:4608
    ds_read_b64_tr_b16 v[162:163], v241 offset:5632
    v_mfma_f32_32x32x16_bf16 v[144:159], v[164:167], v[12:15], v[144:159]
    v_add_f32_e64 v200, v200, v202
    ds_read_b64_tr_b16 v[164:165], v241 offset:37376
    ds_read_b64_tr_b16 v[166:167], v241 offset:38400
    v_add_f32 v201, v201, v203
    s_waitcnt vmcnt(9) lgkmcnt(8)
    v_mfma_f32_32x32x16_bf16 v[128:143], v[168:171], v[16:19], v[128:143]
    s_xor_b32 s58, s39, 12288
    buffer_load_dwordx4 v[48:51], v240, s[28:31], s58 offen offset:0 sc1
    ds_read_b64_tr_b16 v[168:169], v241 offset:4864
    ds_read_b64_tr_b16 v[170:171], v241 offset:5888
    v_mfma_f32_32x32x16_bf16 v[144:159], v[172:175], v[16:19], v[144:159]
    v_add_f32_e64 v200, v200, v201
    ds_read_b64_tr_b16 v[172:173], v241 offset:37632
    ds_read_b64_tr_b16 v[174:175], v241 offset:38656
    v_cvt_pk_bf16_f32 v201, v200, v200
    s_waitcnt vmcnt(9) lgkmcnt(8)
    v_mfma_f32_32x32x16_bf16 v[128:143], v[176:179], v[20:23], v[128:143]
    buffer_load_dwordx4 v[52:55], v240, s[28:31], s58 offen offset:1024 sc1
    ds_read_b64_tr_b16 v[176:177], v241 offset:8192
    ds_read_b64_tr_b16 v[178:179], v241 offset:9216
    v_mfma_f32_32x32x16_bf16 v[144:159], v[180:183], v[20:23], v[144:159]
    v_and_b32 v201, 0xffff0000, v201
    ds_read_b64_tr_b16 v[180:181], v241 offset:40960
    ds_read_b64_tr_b16 v[182:183], v241 offset:41984
    v_sub_f32 v200, v200, v201
    s_waitcnt vmcnt(9) lgkmcnt(8)
    v_mfma_f32_32x32x16_bf16 v[128:143], v[160:163], v[24:27], v[128:143]
    buffer_load_dwordx4 v[56:59], v240, s[28:31], s58 offen offset:2048 sc1
    ds_read_b64_tr_b16 v[160:161], v241 offset:8448
    ds_read_b64_tr_b16 v[162:163], v241 offset:9472
    v_mfma_f32_32x32x16_bf16 v[144:159], v[164:167], v[24:27], v[144:159]
    v_cvt_pk_bf16_f32 v224, v201, v200
    ds_read_b64_tr_b16 v[164:165], v241 offset:41216
    ds_read_b64_tr_b16 v[166:167], v241 offset:42240
    v_add_f32 v204, v204, v206
    s_waitcnt vmcnt(9) lgkmcnt(8)
    v_mfma_f32_32x32x16_bf16 v[128:143], v[168:171], v[28:31], v[128:143]
    buffer_load_dwordx4 v[60:63], v240, s[28:31], s58 offen offset:3072 sc1
    ds_read_b64_tr_b16 v[168:169], v241 offset:8704
    ds_read_b64_tr_b16 v[170:171], v241 offset:9728
    v_mfma_f32_32x32x16_bf16 v[144:159], v[172:175], v[28:31], v[144:159]
    v_add_f32 v205, v205, v207
    ds_read_b64_tr_b16 v[172:173], v241 offset:41472
    ds_read_b64_tr_b16 v[174:175], v241 offset:42496
    v_add_f32 v204, v204, v205
    s_waitcnt vmcnt(9) lgkmcnt(8)
    v_mfma_f32_32x32x16_bf16 v[128:143], v[176:179], v[32:35], v[128:143]
    s_xor_b32 s58, s39, 16384
    buffer_load_dwordx4 v[64:67], v240, s[28:31], s58 offen offset:0 sc1
    ds_read_b64_tr_b16 v[176:177], v241 offset:8960
    ds_read_b64_tr_b16 v[178:179], v241 offset:9984
    v_mfma_f32_32x32x16_bf16 v[144:159], v[180:183], v[32:35], v[144:159]
    v_cvt_pk_bf16_f32 v205, v204, v204
    ds_read_b64_tr_b16 v[180:181], v241 offset:41728
    ds_read_b64_tr_b16 v[182:183], v241 offset:42752
    v_and_b32 v205, 0xffff0000, v205
    s_waitcnt vmcnt(9) lgkmcnt(8)
    v_mfma_f32_32x32x16_bf16 v[128:143], v[160:163], v[36:39], v[128:143]
    buffer_load_dwordx4 v[68:71], v240, s[28:31], s58 offen offset:1024 sc1
    ds_read_b64_tr_b16 v[160:161], v241 offset:12288
    ds_read_b64_tr_b16 v[162:163], v241 offset:13312
    v_mfma_f32_32x32x16_bf16 v[144:159], v[164:167], v[36:39], v[144:159]
    v_sub_f32 v204, v204, v205
    ds_read_b64_tr_b16 v[164:165], v241 offset:45056
    ds_read_b64_tr_b16 v[166:167], v241 offset:46080
    v_cvt_pk_bf16_f32 v225, v205, v204
    s_waitcnt vmcnt(8) lgkmcnt(8)
    v_mfma_f32_32x32x16_bf16 v[128:143], v[168:171], v[40:43], v[128:143]
    buffer_load_dwordx4 v[72:75], v240, s[28:31], s58 offen offset:2048 sc1
    ds_read_b64_tr_b16 v[168:169], v241 offset:12544
    ds_read_b64_tr_b16 v[170:171], v241 offset:13568
    v_mfma_f32_32x32x16_bf16 v[144:159], v[172:175], v[40:43], v[144:159]
    v_lshrrev_b32 v202, 6, v240
    ds_read_b64_tr_b16 v[172:173], v241 offset:45312
    ds_read_b64_tr_b16 v[174:175], v241 offset:46336
    v_mul_u32_u24 v202, 3008, v202
    s_waitcnt vmcnt(8) lgkmcnt(8)
    v_mfma_f32_32x32x16_bf16 v[128:143], v[176:179], v[44:47], v[128:143]
    buffer_load_dwordx4 v[76:79], v240, s[28:31], s58 offen offset:3072 sc1
    ds_read_b64_tr_b16 v[176:177], v241 offset:12800
    ds_read_b64_tr_b16 v[178:179], v241 offset:13824
    v_mfma_f32_32x32x16_bf16 v[144:159], v[180:183], v[44:47], v[144:159]
    ds_read_b64_tr_b16 v[180:181], v241 offset:45568
    ds_read_b64_tr_b16 v[182:183], v241 offset:46592
    v_add_u32 v202, v202, v240
    s_waitcnt vmcnt(7) lgkmcnt(8)
    v_mfma_f32_32x32x16_bf16 v[128:143], v[160:163], v[48:51], v[128:143]
    s_xor_b32 s58, s39, 20480
    buffer_load_dwordx4 v[80:83], v240, s[28:31], s58 offen offset:0 sc1
    ds_read_b64_tr_b16 v[160:161], v241 offset:13056
    ds_read_b64_tr_b16 v[162:163], v241 offset:14080
    v_mfma_f32_32x32x16_bf16 v[144:159], v[164:167], v[48:51], v[144:159]
    v_add_f32 v192, v192, v194
    ds_read_b64_tr_b16 v[164:165], v241 offset:45824
    ds_read_b64_tr_b16 v[166:167], v241 offset:46848
    v_add_f32 v193, v193, v195
    s_waitcnt vmcnt(7) lgkmcnt(8)
    v_mfma_f32_32x32x16_bf16 v[128:143], v[168:171], v[52:55], v[128:143]
L_pad2:
    s_cbranch_execz L_warmed0
    buffer_load_dwordx4 v[84:87], v240, s[28:31], s58 offen offset:1024 sc1
    ds_read_b64_tr_b16 v[168:169], v241 offset:16384
    ds_read_b64_tr_b16 v[170:171], v241 offset:17408
    v_mfma_f32_32x32x16_bf16 v[144:159], v[172:175], v[52:55], v[144:159]
    v_add_f32 v196, v196, v198
    ds_read_b64_tr_b16 v[172:173], v241 offset:49152
    ds_read_b64_tr_b16 v[174:175], v241 offset:50176
    v_add_f32 v197, v197, v199
    s_waitcnt vmcnt(7) lgkmcnt(8)
    v_mfma_f32_32x32x16_bf16 v[128:143], v[176:179], v[56:59], v[128:143]
    buffer_load_dwordx4 v[88:91], v240, s[28:31], s58 offen offset:2048 sc1
    ds_read_b64_tr_b16 v[176:177], v241 offset:16640
    ds_read_b64_tr_b16 v[178:179], v241 offset:17664
    v_mfma_f32_32x32x16_bf16 v[144:159], v[180:183], v[56:59], v[144:159]
    v_add_f32_e64 v192, v192, v196
    ds_read_b64_tr_b16 v[180:181], v241 offset:49408
    ds_read_b64_tr_b16 v[182:183], v241 offset:50432
    v_add_f32 v193, v193, v197
    s_waitcnt vmcnt(7) lgkmcnt(8)
    v_mfma_f32_32x32x16_bf16 v[128:143], v[160:163], v[60:63], v[128:143]
    buffer_load_dwordx4 v[92:95], v240, s[28:31], s58 offen offset:3072 sc1
    ds_read_b64_tr_b16 v[160:161], v241 offset:16896
    ds_read_b64_tr_b16 v[162:163], v241 offset:17920
    v_mfma_f32_32x32x16_bf16 v[144:159], v[164:167], v[60:63], v[144:159]
    v_add_f32_e64 v192, v192, v193
    ds_read_b64_tr_b16 v[164:165], v241 offset:49664
    ds_read_b64_tr_b16 v[166:167], v241 offset:50688
    v_mul_f32 v192, 0x3b000000, v192
    s_waitcnt vmcnt(7) lgkmcnt(8)
    v_mfma_f32_32x32x16_bf16 v[128:143], v[168:171], v[64:67], v[128:143]
    s_xor_b32 s58, s39, 24576
    buffer_load_dwordx4 v[96:99], v240, s[28:31], s58 offen offset:0 sc1
    ds_read_b64_tr_b16 v[168:169], v241 offset:17152
    ds_read_b64_tr_b16 v[170:171], v241 offset:18176
    v_mfma_f32_32x32x16_bf16 v[144:159], v[172:175], v[64:67], v[144:159]
    v_mov_b32 v193, v192
    ds_read_b64_tr_b16 v[172:173], v241 offset:49920
    ds_read_b64_tr_b16 v[174:175], v241 offset:50944
    v_permlane32_swap_b32 v192, v193
    s_waitcnt vmcnt(7) lgkmcnt(8)
    v_mfma_f32_32x32x16_bf16 v[128:143], v[176:179], v[68:71], v[128:143]
    buffer_load_dwordx4 v[100:103], v240, s[28:31], s58 offen offset:1024 sc1
    ds_read_b64_tr_b16 v[176:177], v241 offset:20480
    ds_read_b64_tr_b16 v[178:179], v241 offset:21504
    v_mfma_f32_32x32x16_bf16 v[144:159], v[180:183], v[68:71], v[144:159]
    v_fma_f32 v193, -v192, v192, v193
    ds_read_b64_tr_b16 v[180:181], v241 offset:53248
    ds_read_b64_tr_b16 v[182:183], v241 offset:54272
    v_max_f32 v193, 0, v193
    s_waitcnt vmcnt(7) lgkmcnt(8)
    v_mfma_f32_32x32x16_bf16 v[128:143], v[160:163], v[72:75], v[128:143]
    buffer_load_dwordx4 v[104:107], v240, s[28:31], s58 offen offset:2048 sc1
    ds_read_b64_tr_b16 v[160:161], v241 offset:20736
    ds_read_b64_tr_b16 v[162:163], v241 offset:21760
    v_mfma_f32_32x32x16_bf16 v[144:159], v[164:167], v[72:75], v[144:159]
    v_cvt_pk_bf16_f32 v246, -v192, -v192
    ds_read_b64_tr_b16 v[164:165], v241 offset:53504
    ds_read_b64_tr_b16 v[166:167], v241 offset:54528
    v_cvt_pk_bf16_f32 v193, v193, v193
    s_waitcnt vmcnt(7) lgkmcnt(8)
    v_mfma_f32_32x32x16_bf16 v[128:143], v[168:171], v[76:79], v[128:143]
    buffer_load_dwordx4 v[108:111], v240, s[28:31], s58 offen offset:3072 sc1
    ds_read_b64_tr_b16 v[168:169], v241 offset:20992
    ds_read_b64_tr_b16 v[170:171], v241 offset:22016
    v_mfma_f32_32x32x16_bf16 v[144:159], v[172:175], v[76:79], v[144:159]
    v_and_b32 v193, 0xffff0000, v193
    ds_read_b64_tr_b16 v[172:173], v241 offset:53760
    ds_read_b64_tr_b16 v[174:175], v241 offset:54784
    v_add_f32 v193, 0x3727c5ac, v193
    s_waitcnt vmcnt(7) lgkmcnt(8)
    v_mfma_f32_32x32x16_bf16 v[128:143], v[176:179], v[80:83], v[128:143]
    s_xor_b32 s58, s39, 28672
    buffer_load_dwordx4 v[112:115], v240, s[28:31], s58 offen offset:0 sc1
    ds_read_b64_tr_b16 v[176:177], v241 offset:21248
    ds_read_b64_tr_b16 v[178:179], v241 offset:22272
    v_mfma_f32_32x32x16_bf16 v[144:159], v[180:183], v[80:83], v[144:159]
    v_cvt_pk_bf16_f32 v193, v193, v193
    ds_read_b64_tr_b16 v[180:181], v241 offset:54016
    ds_read_b64_tr_b16 v[182:183], v241 offset:55040
    v_and_b32 v193, 0xffff0000, v193
    s_waitcnt vmcnt(7) lgkmcnt(8)
    v_mfma_f32_32x32x16_bf16 v[128:143], v[160:163], v[84:87], v[128:143]
    buffer_load_dwordx4 v[116:119], v240, s[28:31], s58 offen offset:1024 sc1
    ds_read_b64_tr_b16 v[160:161], v241 offset:24576
    ds_read_b64_tr_b16 v[162:163], v241 offset:25600
    v_mfma_f32_32x32x16_bf16 v[144:159], v[164:167], v[84:87], v[144:159]
    v_sqrt_f32 v193, v193
    ds_read_b64_tr_b16 v[164:165], v241 offset:57344
    ds_read_b64_tr_b16 v[166:167], v241 offset:58368
    v_cndmask_b32 v246, v246, 0, s[68:69]
    s_waitcnt vmcnt(7) lgkmcnt(8)
    v_mfma_f32_32x32x16_bf16 v[128:143], v[168:171], v[88:91], v[128:143]
    buffer_load_dwordx4 v[120:123], v240, s[28:31], s58 offen offset:2048 sc1
    ds_read_b64_tr_b16 v[168:169], v241 offset:24832
    ds_read_b64_tr_b16 v[170:171], v241 offset:25856
    v_mfma_f32_32x32x16_bf16 v[144:159], v[172:175], v[88:91], v[144:159]
    v_cvt_pk_bf16_f32 v193, v193, v193
    ds_read_b64_tr_b16 v[172:173], v241 offset:57600
    ds_read_b64_tr_b16 v[174:175], v241 offset:58624
    v_and_b32 v193, 0xffff0000, v193
    s_waitcnt vmcnt(7) lgkmcnt(8)
    v_mfma_f32_32x32x16_bf16 v[128:143], v[176:179], v[92:95], v[128:143]
    buffer_load_dwordx4 v[124:127], v240, s[28:31], s58 offen offset:3072 sc1
    ds_read_b64_tr_b16 v[176:177], v241 offset:25088
    ds_read_b64_tr_b16 v[178:179], v241 offset:26112
    v_mfma_f32_32x32x16_bf16 v[144:159], v[180:183], v[92:95], v[144:159]
    v_rcp_f32_e64 v245, v193
    ds_read_b64_tr_b16 v[180:181], v241 offset:57856
    ds_read_b64_tr_b16 v[182:183], v241 offset:58880
    v_mov_b32 v226, v246
    s_waitcnt vmcnt(7) lgkmcnt(8)
    v_mfma_f32_32x32x16_bf16 v[128:143], v[160:163], v[96:99], v[128:143]
    s_add_u32 m0, s98, 98304
    s_add_u32 s55, s61, 0
    buffer_load_dwordx4 v202, s[84:87], s55 offen lds
    ds_read_b64_tr_b16 v[160:161], v241 offset:25344
    ds_read_b64_tr_b16 v[162:163], v241 offset:26368
    v_mfma_f32_32x32x16_bf16 v[144:159], v[164:167], v[96:99], v[144:159]
    v_mul_f32 v244, 0x3fb8aa3b, v245
    ds_read_b64_tr_b16 v[164:165], v241 offset:58112
    ds_read_b64_tr_b16 v[166:167], v241 offset:59136
    v_mov_b32 v229, v246
    s_waitcnt vmcnt(7) lgkmcnt(8)
    v_mfma_f32_32x32x16_bf16 v[128:143], v[168:171], v[100:103], v[128:143]
    ds_read_b64_tr_b16 v[168:169], v241 offset:28672
    ds_read_b64_tr_b16 v[170:171], v241 offset:29696
    v_mfma_f32_32x32x16_bf16 v[144:159], v[172:175], v[100:103], v[144:159]
    ds_read_b64_tr_b16 v[172:173], v241 offset:61440
    ds_read_b64_tr_b16 v[174:175], v241 offset:62464
    s_waitcnt vmcnt(6) lgkmcnt(8)
    v_mfma_f32_32x32x8_bf16 v[128:143], v[224:225], v[226:227], v[128:143]
    v_mfma_f32_32x32x8_bf16 v[144:159], v[224:225], v[228:229], v[144:159]
    v_mfma_f32_32x32x16_bf16 v[128:143], v[176:179], v[104:107], v[128:143]
    s_add_u32 m0, s98, 99328
    s_add_u32 s55, s61, 49152
    buffer_load_dwordx4 v202, s[84:87], s55 offen lds
    ds_read_b64_tr_b16 v[176:177], v241 offset:28928
    ds_read_b64_tr_b16 v[178:179], v241 offset:29952
    v_mfma_f32_32x32x16_bf16 v[144:159], v[180:183], v[104:107], v[144:159]
    ds_read_b64_tr_b16 v[180:181], v241 offset:61696
    ds_read_b64_tr_b16 v[182:183], v241 offset:62720
    s_waitcnt vmcnt(6) lgkmcnt(8)
    v_mfma_f32_32x32x16_bf16 v[128:143], v[160:163], v[108:111], v[128:143]
    ds_read_b64_tr_b16 v[160:161], v241 offset:29184
    ds_read_b64_tr_b16 v[162:163], v241 offset:30208
    v_mfma_f32_32x32x16_bf16 v[144:159], v[164:167], v[108:111], v[144:159]
    ds_read_b64_tr_b16 v[164:165], v241 offset:61952
    ds_read_b64_tr_b16 v[166:167], v241 offset:62976
    s_waitcnt vmcnt(5) lgkmcnt(8)
    v_mfma_f32_32x32x16_bf16 v[128:143], v[168:171], v[112:115], v[128:143]
    s_add_u32 m0, s98, 100352
    s_add_u32 s55, s61, 98304
    buffer_load_dwordx4 v202, s[84:87], s55 offen lds
    ds_read_b64_tr_b16 v[168:169], v241 offset:29440
    ds_read_b64_tr_b16 v[170:171], v241 offset:30464
    v_mfma_f32_32x32x16_bf16 v[144:159], v[172:175], v[112:115], v[144:159]
    ds_read_b64_tr_b16 v[172:173], v241 offset:62208
    ds_read_b64_tr_b16 v[174:175], v241 offset:63232
    s_waitcnt vmcnt(5) lgkmcnt(8)
    v_mfma_f32_32x32x16_bf16 v[128:143], v[176:179], v[116:119], v[128:143]
    ds_read_b128 v[232:235], v243 offset:2368
    v_mfma_f32_32x32x16_bf16 v[144:159], v[180:183], v[116:119], v[144:159]
    ds_read_b128 v[236:239], v243 offset:2960
    s_waitcnt vmcnt(4) lgkmcnt(6)
    v_mfma_f32_32x32x16_bf16 v[128:143], v[160:163], v[120:123], v[128:143]
    s_add_u32 m0, s98, 101376
    s_add_u32 s55, s61, 147456
    buffer_load_dwordx4 v202, s[84:87], s55 offen lds
    v_mov_b32 v180, v202
    v_lshrrev_b32 v181, 7, v240
    v_mul_u32_u24 v181, 896, v181
    v_add_u32 v181, v181, v240
    v_mfma_f32_32x32x16_bf16 v[144:159], v[164:167], v[120:123], v[144:159]
    s_waitcnt vmcnt(4) lgkmcnt(2)
    v_mfma_f32_32x32x16_bf16 v[128:143], v[168:171], v[124:127], v[128:143]
    v_mfma_f32_32x32x16_bf16 v[144:159], v[172:175], v[124:127], v[144:159]
    s_sub_u32 s55, 0x180, s92
    s_and_b32 s55, s55, 0x380
    s_mul_i32 s56, s0, 4096
    s_add_u32 s55, s55, s56
    v_lshlrev_b32 v183, 6, v240
    s_mov_b64 exec, 0xf
    buffer_load_dword v183, v183, s[92:95], s55 offen
    s_mov_b64 exec, -1
    s_waitcnt lgkmcnt(0)
    s_nop 1
    v_cvt_pk_bf16_f32 v224, v128, v129
    v_cvt_pk_bf16_f32 v225, v130, v131
    v_cvt_pk_bf16_f32 v226, v132, v133
    v_cvt_pk_bf16_f32 v227, v134, v135
    v_cvt_pk_bf16_f32 v228, v136, v137
    v_cvt_pk_bf16_f32 v229, v138, v139
    v_mfma_f32_32x32x16_bf16 v[192:207], v[232:235], v[224:227], 0
    v_cvt_pk_bf16_f32 v230, v140, v141
    v_cvt_pk_bf16_f32 v231, v142, v143
    s_add_u32 m0, s98, 102400
    s_add_u32 s55, s61, 196608
    buffer_load_dwordx4 v180, s[84:87], s55 offen lds
    v_mul_f32 v144, v144, v245
    v_mul_f32 v145, v145, v245
    v_mul_f32 v146, v146, v245
    v_mul_f32 v147, v147, v245
    v_mfma_f32_32x32x16_bf16 v[192:207], v[236:239], v[228:231], v[192:207]
    v_mul_f32 v148, v148, v245
    v_mul_f32 v149, v149, v245
    v_mul_f32 v150, v150, v245
    v_mul_f32 v151, v151, v245
    v_cvt_pk_bf16_f32 v144, v144, v145
    v_cvt_pk_bf16_f32 v145, v146, v147
    v_cvt_pk_bf16_f32 v146, v148, v149
    v_cvt_pk_bf16_f32 v147, v150, v151
    ds_write_b128 v242, v[144:147] offset:16384
    s_add_u32 m0, s98, 103424
    s_add_u32 s55, s61, 245760
    buffer_load_dwordx4 v180, s[84:87], s55 offen lds
    v_mul_f32 v152, v152, v245
    v_mul_f32 v153, v153, v245
    v_mul_f32 v154, v154, v245
    v_mul_f32 v155, v155, v245
    v_mul_f32 v156, v156, v245
    v_mul_f32 v157, v157, v245
    v_mul_f32 v158, v158, v245
    v_mul_f32 v159, v159, v245
    v_cvt_pk_bf16_f32 v148, v152, v153
    v_cvt_pk_bf16_f32 v149, v154, v155
    v_cvt_pk_bf16_f32 v150, v156, v157
    v_cvt_pk_bf16_f32 v151, v158, v159
    ds_write_b128 v242, v[148:151] offset:16512
    v_max3_f32 v160, v192, v193, v194
    s_add_u32 m0, s98, 104448
    s_add_u32 s55, s61, 294912
    buffer_load_dwordx4 v180, s[84:87], s55 offen lds
    v_min3_f32 v161, v192, v193, v194
    v_max3_f32 v160, v160, v195, v196
    v_min3_f32 v161, v161, v195, v196
    v_max3_f32 v160, v160, v197, v198
    v_min3_f32 v161, v161, v197, v198
    v_max3_f32 v160, v160, v199, v200
    v_min3_f32 v161, v161, v199, v200
    v_max3_f32 v160, v160, v201, v202
    v_min3_f32 v161, v161, v201, v202
    v_max3_f32 v160, v160, v203, v204
    v_min3_f32 v161, v161, v203, v204
    v_max3_f32 v160, v160, v205, v206
    s_add_u32 m0, s98, 105472
    s_add_u32 s55, s61, 344064
    buffer_load_dwordx4 v180, s[84:87], s55 offen lds
    v_min3_f32 v161, v161, v205, v206
    v_max_f32 v160, v160, v207
    v_min_f32 v161, v161, v207
    v_pk_mul_f32 v[160:161], v[160:161], v[244:245] op_sel_hi:[1,0]
    v_pk_fma_f32 v[128:129], v[192:193], v[244:245], v[160:161] op_sel_hi:[1,0,0] neg_lo:[0,0,1] neg_hi:[0,0,1]
    v_pk_fma_f32 v[130:131], v[194:195], v[244:245], v[160:161] op_sel_hi:[1,0,0] neg_lo:[0,0,1] neg_hi:[0,0,1]
    v_pk_fma_f32 v[132:133], v[196:197], v[244:245], v[160:161] op_sel_hi:[1,0,0] neg_lo:[0,0,1] neg_hi:[0,0,1]
    v_pk_fma_f32 v[134:135], v[198:199], v[244:245], v[160:161] op_sel_hi:[1,0,0] neg_lo:[0,0,1] neg_hi:[0,0,1]
    v_pk_fma_f32 v[136:137], v[200:201], v[244:245], v[160:161] op_sel_hi:[1,0,0] neg_lo:[0,0,1] neg_hi:[0,0,1]
    v_pk_fma_f32 v[138:139], v[202:203], v[244:245], v[160:161] op_sel_hi:[1,0,0] neg_lo:[0,0,1] neg_hi:[0,0,1]
    v_pk_fma_f32 v[140:141], v[204:205], v[244:245], v[160:161] op_sel_hi:[1,0,0] neg_lo:[0,0,1] neg_hi:[0,0,1]
    v_pk_fma_f32 v[142:143], v[206:207], v[244:245], v[160:161] op_sel_hi:[1,0,0] neg_lo:[0,0,1] neg_hi:[0,0,1]
    v_exp_f32 v128, v128
    s_xor_b32 s55, s62, 0
    buffer_load_dwordx4 a[192:195], v181, s[92:95], s55 offen
    v_exp_f32 v129, v129
    v_exp_f32 v130, v130
    v_exp_f32 v131, v131
    v_exp_f32 v132, v132
    v_exp_f32 v133, v133
    v_exp_f32 v134, v134
    v_exp_f32 v135, v135
    v_exp_f32 v136, v136
    v_exp_f32 v137, v137
    v_exp_f32 v138, v138
    v_exp_f32 v139, v139
    v_exp_f32 v140, v140
    s_xor_b32 s55, s62, 32768
    buffer_load_dwordx4 a[196:199], v181, s[92:95], s55 offen
    v_exp_f32 v141, v141
    v_exp_f32 v142, v142
    v_exp_f32_e64 v143, v143
    v_pk_add_f32 v[162:163], v[128:129], v[130:131]
    v_pk_add_f32 v[162:163], v[162:163], v[132:133]
    v_pk_add_f32 v[162:163], v[162:163], v[134:135]
    v_pk_add_f32 v[162:163], v[162:163], v[136:137]
    v_pk_add_f32 v[162:163], v[162:163], v[138:139]
    v_pk_add_f32 v[162:163], v[162:163], v[140:141]
    v_pk_add_f32 v[162:163], v[162:163], v[142:143]
    v_add_f32 v162, v162, v163
    v_rcp_f32_e64 v162, v162
    s_nop 0
    v_pk_mul_f32 v[128:129], v[128:129], v[162:163] op_sel_hi:[1,0]
    s_xor_b32 s55, s62, 65536
    buffer_load_dwordx4 a[200:203], v181, s[92:95], s55 offen
    v_pk_mul_f32 v[130:131], v[130:131], v[162:163] op_sel_hi:[1,0]
    v_pk_mul_f32 v[132:133], v[132:133], v[162:163] op_sel_hi:[1,0]
    v_pk_mul_f32 v[134:135], v[134:135], v[162:163] op_sel_hi:[1,0]
    v_cvt_pk_bf16_f32 v224, v128, v129
    v_cvt_pk_bf16_f32 v225, v130, v131
    v_cvt_pk_bf16_f32 v226, v132, v133
    v_cvt_pk_bf16_f32 v227, v134, v135
    ds_write_b128 v242, v[224:227] offset:0
    v_pk_mul_f32 v[136:137], v[136:137], v[162:163] op_sel_hi:[1,0]
    v_pk_mul_f32 v[138:139], v[138:139], v[162:163] op_sel_hi:[1,0]
    v_pk_mul_f32 v[140:141], v[140:141], v[162:163] op_sel_hi:[1,0]
    v_pk_mul_f32 v[142:143], v[142:143], v[162:163] op_sel_hi:[1,0]
    v_cvt_pk_bf16_f32 v228, v136, v137
    s_xor_b32 s55, s62, 98304
    buffer_load_dwordx4 a[204:207], v181, s[92:95], s55 offen
    v_cvt_pk_bf16_f32 v229, v138, v139
    v_cvt_pk_bf16_f32 v230, v140, v141
    v_cvt_pk_bf16_f32 v231, v142, v143
    ds_write_b128 v242, v[228:231] offset:128
    v_pk_fma_f32 v[192:193], v[192:193], v[244:245], v[160:161] op_sel:[0,0,1] op_sel_hi:[1,0,1] neg_lo:[1,0,0] neg_hi:[1,0,0]
    v_pk_fma_f32 v[194:195], v[194:195], v[244:245], v[160:161] op_sel:[0,0,1] op_sel_hi:[1,0,1] neg_lo:[1,0,0] neg_hi:[1,0,0]
    v_pk_fma_f32 v[196:197], v[196:197], v[244:245], v[160:161] op_sel:[0,0,1] op_sel_hi:[1,0,1] neg_lo:[1,0,0] neg_hi:[1,0,0]
    v_pk_fma_f32 v[198:199], v[198:199], v[244:245], v[160:161] op_sel:[0,0,1] op_sel_hi:[1,0,1] neg_lo:[1,0,0] neg_hi:[1,0,0]
    v_pk_fma_f32 v[200:201], v[200:201], v[244:245], v[160:161] op_sel:[0,0,1] op_sel_hi:[1,0,1] neg_lo:[1,0,0] neg_hi:[1,0,0]
    v_pk_fma_f32 v[202:203], v[202:203], v[244:245], v[160:161] op_sel:[0,0,1] op_sel_hi:[1,0,1] neg_lo:[1,0,0] neg_hi:[1,0,0]
    v_pk_fma_f32 v[204:205], v[204:205], v[244:245], v[160:161] op_sel:[0,0,1] op_sel_hi:[1,0,1] neg_lo:[1,0,0] neg_hi:[1,0,0]
    v_pk_fma_f32 v[206:207], v[206:207], v[244:245], v[160:161] op_sel:[0,0,1] op_sel_hi:[1,0,1] neg_lo:[1,0,0] neg_hi:[1,0,0]
    v_exp_f32 v192, v192
    v_exp_f32 v193, v193
    s_xor_b32 s55, s62, 131072
    buffer_load_dwordx4 a[208:211], v181, s[92:95], s55 offen
    v_exp_f32 v194, v194
    v_exp_f32 v195, v195
    v_exp_f32 v196, v196
    v_exp_f32 v197, v197
    v_exp_f32 v198, v198
    v_exp_f32 v199, v199
    v_exp_f32 v200, v200
    v_exp_f32 v201, v201
    v_exp_f32 v202, v202
    v_exp_f32 v203, v203
    v_exp_f32 v204, v204
    v_exp_f32 v205, v205
    s_xor_b32 s55, s62, 163840
    buffer_load_dwordx4 a[212:215], v181, s[92:95], s55 offen
    v_exp_f32 v206, v206
    v_exp_f32 v207, v207
    v_pk_add_f32 v[164:165], v[192:193], v[194:195]
    v_pk_add_f32 v[164:165], v[164:165], v[196:197]
    v_pk_add_f32 v[164:165], v[164:165], v[198:199]
    v_pk_add_f32 v[164:165], v[164:165], v[200:201]
    v_pk_add_f32 v[164:165], v[164:165], v[202:203]
    v_pk_add_f32 v[164:165], v[164:165], v[204:205]
    v_pk_add_f32 v[164:165], v[164:165], v[206:207]
    v_add_f32 v164, v164, v165
    v_rcp_f32_e64 v164, v164
    s_nop 0
    v_pk_mul_f32 v[192:193], v[192:193], v[164:165] op_sel_hi:[1,0]
    v_pk_mul_f32 v[194:195], v[194:195], v[164:165] op_sel_hi:[1,0]
    v_pk_mul_f32 v[196:197], v[196:197], v[164:165] op_sel_hi:[1,0]
    v_pk_mul_f32 v[198:199], v[198:199], v[164:165] op_sel_hi:[1,0]
    v_cvt_pk_bf16_f32 v232, v192, v193
    v_cvt_pk_bf16_f32 v233, v194, v195
    v_cvt_pk_bf16_f32 v234, v196, v197
    v_cvt_pk_bf16_f32 v235, v198, v199
    ds_write_b128 v242, v[232:235] offset:8192
    v_pk_mul_f32 v[200:201], v[200:201], v[164:165] op_sel_hi:[1,0]
    v_pk_mul_f32 v[202:203], v[202:203], v[164:165] op_sel_hi:[1,0]
    v_pk_mul_f32 v[204:205], v[204:205], v[164:165] op_sel_hi:[1,0]
    v_pk_mul_f32 v[206:207], v[206:207], v[164:165] op_sel_hi:[1,0]
    v_cvt_pk_bf16_f32 v236, v200, v201
    v_cvt_pk_bf16_f32 v237, v202, v203
    v_cvt_pk_bf16_f32 v238, v204, v205
    v_cvt_pk_bf16_f32 v239, v206, v207
    ds_write_b128 v242, v[236:239] offset:8320
    v_mov_b32 v128, 0x3f803f80
    v_mov_b32 v129, 0x3f803f80
    v_mov_b32 v130, 0x3f803f80
    v_mov_b32 v131, 0x3f803f80
    s_waitcnt lgkmcnt(0)
    s_barrier
    ds_read_b64_tr_b16 v[192:193], v184 offset:0
    ds_read_b64_tr_b16 v[194:195], v184 offset:512
    ds_read_b64_tr_b16 v[224:225], v185 offset:0
    ds_read_b64_tr_b16 v[226:227], v185 offset:512
    ds_read_b64_tr_b16 v[196:197], v184 offset:1024
    ds_read_b64_tr_b16 v[198:199], v184 offset:1536
    ds_read_b64_tr_b16 v[228:229], v185 offset:1024
    ds_read_b64_tr_b16 v[230:231], v185 offset:1536
    s_waitcnt lgkmcnt(4)
    v_mfma_f32_16x16x32_bf16 v[152:155], v[192:195], v[224:227], 0
    ds_read_b64_tr_b16 v[200:201], v184 offset:2048
    ds_read_b64_tr_b16 v[202:203], v184 offset:2560
    v_mfma_f32_16x16x32_bf16 v[156:159], v[192:195], v[128:131], 0
    ds_read_b64_tr_b16 v[232:233], v185 offset:2048
    ds_read_b64_tr_b16 v[234:235], v185 offset:2560
    s_waitcnt lgkmcnt(4)
    v_mfma_f32_16x16x32_bf16 v[152:155], v[196:199], v[228:231], v[152:155]
    ds_read_b64_tr_b16 v[204:205], v184 offset:3072
    ds_read_b64_tr_b16 v[206:207], v184 offset:3584
    v_mfma_f32_16x16x32_bf16 v[156:159], v[196:199], v[128:131], v[156:159]
    ds_read_b64_tr_b16 v[236:237], v185 offset:3072
    ds_read_b64_tr_b16 v[238:239], v185 offset:3584
    s_waitcnt lgkmcnt(4)
    v_mfma_f32_16x16x32_bf16 v[152:155], v[200:203], v[232:235], v[152:155]
    v_mfma_f32_16x16x32_bf16 v[156:159], v[200:203], v[128:131], v[156:159]
    s_waitcnt lgkmcnt(0)
    v_mfma_f32_16x16x32_bf16 v[152:155], v[204:207], v[236:239], v[152:155]
    v_mfma_f32_16x16x32_bf16 v[156:159], v[204:207], v[128:131], v[156:159]
    s_nop 5
    s_nop 0
    v_cvt_pk_bf16_f32 v148, v152, v153
    v_cvt_pk_bf16_f32 v149, v154, v155
    v_cvt_pk_bf16_f32 v150, v152, v153
    v_cvt_pk_bf16_f32 v151, v154, v155
    v_min_u32 v156, -2, v156
    v_permlane16_swap_b32 v148, v150
    v_permlane16_swap_b32 v149, v151
    v_min_u32 v148, -2, v148
    s_mov_b64 exec, s[96:97]
    buffer_store_dwordx4 v[148:151], v186, s[24:27], s49 offen sc1
    s_mov_b64 exec, s[10:11]
    buffer_store_dwordx4 v[156:159], v187, s[24:27], s49 offen sc1
    s_mov_b64 exec, -1
    s_waitcnt vmcnt(8)
    s_barrier
    v_add_u32 v147, 0x18000, v241
    ds_read_b64_tr_b16 v[160:161], v147 offset:0
    ds_read_b64_tr_b16 v[162:163], v147 offset:1024
    ds_read_b64_tr_b16 v[164:165], v147 offset:256
    ds_read_b64_tr_b16 v[166:167], v147 offset:1280
    ds_read_b64_tr_b16 v[168:169], v147 offset:512
    ds_read_b64_tr_b16 v[170:171], v147 offset:1536
    ds_read_b64_tr_b16 v[172:173], v147 offset:768
    ds_read_b64_tr_b16 v[174:175], v147 offset:1792
    ds_read_b64_tr_b16 v[176:177], v147 offset:4096
    ds_read_b64_tr_b16 v[178:179], v147 offset:5120
    v_and_b32 v224, 0x1f0, v240
    v_add_u32 v224, 0x27a60, v224
    ds_read_b128 v[224:227], v224
    s_add_u32 s57, s98, 98304
    v_add_u32 v194, s57, v240
    ds_read_b128 v[232:235], v194 offset:0
    ds_read_b128 v[236:239], v194 offset:1024
    s_waitcnt lgkmcnt(11)
    v_mfma_f32_32x32x16_bf16 v[128:143], v[160:163], v[0:3], 0
    s_xor_b32 s55, s62, 196608
    buffer_load_dwordx4 a[216:219], v181, s[92:95], s55 offen
    ds_read_b64_tr_b16 v[160:161], v147 offset:4352
    ds_read_b64_tr_b16 v[162:163], v147 offset:5376
    s_waitcnt lgkmcnt(3)
    v_mfma_f32_16x16x32_bf16 v[228:231], v[224:227], v[232:235], 0
    ds_read_b128 v[232:235], v194 offset:2048
    s_lshl_b32 s57, s36, 2
    s_add_u32 s57, s57, 161888
    v_mfma_f32_32x32x16_bf16 v[128:143], v[164:167], v[4:7], v[128:143]
    ds_read_b64_tr_b16 v[164:165], v147 offset:4608
    ds_read_b64_tr_b16 v[166:167], v147 offset:5632
    s_waitcnt lgkmcnt(5)
    v_mfma_f32_16x16x32_bf16 v[228:231], v[224:227], v[236:239], v[228:231]
    ds_read_b128 v[236:239], v194 offset:3072
    v_lshrrev_b32 v192, 9, v240
    v_lshl_add_u32 v192, v192, 5, s57
    v_mfma_f32_32x32x16_bf16 v[128:143], v[168:171], v[8:11], v[128:143]
    s_xor_b32 s55, s62, 229376
    buffer_load_dwordx4 a[220:223], v181, s[92:95], s55 offen
    ds_read_b64_tr_b16 v[168:169], v147 offset:4864
    ds_read_b64_tr_b16 v[170:171], v147 offset:5888
    s_waitcnt lgkmcnt(5)
    v_mfma_f32_16x16x32_bf16 v[228:231], v[224:227], v[232:235], v[228:231]
    ds_read_b128 v[232:235], v194 offset:4096
    v_bfe_u32 v193, v240, 4, 1
    v_lshl_add_u32 v192, v193, 8, v192
    v_mfma_f32_32x32x16_bf16 v[128:143], v[172:175], v[12:15], v[128:143]
    ds_read_b64_tr_b16 v[172:173], v147 offset:8192
    ds_read_b64_tr_b16 v[174:175], v147 offset:9216
    s_waitcnt lgkmcnt(5)
    v_mfma_f32_16x16x32_bf16 v[228:231], v[224:227], v[236:239], v[228:231]
    ds_read_b128 v[236:239], v194 offset:5120
    v_bfe_u32 v193, v240, 8, 1
    v_lshl_add_u32 v192, v193, 7, v192
    v_mfma_f32_32x32x16_bf16 v[128:143], v[176:179], v[16:19], v[128:143]
    s_xor_b32 s55, s62, 262144
    buffer_load_dwordx4 a[224:227], v181, s[92:95], s55 offen
    ds_read_b64_tr_b16 v[176:177], v147 offset:8448
    ds_read_b64_tr_b16 v[178:179], v147 offset:9472
    s_waitcnt lgkmcnt(5)
    v_mfma_f32_16x16x32_bf16 v[228:231], v[224:227], v[232:235], v[228:231]
    ds_read_b128 v[232:235], v194 offset:6144
    v_bfe_u32 v193, v240, 5, 1
    v_lshl_add_u32 v192, v193, 6, v192
    v_mfma_f32_32x32x16_bf16 v[128:143], v[160:163], v[20:23], v[128:143]
    ds_read_b64_tr_b16 v[160:161], v147 offset:8704
    ds_read_b64_tr_b16 v[162:163], v147 offset:9728
    s_waitcnt lgkmcnt(5)
    v_mfma_f32_16x16x32_bf16 v[228:231], v[224:227], v[236:239], v[228:231]
    ds_read_b128 v[236:239], v194 offset:7168
    v_mfma_f32_32x32x16_bf16 v[128:143], v[164:167], v[24:27], v[128:143]
    ds_read_b64_tr_b16 v[164:165], v147 offset:8960
    ds_read_b64_tr_b16 v[166:167], v147 offset:9984
    s_waitcnt lgkmcnt(5)
    v_mfma_f32_16x16x32_bf16 v[228:231], v[224:227], v[232:235], v[228:231]
    v_mfma_f32_32x32x16_bf16 v[128:143], v[168:171], v[28:31], v[128:143]
    s_xor_b32 s55, s62, 294912
    buffer_load_dwordx4 a[228:231], v181, s[92:95], s55 offen
    ds_read_b64_tr_b16 v[168:169], v147 offset:12288
    ds_read_b64_tr_b16 v[170:171], v147 offset:13312
    s_waitcnt lgkmcnt(4)
    v_mfma_f32_16x16x32_bf16 v[228:231], v[224:227], v[236:239], v[228:231]
    v_mfma_f32_32x32x16_bf16 v[128:143], v[172:175], v[32:35], v[128:143]
    ds_read_b64_tr_b16 v[172:173], v147 offset:12544
    ds_read_b64_tr_b16 v[174:175], v147 offset:13568
    v_mov_b32 v204, -1
    v_mov_b32 v205, -1
    v_mov_b32 v206, -1
    v_mov_b32 v207, -1
    v_mfma_f32_32x32x16_bf16 v[128:143], v[176:179], v[36:39], v[128:143]
    s_xor_b32 s55, s62, 327680
    buffer_load_dwordx4 a[232:235], v181, s[92:95], s55 offen
    ds_read_b64_tr_b16 v[176:177], v147 offset:12800
    ds_read_b64_tr_b16 v[178:179], v147 offset:13824
    s_add_u32 s57, s49, 1179648
    s_mov_b64 exec, s[96:97]
    buffer_store_dwordx4 v[204:207], v186, s[24:27], s57 offen sc1
    s_mov_b64 exec, s[10:11]
    buffer_store_dwordx4 v[204:207], v187, s[24:27], s57 offen sc1
    s_mov_b64 exec, -1
    v_mfma_f32_32x32x16_bf16 v[128:143], v[160:163], v[40:43], v[128:143]
    ds_read_b64_tr_b16 v[160:161], v147 offset:13056
    ds_read_b64_tr_b16 v[162:163], v147 offset:14080
    v_permlane32_swap_b32 v228, v230
    s_waitcnt lgkmcnt(8)
    v_mfma_f32_32x32x16_bf16 v[128:143], v[164:167], v[44:47], v[128:143]
    ds_read_b64_tr_b16 v[164:165], v147 offset:16384
    ds_read_b64_tr_b16 v[166:167], v147 offset:17408
    v_permlane32_swap_b32 v229, v231
    s_waitcnt lgkmcnt(8)
    v_mfma_f32_32x32x16_bf16 v[128:143], v[168:171], v[48:51], v[128:143]
    s_xor_b32 s55, s62, 360448
    buffer_load_dwordx4 a[236:239], v181, s[92:95], s55 offen
    ds_read_b64_tr_b16 v[168:169], v147 offset:16640
    ds_read_b64_tr_b16 v[170:171], v147 offset:17664
    v_add_f32 v228, v228, v230
    v_add_f32 v229, v229, v231
    s_waitcnt lgkmcnt(8)
    v_mfma_f32_32x32x16_bf16 v[128:143], v[172:175], v[52:55], v[128:143]
    ds_read_b64_tr_b16 v[172:173], v147 offset:16896
    ds_read_b64_tr_b16 v[174:175], v147 offset:17920
    v_add_f32 v228, v228, v228 row_ror:4
    v_add_f32 v229, v229, v229 row_ror:4
    s_waitcnt lgkmcnt(8)
    v_mfma_f32_32x32x16_bf16 v[128:143], v[176:179], v[56:59], v[128:143]
    s_xor_b32 s55, s62, 393216
    buffer_load_dwordx4 a[240:243], v181, s[92:95], s55 offen
    ds_read_b64_tr_b16 v[176:177], v147 offset:17152
    ds_read_b64_tr_b16 v[178:179], v147 offset:18176
    v_add_f32 v228, v228, v228 row_ror:8
    v_add_f32 v229, v229, v229 row_ror:8
    s_waitcnt lgkmcnt(8)
    v_mfma_f32_32x32x16_bf16 v[128:143], v[160:163], v[60:63], v[128:143]
    ds_read_b64_tr_b16 v[160:161], v147 offset:20480
    ds_read_b64_tr_b16 v[162:163], v147 offset:21504
    ds_write2_b32 v192, v228, v229 offset0:0 offset1:4
    s_waitcnt lgkmcnt(9)
    v_mfma_f32_32x32x16_bf16 v[128:143], v[164:167], v[64:67], v[128:143]
    s_xor_b32 s55, s62, 425984
    buffer_load_dwordx4 a[244:247], v181, s[92:95], s55 offen
    ds_read_b64_tr_b16 v[164:165], v147 offset:20736
    ds_read_b64_tr_b16 v[166:167], v147 offset:21760
    s_waitcnt lgkmcnt(9)
    v_mfma_f32_32x32x16_bf16 v[128:143], v[168:171], v[68:71], v[128:143]
    ds_read_b64_tr_b16 v[168:169], v147 offset:20992
    ds_read_b64_tr_b16 v[170:171], v147 offset:22016
    s_waitcnt lgkmcnt(9)
    v_mfma_f32_32x32x16_bf16 v[128:143], v[172:175], v[72:75], v[128:143]
    ds_read_b64_tr_b16 v[172:173], v147 offset:21248
    ds_read_b64_tr_b16 v[174:175], v147 offset:22272
    s_waitcnt lgkmcnt(6)
    s_barrier
    ds_read_b128 v[196:199], v254 offset:2560
    v_mfma_f32_32x32x16_bf16 v[128:143], v[176:179], v[76:79], v[128:143]
    s_xor_b32 s55, s62, 458752
    buffer_load_dwordx4 a[248:251], v181, s[92:95], s55 offen
    ds_read_b64_tr_b16 v[176:177], v147 offset:24576
    ds_read_b64_tr_b16 v[178:179], v147 offset:25600
    v_mfma_f32_32x32x16_bf16 v[128:143], v[160:163], v[80:83], v[128:143]
    ds_read_b64_tr_b16 v[160:161], v147 offset:24832
    ds_read_b64_tr_b16 v[162:163], v147 offset:25856
    s_waitcnt lgkmcnt(9)
    v_mfma_f32_32x32x16_bf16 v[128:143], v[164:167], v[84:87], v[128:143]
    s_xor_b32 s55, s62, 491520
L_pad3:
    s_cbranch_execz L_warmed0
    buffer_load_dwordx4 a[252:255], v181, s[92:95], s55 offen
    ds_read_b64_tr_b16 v[164:165], v147 offset:25088
    ds_read_b64_tr_b16 v[166:167], v147 offset:26112
    s_waitcnt lgkmcnt(6)
    v_mfma_f32_32x32x16_bf16 v[128:143], v[168:171], v[88:91], v[128:143]
    ds_read_b64_tr_b16 v[168:169], v147 offset:25344
    ds_read_b64_tr_b16 v[170:171], v147 offset:26368
    v_add_f32 v196, v196, v198
    v_add_f32 v197, v197, v199
    v_mfma_f32_32x32x16_bf16 v[128:143], v[172:175], v[92:95], v[128:143]
    ds_read_b64_tr_b16 v[172:173], v147 offset:28672
    ds_read_b64_tr_b16 v[174:175], v147 offset:29696
    v_add_f32 v196, v196, v197
    v_cvt_pk_bf16_f32 v197, v196, v196
    s_waitcnt lgkmcnt(8)
    v_mfma_f32_32x32x16_bf16 v[128:143], v[176:179], v[96:99], v[128:143]
    s_add_u32 s56, s49, 524288
    buffer_load_dwordx4 v[32:35], v240, s[24:27], s56 offen sc1
    ds_read_b64_tr_b16 v[176:177], v147 offset:28928
    ds_read_b64_tr_b16 v[178:179], v147 offset:29952
    v_and_b32 v197, 0xffff0000, v197
    v_sub_f32 v196, v196, v197
    s_waitcnt lgkmcnt(8)
    v_mfma_f32_32x32x16_bf16 v[128:143], v[160:163], v[100:103], v[128:143]
    s_add_u32 s56, s49, 0
    buffer_load_dwordx4 v[0:3], v240, s[24:27], s56 offen sc1
    ds_read_b64_tr_b16 v[160:161], v147 offset:29184
    ds_read_b64_tr_b16 v[162:163], v147 offset:30208
    v_cvt_pk_bf16_f32 v200, v197, v196
    v_mov_b32 v201, 0
    s_waitcnt lgkmcnt(8)
    v_mfma_f32_32x32x16_bf16 v[128:143], v[164:167], v[104:107], v[128:143]
    s_add_u32 s56, s49, 65536
    buffer_load_dwordx4 v[4:7], v240, s[24:27], s56 offen sc1
    ds_read_b64_tr_b16 v[164:165], v147 offset:29440
    ds_read_b64_tr_b16 v[166:167], v147 offset:30464
    v_mov_b32 v202, v246
    v_mov_b32 v203, 0
    s_waitcnt lgkmcnt(8)
    v_mfma_f32_32x32x16_bf16 v[128:143], v[168:171], v[108:111], v[128:143]
    s_add_u32 s56, s49, 131072
    buffer_load_dwordx4 v[8:11], v240, s[24:27], s56 offen sc1
    v_and_b32 v36, 0x1f0, v240
    v_add_u32 v36, 0x27a60, v36
    ds_read_b128 v[36:39], v36
    s_waitcnt lgkmcnt(7)
    v_mfma_f32_32x32x8_bf16 v[128:143], v[200:201], v[202:203], v[128:143]
    v_mfma_f32_32x32x16_bf16 v[128:143], v[172:175], v[112:115], v[128:143]
    s_add_u32 s56, s49, 196608
    buffer_load_dwordx4 v[12:15], v240, s[24:27], s56 offen sc1
    ds_read_b128 v[232:235], v243 offset:2368
    s_waitcnt lgkmcnt(6)
    v_mfma_f32_32x32x16_bf16 v[128:143], v[176:179], v[116:119], v[128:143]
    s_add_u32 s56, s49, 262144
    buffer_load_dwordx4 v[16:19], v240, s[24:27], s56 offen sc1
    ds_read_b128 v[236:239], v243 offset:2960
    s_waitcnt lgkmcnt(5)
    v_mfma_f32_32x32x16_bf16 v[128:143], v[160:163], v[120:123], v[128:143]
    s_add_u32 s56, s49, 327680
    buffer_load_dwordx4 v[20:23], v240, s[24:27], s56 offen sc1
    s_waitcnt lgkmcnt(3)
    v_mfma_f32_32x32x16_bf16 v[128:143], v[164:167], v[124:127], v[128:143]
    s_add_u32 s56, s49, 393216
    buffer_load_dwordx4 v[24:27], v240, s[24:27], s56 offen sc1
    s_add_u32 s56, s49, 458752
    buffer_load_dwordx4 v[28:31], v240, s[24:27], s56 offen sc1
    s_waitcnt vmcnt(19)
    ds_write_b128 v252, a[192:195] offset:0
    s_waitcnt lgkmcnt(1)
    s_nop 4
    v_cvt_pk_bf16_f32 v224, v128, v129
    v_cvt_pk_bf16_f32 v225, v130, v131
    v_cvt_pk_bf16_f32 v226, v132, v133
    v_cvt_pk_bf16_f32 v227, v134, v135
    v_cvt_pk_bf16_f32 v228, v136, v137
    v_cvt_pk_bf16_f32 v229, v138, v139
    v_mfma_f32_32x32x16_bf16 v[192:207], v[232:235], v[224:227], 0
    v_cvt_pk_bf16_f32 v230, v140, v141
    v_cvt_pk_bf16_f32 v231, v142, v143
    ds_write_b128 v252, a[196:199] offset:1024
    s_nop 0
    v_mfma_f32_32x32x16_bf16 v[192:207], v[236:239], v[228:231], v[192:207]
    ds_write_b128 v252, a[200:203] offset:2048
    ds_write_b128 v252, a[204:207] offset:3072
    s_nop 9
    v_max3_f32 v160, v192, v193, v194
    v_min3_f32 v161, v192, v193, v194
    v_max3_f32 v160, v160, v195, v196
    v_min3_f32 v161, v161, v195, v196
    v_max3_f32 v160, v160, v197, v198
    v_min3_f32 v161, v161, v197, v198
    v_max3_f32 v160, v160, v199, v200
    v_min3_f32 v161, v161, v199, v200
    v_max3_f32 v160, v160, v201, v202
    v_min3_f32 v161, v161, v201, v202
    ds_write_b128 v252, a[208:211] offset:4096
    v_max3_f32 v160, v160, v203, v204
    v_min3_f32 v161, v161, v203, v204
    v_max3_f32 v160, v160, v205, v206
    v_min3_f32 v161, v161, v205, v206
    v_max_f32 v160, v160, v207
    v_min_f32 v161, v161, v207
    v_pk_mul_f32 v[160:161], v[160:161], v[244:245] op_sel_hi:[1,0]
    v_pk_fma_f32 v[128:129], v[192:193], v[244:245], v[160:161] op_sel_hi:[1,0,0] neg_lo:[0,0,1] neg_hi:[0,0,1]
    v_pk_fma_f32 v[130:131], v[194:195], v[244:245], v[160:161] op_sel_hi:[1,0,0] neg_lo:[0,0,1] neg_hi:[0,0,1]
    v_pk_fma_f32 v[132:133], v[196:197], v[244:245], v[160:161] op_sel_hi:[1,0,0] neg_lo:[0,0,1] neg_hi:[0,0,1]
    ds_write_b128 v252, a[212:215] offset:5120
    v_pk_fma_f32 v[134:135], v[198:199], v[244:245], v[160:161] op_sel_hi:[1,0,0] neg_lo:[0,0,1] neg_hi:[0,0,1]
    v_pk_fma_f32 v[136:137], v[200:201], v[244:245], v[160:161] op_sel_hi:[1,0,0] neg_lo:[0,0,1] neg_hi:[0,0,1]
    v_pk_fma_f32 v[138:139], v[202:203], v[244:245], v[160:161] op_sel_hi:[1,0,0] neg_lo:[0,0,1] neg_hi:[0,0,1]
    v_pk_fma_f32 v[140:141], v[204:205], v[244:245], v[160:161] op_sel_hi:[1,0,0] neg_lo:[0,0,1] neg_hi:[0,0,1]
    v_pk_fma_f32 v[142:143], v[206:207], v[244:245], v[160:161] op_sel_hi:[1,0,0] neg_lo:[0,0,1] neg_hi:[0,0,1]
    v_exp_f32 v128, v128
    v_exp_f32 v129, v129
    v_exp_f32 v130, v130
    v_exp_f32 v131, v131
    v_exp_f32 v132, v132
    ds_write_b128 v252, a[216:219] offset:6144
    v_exp_f32 v133, v133
    v_exp_f32 v134, v134
    v_exp_f32 v135, v135
    v_exp_f32 v136, v136
    v_exp_f32 v137, v137
    v_exp_f32 v138, v138
    v_exp_f32 v139, v139
    v_exp_f32 v140, v140
    v_exp_f32 v141, v141
    v_exp_f32 v142, v142
    ds_write_b128 v252, a[220:223] offset:7168
    v_exp_f32 v143, v143
    v_pk_add_f32 v[162:163], v[128:129], v[130:131]
    v_pk_add_f32 v[162:163], v[162:163], v[132:133]
    v_pk_add_f32 v[162:163], v[162:163], v[134:135]
    v_pk_add_f32 v[162:163], v[162:163], v[136:137]
    v_pk_add_f32 v[162:163], v[162:163], v[138:139]
    v_pk_add_f32 v[162:163], v[162:163], v[140:141]
    v_pk_add_f32 v[162:163], v[162:163], v[142:143]
    v_add_f32_e64 v162, v162, v163
    v_cvt_pk_bf16_f32 v224, v128, v129
    v_cvt_pk_bf16_f32 v225, v130, v131
    v_cvt_pk_bf16_f32 v226, v132, v133
    v_cvt_pk_bf16_f32 v227, v134, v135
    v_cvt_pk_bf16_f32 v228, v136, v137
    v_cvt_pk_bf16_f32 v229, v138, v139
    v_cvt_pk_bf16_f32 v230, v140, v141
    v_cvt_pk_bf16_f32 v231, v142, v143
    v_pk_fma_f32 v[192:193], v[192:193], v[244:245], v[160:161] op_sel:[0,0,1] op_sel_hi:[1,0,1] neg_lo:[1,0,0] neg_hi:[1,0,0]
    v_pk_fma_f32 v[194:195], v[194:195], v[244:245], v[160:161] op_sel:[0,0,1] op_sel_hi:[1,0,1] neg_lo:[1,0,0] neg_hi:[1,0,0]
    v_pk_fma_f32 v[196:197], v[196:197], v[244:245], v[160:161] op_sel:[0,0,1] op_sel_hi:[1,0,1] neg_lo:[1,0,0] neg_hi:[1,0,0]
    v_pk_fma_f32 v[198:199], v[198:199], v[244:245], v[160:161] op_sel:[0,0,1] op_sel_hi:[1,0,1] neg_lo:[1,0,0] neg_hi:[1,0,0]
    v_pk_fma_f32 v[200:201], v[200:201], v[244:245], v[160:161] op_sel:[0,0,1] op_sel_hi:[1,0,1] neg_lo:[1,0,0] neg_hi:[1,0,0]
    v_pk_fma_f32 v[202:203], v[202:203], v[244:245], v[160:161] op_sel:[0,0,1] op_sel_hi:[1,0,1] neg_lo:[1,0,0] neg_hi:[1,0,0]
    v_pk_fma_f32 v[204:205], v[204:205], v[244:245], v[160:161] op_sel:[0,0,1] op_sel_hi:[1,0,1] neg_lo:[1,0,0] neg_hi:[1,0,0]
    v_pk_fma_f32 v[206:207], v[206:207], v[244:245], v[160:161] op_sel:[0,0,1] op_sel_hi:[1,0,1] neg_lo:[1,0,0] neg_hi:[1,0,0]
    v_exp_f32 v192, v192
    v_exp_f32 v193, v193
    v_exp_f32 v194, v194
    v_exp_f32 v195, v195
    v_exp_f32 v196, v196
    v_exp_f32 v197, v197
    v_exp_f32 v198, v198
    v_exp_f32 v199, v199
    v_exp_f32 v200, v200
    v_exp_f32 v201, v201
    v_exp_f32 v202, v202
    v_exp_f32 v203, v203
    v_exp_f32 v204, v204
    v_exp_f32 v205, v205
    v_exp_f32 v206, v206
    v_exp_f32 v207, v207
    v_pk_add_f32 v[164:165], v[192:193], v[194:195]
    v_pk_add_f32 v[164:165], v[164:165], v[196:197]
    v_pk_add_f32 v[164:165], v[164:165], v[198:199]
    v_pk_add_f32 v[164:165], v[164:165], v[200:201]
    v_pk_add_f32 v[164:165], v[164:165], v[202:203]
    v_pk_add_f32 v[164:165], v[164:165], v[204:205]
    v_pk_add_f32 v[164:165], v[164:165], v[206:207]
    v_add_f32 v164, v164, v165
    v_rcp_f32 v164, v164
    v_mul_f32 v166, 0x358637bd, v162
    v_mul_f32_e64 v164, v164, v162
    v_pk_mul_f32 v[192:193], v[192:193], v[164:165] op_sel_hi:[1,0]
    v_pk_mul_f32 v[194:195], v[194:195], v[164:165] op_sel_hi:[1,0]
    v_pk_mul_f32 v[196:197], v[196:197], v[164:165] op_sel_hi:[1,0]
    v_pk_mul_f32 v[198:199], v[198:199], v[164:165] op_sel_hi:[1,0]
    v_cvt_pk_bf16_f32 v232, v192, v193
    v_cvt_pk_bf16_f32 v233, v194, v195
    v_cvt_pk_bf16_f32 v234, v196, v197
    v_cvt_pk_bf16_f32 v235, v198, v199
    v_pk_mul_f32 v[200:201], v[200:201], v[164:165] op_sel_hi:[1,0]
    v_pk_mul_f32 v[202:203], v[202:203], v[164:165] op_sel_hi:[1,0]
    v_pk_mul_f32 v[204:205], v[204:205], v[164:165] op_sel_hi:[1,0]
    v_pk_mul_f32 v[206:207], v[206:207], v[164:165] op_sel_hi:[1,0]
    v_cvt_pk_bf16_f32 v236, v200, v201
    v_cvt_pk_bf16_f32 v237, v202, v203
    v_cvt_pk_bf16_f32 v238, v204, v205
    v_cvt_pk_bf16_f32 v239, v206, v207
    v_xor_b32 v176, 32, v251
    v_xor_b32 v177, 64, v251
    v_xor_b32 v178, 96, v251
    s_add_u32 s1, s50, 32
    v_mov_b32_e64 v179, s1
L_chk1:
    s_waitcnt vmcnt(6)
    v_mfma_f32_16x16x32_bf16 v[40:43], v[36:39], v[0:3], 0
    v_max3_u32 v44, v32, v0, v4
    v_permlane16_swap_b32 v32, v33
    v_mfma_f32_16x16x32_bf16 v[40:43], v[36:39], v[4:7], v[40:43]
    v_permlane16_swap_b32 v34, v35
    s_waitcnt vmcnt(4)
    v_mfma_f32_16x16x32_bf16 v[40:43], v[36:39], v[8:11], v[40:43]
    v_add_f32 v32, v32, v33
    v_add_f32_e64 v34, v34, v35
    v_mfma_f32_16x16x32_bf16 v[40:43], v[36:39], v[12:15], v[40:43]
    v_max3_u32 v44, v44, v8, v12
    v_permlane32_swap_b32 v32, v34
    s_waitcnt vmcnt(2)
    v_mfma_f32_16x16x32_bf16 v[40:43], v[36:39], v[16:19], v[40:43]
    v_add_f32_e64 v32, v32, v34
    v_max3_u32 v44, v44, v16, v20
    v_mfma_f32_16x16x32_bf16 v[40:43], v[36:39], v[20:23], v[40:43]
    v_add_f32 v32, v32, v32 row_ror:4
    s_waitcnt vmcnt(0)
    v_mfma_f32_16x16x32_bf16 v[40:43], v[36:39], v[24:27], v[40:43]
    v_add_f32 v32, v32, v32 row_ror:8
    v_max3_u32 v44, v44, v24, v28
    v_mfma_f32_16x16x32_bf16 v[40:43], v[36:39], v[28:31], v[40:43]
    v_cmp_eq_u32 vcc, -1, v44
    v_cvt_pk_bf16_f32 v32, v32, v32
    ds_write_b16 v189, v32
    s_cbranch_vccnz L_again1
    s_nop 3
    v_cvt_pk_bf16_f32 v40, v40, v41
    v_cvt_pk_bf16_f32 v41, v42, v43
    ds_write_b64 v188, v[40:41]
    s_waitcnt lgkmcnt(0)
    s_barrier
    ds_read_b128 v[0:3], v243 offset:0
    ds_read_b128 v[4:7], v243 offset:592
    ds_read_b128 v[8:11], v243 offset:1184
    s_waitcnt lgkmcnt(2)
    v_mfma_f32_32x32x16_bf16 v[144:159], v[0:3], v[224:227], 0
    ds_read_b128 v[12:15], v243 offset:1776
    ds_read_b128 v[16:19], v190 offset:0
    s_waitcnt lgkmcnt(3)
    v_mfma_f32_32x32x16_bf16 v[144:159], v[4:7], v[228:231], v[144:159]
    ds_read_b128 v[20:23], v190 offset:16
    ds_read_b128 v[24:27], v190 offset:64
    s_waitcnt lgkmcnt(4)
    v_mfma_f32_32x32x16_bf16 v[144:159], v[8:11], v[232:235], v[144:159]
    ds_read_b128 v[28:31], v190 offset:80
    s_waitcnt lgkmcnt(4)
    v_mfma_f32_32x32x16_bf16 v[144:159], v[12:15], v[236:239], v[144:159]
    s_waitcnt lgkmcnt(0)
    v_dot2c_f32_bf16 v166, v16, v224
    v_dot2c_f32_bf16 v166, v17, v225
    v_dot2c_f32_bf16 v166, v18, v226
    v_dot2c_f32_bf16 v166, v19, v227
    v_dot2c_f32_bf16 v166, v20, v228
    v_dot2c_f32_bf16 v166, v21, v229
    v_dot2c_f32_bf16 v166, v22, v230
    v_dot2c_f32_bf16 v166, v23, v231
    v_dot2c_f32_bf16 v166, v24, v232
    v_dot2c_f32_bf16 v166, v25, v233
    v_dot2c_f32_bf16 v166, v26, v234
    v_dot2c_f32_bf16 v166, v27, v235
    v_dot2c_f32_bf16 v166, v28, v236
    v_dot2c_f32_bf16 v166, v29, v237
    v_dot2c_f32_bf16 v166, v30, v238
    v_dot2c_f32_bf16 v166, v31, v239
    s_nop 2
    v_rcp_f32_e64 v166, v166
    s_cmp_eq_u32 s51, 0
    s_cbranch_scc0 L_glob_27
    v_pk_mul_f32 v[144:145], v[144:145], v[166:167] op_sel_hi:[1,0]
    v_pk_mul_f32 v[146:147], v[146:147], v[166:167] op_sel_hi:[1,0]
    v_pk_mul_f32 v[148:149], v[148:149], v[166:167] op_sel_hi:[1,0]
    v_pk_mul_f32 v[150:151], v[150:151], v[166:167] op_sel_hi:[1,0]
    v_cvt_pk_bf16_f32 v192, v144, v145
    v_cvt_pk_bf16_f32 v193, v146, v147
    v_cvt_pk_bf16_f32 v194, v148, v149
    v_cvt_pk_bf16_f32 v195, v150, v151
    buffer_store_dwordx4 v[192:195], v191, s[24:27], s42 offen offset:0
    v_pk_mul_f32 v[152:153], v[152:153], v[166:167] op_sel_hi:[1,0]
    v_pk_mul_f32 v[154:155], v[154:155], v[166:167] op_sel_hi:[1,0]
    v_pk_mul_f32 v[156:157], v[156:157], v[166:167] op_sel_hi:[1,0]
    v_pk_mul_f32 v[158:159], v[158:159], v[166:167] op_sel_hi:[1,0]
    v_cvt_pk_bf16_f32 v196, v152, v153
    v_cvt_pk_bf16_f32 v197, v154, v155
    v_cvt_pk_bf16_f32 v198, v156, v157
    v_cvt_pk_bf16_f32 v199, v158, v159
    buffer_store_dwordx4 v[196:199], v191, s[24:27], s42 offen offset:256
L_join_28:
    ds_read_b64_tr_b16 v[64:65], v251 offset:0
    ds_read_b64_tr_b16 v[66:67], v251 offset:512
    ds_read_b64_tr_b16 v[68:69], v176 offset:16384
    ds_read_b64_tr_b16 v[70:71], v176 offset:16896
    ds_read_b64_tr_b16 v[72:73], v177 offset:32768
    ds_read_b64_tr_b16 v[74:75], v177 offset:33280
    ds_read_b64_tr_b16 v[76:77], v178 offset:49152
    ds_read_b64_tr_b16 v[78:79], v178 offset:49664
    ds_read_b64_tr_b16 v[80:81], v251 offset:1024
    ds_read_b64_tr_b16 v[82:83], v251 offset:1536
    ds_read_b64_tr_b16 v[84:85], v176 offset:17408
    ds_read_b64_tr_b16 v[86:87], v176 offset:17920
    ds_read_b64_tr_b16 v[88:89], v177 offset:33792
    ds_read_b64_tr_b16 v[90:91], v177 offset:34304
    ds_read_b64_tr_b16 v[92:93], v178 offset:50176
    ds_read_b64_tr_b16 v[94:95], v178 offset:50688
    ds_read_b64_tr_b16 v[96:97], v251 offset:2048
    ds_read_b64_tr_b16 v[98:99], v251 offset:2560
    ds_read_b64_tr_b16 v[100:101], v176 offset:18432
    ds_read_b64_tr_b16 v[102:103], v176 offset:18944
    ds_read_b64_tr_b16 v[104:105], v177 offset:34816
    ds_read_b64_tr_b16 v[106:107], v177 offset:35328
    ds_read_b64_tr_b16 v[108:109], v178 offset:51200
    ds_read_b64_tr_b16 v[110:111], v178 offset:51712
    ds_read_b64_tr_b16 v[112:113], v251 offset:3072
    ds_read_b64_tr_b16 v[114:115], v251 offset:3584
    ds_read_b64_tr_b16 v[116:117], v176 offset:19456
    ds_read_b64_tr_b16 v[118:119], v176 offset:19968
    ds_read_b64_tr_b16 v[120:121], v177 offset:35840
    ds_read_b64_tr_b16 v[122:123], v177 offset:36352
    ds_read_b64_tr_b16 v[124:125], v178 offset:52224
    ds_read_b64_tr_b16 v[126:127], v178 offset:52736
    s_mov_b64 exec, 1
    s_cmp_eq_u32 s51, 0
    s_cbranch_scc0 L_glob_29
    s_waitcnt vmcnt(0)
    buffer_store_dword v179, off, s[24:27], s43
L_join_30:
    s_mov_b64 exec, -1
    s_branch L_overo1
L_moreo1:
    buffer_load_dword v234, v250, s[24:27], s45 offen offset:0 sc1
    s_sub_u32 s59, s59, 1
    s_cbranch_scc1 L_timeout
    s_waitcnt vmcnt(1)
    v_cmp_ne_u32_e64 vcc, s1, v235
    s_nop 0
    s_cbranch_vccz L_goo1
    s_branch L_spino1
L_overo1:
    ds_write_b128 v252, a[224:227] offset:8192
    ds_write_b128 v252, a[228:231] offset:9216
    ds_write_b128 v252, a[232:235] offset:10240
    ds_write_b128 v252, a[236:239] offset:11264
    s_mov_b64 exec, 0xffff
    buffer_load_dword v234, v250, s[24:27], s45 offen offset:0 sc1
    s_mov_b64 exec, -1
    ds_write_b128 v252, a[240:243] offset:12288
    ds_write_b128 v252, a[244:247] offset:13312
    ds_write_b128 v252, a[248:251] offset:14336
    ds_write_b128 v252, a[252:255] offset:15360
    s_mov_b64 exec, 0xffff
L_spino1:
    buffer_load_dword v235, v250, s[24:27], s45 offen offset:0 sc1
    s_waitcnt vmcnt(1)
    v_cmp_ne_u32 vcc, s1, v234
    s_nop 0
    s_cbranch_vccnz L_moreo1
L_goo1:
    s_mov_b64 exec, -1
    buffer_load_dwordx4 v[0:3], v240, s[24:27], s44 offen offset:0 sc1
    buffer_load_dwordx4 v[4:7], v240, s[24:27], s44 offen offset:1024 sc1
    buffer_load_dwordx4 v[8:11], v240, s[24:27], s44 offen offset:2048 sc1
    buffer_load_dwordx4 v[12:15], v240, s[24:27], s44 offen offset:3072 sc1
    s_waitcnt lgkmcnt(0)
    s_barrier
    ds_read_b64_tr_b16 v[128:129], v251 offset:4096
    ds_read_b64_tr_b16 v[130:131], v251 offset:4608
    ds_read_b64_tr_b16 v[132:133], v176 offset:20480
    ds_read_b64_tr_b16 v[134:135], v176 offset:20992
    ds_read_b64_tr_b16 v[136:137], v177 offset:36864
    ds_read_b64_tr_b16 v[138:139], v177 offset:37376
    s_xor_b32 s58, s44, 4096
    buffer_load_dwordx4 v[16:19], v240, s[24:27], s58 offen offset:0 sc1
    ds_read_b64_tr_b16 v[140:141], v178 offset:53248
    ds_read_b64_tr_b16 v[142:143], v178 offset:53760
    ds_read_b64_tr_b16 v[144:145], v251 offset:5120
    ds_read_b64_tr_b16 v[146:147], v251 offset:5632
    ds_read_b64_tr_b16 v[148:149], v176 offset:21504
    ds_read_b64_tr_b16 v[150:151], v176 offset:22016
    buffer_load_dwordx4 v[20:23], v240, s[24:27], s58 offen offset:1024 sc1
    ds_read_b64_tr_b16 v[152:153], v177 offset:37888
    ds_read_b64_tr_b16 v[154:155], v177 offset:38400
    ds_read_b64_tr_b16 v[156:157], v178 offset:54272
    ds_read_b64_tr_b16 v[158:159], v178 offset:54784
    ds_read_b64_tr_b16 v[160:161], v251 offset:6144
    ds_read_b64_tr_b16 v[162:163], v251 offset:6656
    buffer_load_dwordx4 v[24:27], v240, s[24:27], s58 offen offset:2048 sc1
    ds_read_b64_tr_b16 v[164:165], v176 offset:22528
    ds_read_b64_tr_b16 v[166:167], v176 offset:23040
    ds_read_b64_tr_b16 v[168:169], v177 offset:38912
    ds_read_b64_tr_b16 v[170:171], v177 offset:39424
    ds_read_b64_tr_b16 v[172:173], v178 offset:55296
    ds_read_b64_tr_b16 v[174:175], v178 offset:55808
    buffer_load_dwordx4 v[28:31], v240, s[24:27], s58 offen offset:3072 sc1
    s_waitcnt vmcnt(7)
    v_mfma_f32_16x16x32_bf16 v[208:211], v[64:67], v[0:3], v[208:211]
    s_xor_b32 s58, s44, 8192
    buffer_load_dwordx4 v[32:35], v240, s[24:27], s58 offen offset:0 sc1
    v_mfma_f32_16x16x32_bf16 v[212:215], v[68:71], v[0:3], v[212:215]
    ds_read_b64_tr_b16 v[64:65], v251 offset:7168
    ds_read_b64_tr_b16 v[66:67], v251 offset:7680
    v_mfma_f32_16x16x32_bf16 v[216:219], v[72:75], v[0:3], v[216:219]
    ds_read_b64_tr_b16 v[68:69], v176 offset:23552
    v_mfma_f32_16x16x32_bf16 v[220:223], v[76:79], v[0:3], v[220:223]
    ds_read_b64_tr_b16 v[70:71], v176 offset:24064
    s_waitcnt vmcnt(7)
    v_mfma_f32_16x16x32_bf16 v[208:211], v[80:83], v[4:7], v[208:211]
    buffer_load_dwordx4 v[36:39], v240, s[24:27], s58 offen offset:1024 sc1
    v_mfma_f32_16x16x32_bf16 v[212:215], v[84:87], v[4:7], v[212:215]
    ds_read_b64_tr_b16 v[72:73], v177 offset:39936
    ds_read_b64_tr_b16 v[74:75], v177 offset:40448
    v_mfma_f32_16x16x32_bf16 v[216:219], v[88:91], v[4:7], v[216:219]
    ds_read_b64_tr_b16 v[76:77], v178 offset:56320
    v_mfma_f32_16x16x32_bf16 v[220:223], v[92:95], v[4:7], v[220:223]
    ds_read_b64_tr_b16 v[78:79], v178 offset:56832
    s_waitcnt vmcnt(7)
    v_mfma_f32_16x16x32_bf16 v[208:211], v[96:99], v[8:11], v[208:211]
    buffer_load_dwordx4 v[40:43], v240, s[24:27], s58 offen offset:2048 sc1
    v_mfma_f32_16x16x32_bf16 v[212:215], v[100:103], v[8:11], v[212:215]
    ds_read_b64_tr_b16 v[80:81], v251 offset:8192
    ds_read_b64_tr_b16 v[82:83], v251 offset:8704
    v_mfma_f32_16x16x32_bf16 v[216:219], v[104:107], v[8:11], v[216:219]
    ds_read_b64_tr_b16 v[84:85], v176 offset:24576
    v_mfma_f32_16x16x32_bf16 v[220:223], v[108:111], v[8:11], v[220:223]
    ds_read_b64_tr_b16 v[86:87], v176 offset:25088
    s_waitcnt vmcnt(7)
    v_mfma_f32_16x16x32_bf16 v[208:211], v[112:115], v[12:15], v[208:211]
    buffer_load_dwordx4 v[44:47], v240, s[24:27], s58 offen offset:3072 sc1
    v_mfma_f32_16x16x32_bf16 v[212:215], v[116:119], v[12:15], v[212:215]
    ds_read_b64_tr_b16 v[88:89], v177 offset:40960
    ds_read_b64_tr_b16 v[90:91], v177 offset:41472
    v_mfma_f32_16x16x32_bf16 v[216:219], v[120:123], v[12:15], v[216:219]
    ds_read_b64_tr_b16 v[92:93], v178 offset:57344
    v_mfma_f32_16x16x32_bf16 v[220:223], v[124:127], v[12:15], v[220:223]
    ds_read_b64_tr_b16 v[94:95], v178 offset:57856
    s_waitcnt vmcnt(7) lgkmcnt(15)
    v_mfma_f32_16x16x32_bf16 v[208:211], v[128:131], v[16:19], v[208:211]
    s_xor_b32 s58, s44, 12288
    buffer_load_dwordx4 v[48:51], v240, s[24:27], s58 offen offset:0 sc1
    v_mfma_f32_16x16x32_bf16 v[212:215], v[132:135], v[16:19], v[212:215]
    ds_read_b64_tr_b16 v[96:97], v251 offset:9216
    ds_read_b64_tr_b16 v[98:99], v251 offset:9728
    v_mfma_f32_16x16x32_bf16 v[216:219], v[136:139], v[16:19], v[216:219]
    ds_read_b64_tr_b16 v[100:101], v176 offset:25600
    v_mfma_f32_16x16x32_bf16 v[220:223], v[140:143], v[16:19], v[220:223]
    ds_read_b64_tr_b16 v[102:103], v176 offset:26112
    s_waitcnt vmcnt(7)
    v_mfma_f32_16x16x32_bf16 v[208:211], v[144:147], v[20:23], v[208:211]
    buffer_load_dwordx4 v[52:55], v240, s[24:27], s58 offen offset:1024 sc1
    v_mfma_f32_16x16x32_bf16 v[212:215], v[148:151], v[20:23], v[212:215]
    ds_read_b64_tr_b16 v[104:105], v177 offset:41984
    ds_read_b64_tr_b16 v[106:107], v177 offset:42496
    v_mfma_f32_16x16x32_bf16 v[216:219], v[152:155], v[20:23], v[216:219]
    ds_read_b64_tr_b16 v[108:109], v178 offset:58368
    v_mfma_f32_16x16x32_bf16 v[220:223], v[156:159], v[20:23], v[220:223]
    ds_read_b64_tr_b16 v[110:111], v178 offset:58880
    s_waitcnt vmcnt(7)
    v_mfma_f32_16x16x32_bf16 v[208:211], v[160:163], v[24:27], v[208:211]
    buffer_load_dwordx4 v[56:59], v240, s[24:27], s58 offen offset:2048 sc1
    v_mfma_f32_16x16x32_bf16 v[212:215], v[164:167], v[24:27], v[212:215]
    ds_read_b64_tr_b16 v[112:113], v251 offset:10240
    ds_read_b64_tr_b16 v[114:115], v251 offset:10752
    v_mfma_f32_16x16x32_bf16 v[216:219], v[168:171], v[24:27], v[216:219]
    ds_read_b64_tr_b16 v[116:117], v176 offset:26624
    v_mfma_f32_16x16x32_bf16 v[220:223], v[172:175], v[24:27], v[220:223]
    ds_read_b64_tr_b16 v[118:119], v176 offset:27136
    s_waitcnt vmcnt(7) lgkmcnt(15)
    v_mfma_f32_16x16x32_bf16 v[208:211], v[64:67], v[28:31], v[208:211]
    buffer_load_dwordx4 v[60:63], v240, s[24:27], s58 offen offset:3072 sc1
    v_mfma_f32_16x16x32_bf16 v[212:215], v[68:71], v[28:31], v[212:215]
    ds_read_b64_tr_b16 v[120:121], v177 offset:43008
    ds_read_b64_tr_b16 v[122:123], v177 offset:43520
    v_mfma_f32_16x16x32_bf16 v[216:219], v[72:75], v[28:31], v[216:219]
    ds_read_b64_tr_b16 v[124:125], v178 offset:59392
    v_mfma_f32_16x16x32_bf16 v[220:223], v[76:79], v[28:31], v[220:223]
    ds_read_b64_tr_b16 v[126:127], v178 offset:59904
    s_waitcnt vmcnt(7) lgkmcnt(15)
    v_mfma_f32_16x16x32_bf16 v[208:211], v[80:83], v[32:35], v[208:211]
    ds_read_b64_tr_b16 v[128:129], v251 offset:11264
    ds_read_b64_tr_b16 v[130:131], v251 offset:11776
    v_mfma_f32_16x16x32_bf16 v[212:215], v[84:87], v[32:35], v[212:215]
    ds_read_b64_tr_b16 v[132:133], v176 offset:27648
    ds_read_b64_tr_b16 v[134:135], v176 offset:28160
    v_mfma_f32_16x16x32_bf16 v[216:219], v[88:91], v[32:35], v[216:219]
    ds_read_b64_tr_b16 v[136:137], v177 offset:44032
    ds_read_b64_tr_b16 v[138:139], v177 offset:44544
    v_mfma_f32_16x16x32_bf16 v[220:223], v[92:95], v[32:35], v[220:223]
    ds_read_b64_tr_b16 v[140:141], v178 offset:60416
    s_waitcnt vmcnt(6) lgkmcnt(15)
    v_mfma_f32_16x16x32_bf16 v[208:211], v[96:99], v[36:39], v[208:211]
    ds_read_b64_tr_b16 v[142:143], v178 offset:60928
    ds_read_b64_tr_b16 v[144:145], v251 offset:12288
    v_mfma_f32_16x16x32_bf16 v[212:215], v[100:103], v[36:39], v[212:215]
    ds_read_b64_tr_b16 v[146:147], v251 offset:12800
    ds_read_b64_tr_b16 v[148:149], v176 offset:28672
    v_mfma_f32_16x16x32_bf16 v[216:219], v[104:107], v[36:39], v[216:219]
    ds_read_b64_tr_b16 v[150:151], v176 offset:29184
    ds_read_b64_tr_b16 v[152:153], v177 offset:45056
    v_mfma_f32_16x16x32_bf16 v[220:223], v[108:111], v[36:39], v[220:223]
    ds_read_b64_tr_b16 v[154:155], v177 offset:45568
    s_waitcnt vmcnt(5) lgkmcnt(14)
    v_mfma_f32_16x16x32_bf16 v[208:211], v[112:115], v[40:43], v[208:211]
    ds_read_b64_tr_b16 v[156:157], v178 offset:61440
    ds_read_b64_tr_b16 v[158:159], v178 offset:61952
    v_mfma_f32_16x16x32_bf16 v[212:215], v[116:119], v[40:43], v[212:215]
    ds_read_b64_tr_b16 v[160:161], v251 offset:13312
    ds_read_b64_tr_b16 v[162:163], v251 offset:13824
    v_mfma_f32_16x16x32_bf16 v[216:219], v[120:123], v[40:43], v[216:219]
    ds_read_b64_tr_b16 v[164:165], v176 offset:29696
    ds_read_b64_tr_b16 v[166:167], v176 offset:30208
    v_mfma_f32_16x16x32_bf16 v[220:223], v[124:127], v[40:43], v[220:223]
    ds_read_b64_tr_b16 v[168:169], v177 offset:46080
    s_waitcnt vmcnt(4) lgkmcnt(13)
    v_mfma_f32_16x16x32_bf16 v[208:211], v[128:131], v[44:47], v[208:211]
    ds_read_b64_tr_b16 v[170:171], v177 offset:46592
    ds_read_b64_tr_b16 v[172:173], v178 offset:62464
    v_mfma_f32_16x16x32_bf16 v[212:215], v[132:135], v[44:47], v[212:215]
    ds_read_b64_tr_b16 v[174:175], v178 offset:62976
    ds_read_b64_tr_b16 v[64:65], v251 offset:14336
    v_mfma_f32_16x16x32_bf16 v[216:219], v[136:139], v[44:47], v[216:219]
    ds_read_b64_tr_b16 v[66:67], v251 offset:14848
    ds_read_b64_tr_b16 v[68:69], v176 offset:30720
    v_mfma_f32_16x16x32_bf16 v[220:223], v[140:143], v[44:47], v[220:223]
    ds_read_b64_tr_b16 v[70:71], v176 offset:31232
    s_waitcnt vmcnt(3) lgkmcnt(12)
    v_mfma_f32_16x16x32_bf16 v[208:211], v[144:147], v[48:51], v[208:211]
    ds_read_b64_tr_b16 v[72:73], v177 offset:47104
    ds_read_b64_tr_b16 v[74:75], v177 offset:47616
    v_mfma_f32_16x16x32_bf16 v[212:215], v[148:151], v[48:51], v[212:215]
    ds_read_b64_tr_b16 v[76:77], v178 offset:63488
    ds_read_b64_tr_b16 v[78:79], v178 offset:64000
    v_mfma_f32_16x16x32_bf16 v[216:219], v[152:155], v[48:51], v[216:219]
    ds_read_b64_tr_b16 v[80:81], v251 offset:15360
    ds_read_b64_tr_b16 v[82:83], v251 offset:15872
    v_mfma_f32_16x16x32_bf16 v[220:223], v[156:159], v[48:51], v[220:223]
    ds_read_b64_tr_b16 v[84:85], v176 offset:31744
    s_waitcnt vmcnt(2) lgkmcnt(11)
    v_mfma_f32_16x16x32_bf16 v[208:211], v[160:163], v[52:55], v[208:211]
    ds_read_b64_tr_b16 v[86:87], v176 offset:32256
    ds_read_b64_tr_b16 v[88:89], v177 offset:48128
    v_mfma_f32_16x16x32_bf16 v[212:215], v[164:167], v[52:55], v[212:215]
    ds_read_b64_tr_b16 v[90:91], v177 offset:48640
    ds_read_b64_tr_b16 v[92:93], v178 offset:64512
    v_mfma_f32_16x16x32_bf16 v[216:219], v[168:171], v[52:55], v[216:219]
    ds_read_b64_tr_b16 v[94:95], v178 offset:65024
    v_mfma_f32_16x16x32_bf16 v[220:223], v[172:175], v[52:55], v[220:223]
    s_waitcnt vmcnt(1) lgkmcnt(8)
    v_mfma_f32_16x16x32_bf16 v[208:211], v[64:67], v[56:59], v[208:211]
    v_mfma_f32_16x16x32_bf16 v[212:215], v[68:71], v[56:59], v[212:215]
    v_mfma_f32_16x16x32_bf16 v[216:219], v[72:75], v[56:59], v[216:219]
    v_mfma_f32_16x16x32_bf16 v[220:223], v[76:79], v[56:59], v[220:223]
    s_waitcnt vmcnt(0) lgkmcnt(0)
    v_mfma_f32_16x16x32_bf16 v[208:211], v[80:83], v[60:63], v[208:211]
    v_mfma_f32_16x16x32_bf16 v[212:215], v[84:87], v[60:63], v[212:215]
    v_mfma_f32_16x16x32_bf16 v[216:219], v[88:91], v[60:63], v[216:219]
    v_mfma_f32_16x16x32_bf16 v[220:223], v[92:95], v[60:63], v[220:223]
    s_cmp_eq_u32 s51, 0
    s_cbranch_scc0 L_glob_31
    s_nop 1
    s_nop 0
    v_cvt_pk_bf16_f32 v128, v208, v209
    v_cvt_pk_bf16_f32 v129, v210, v211
    v_cvt_pk_bf16_f32 v130, v212, v213
    v_cvt_pk_bf16_f32 v131, v214, v215
    buffer_store_dwordx4 v[128:131], v247, s[28:31], s46 offen offset:0
    v_cvt_pk_bf16_f32 v132, v216, v217
    v_cvt_pk_bf16_f32 v133, v218, v219
    v_cvt_pk_bf16_f32 v134, v220, v221
    v_cvt_pk_bf16_f32 v135, v222, v223
    buffer_store_dwordx4 v[132:135], v247, s[28:31], s46 offen offset:512
L_join_32:
    v_pk_add_f32 v[136:137], v[208:209], v[210:211]
    v_pk_mul_f32 v[138:139], v[208:209], v[208:209]
    v_pk_fma_f32 v[138:139], v[210:211], v[210:211], v[138:139]
    v_pk_add_f32 v[136:137], v[136:137], v[212:213]
    v_pk_fma_f32 v[138:139], v[212:213], v[212:213], v[138:139]
    v_pk_add_f32 v[136:137], v[136:137], v[214:215]
    v_pk_fma_f32 v[138:139], v[214:215], v[214:215], v[138:139]
    v_pk_add_f32 v[136:137], v[136:137], v[216:217]
    v_pk_fma_f32 v[138:139], v[216:217], v[216:217], v[138:139]
    v_pk_add_f32 v[136:137], v[136:137], v[218:219]
    v_pk_fma_f32 v[138:139], v[218:219], v[218:219], v[138:139]
    v_pk_add_f32 v[136:137], v[136:137], v[220:221]
    v_pk_fma_f32 v[138:139], v[220:221], v[220:221], v[138:139]
L_pad4:
    s_cbranch_execz L_back_8
    v_pk_add_f32 v[136:137], v[136:137], v[222:223]
    v_pk_fma_f32 v[138:139], v[222:223], v[222:223], v[138:139]
    v_add_f32 v136, v136, v137
    v_add_f32 v138, v138, v139
    s_nop 1
    v_permlane32_swap_b32 v136, v138
    v_add_f32 v136, v136, v138
    v_mov_b32 v137, v136
    s_cmp_eq_u32 s51, 0
    s_cbranch_scc0 L_glob_33
    v_permlane16_swap_b32 v136, v137
    s_mov_b64 exec, s[96:97]
    v_add_f32 v136, v136, v137
    v_and_b32 v136, -2, v136
    buffer_store_dword v136, v248, s[24:27], s47 offen
L_join_34:
    s_mov_b64 exec, -1
    s_barrier
    ds_write_b128 v253, a[0:3] offset:0
    ds_write_b128 v253, a[4:7] offset:2048
    ds_write_b128 v253, a[8:11] offset:4096
    ds_write_b128 v253, a[12:15] offset:6144
    s_add_u32 s49, s49, 589824
    s_mov_b64 exec, 1
    s_cmp_eq_u32 s51, 0
    s_cbranch_scc0 L_glob_35
    s_waitcnt vmcnt(1)
    buffer_store_dword v179, off, s[24:27], s48
L_join_36:
    s_mov_b64 exec, -1
    s_branch L_overx2
L_morex2:
    buffer_load_dword v234, v250, s[24:27], s41 offen offset:0 sc1
    s_sub_u32 s59, s59, 1
    s_cbranch_scc1 L_timeout
    s_waitcnt vmcnt(1)
    v_cmp_ne_u32 vcc, s1, v235
    s_nop 0
    s_cbranch_vccz L_gox2
    s_branch L_spinx2
L_stub_37:
    s_mov_b64 exec, 0
    s_cmp_eq_u32 s36, 2
    s_cbranch_scc1 L_pad7
    s_branch L_pad8
L_stub_42:
    s_mov_b64 exec, 0
    s_cmp_eq_u32 s36, 2
    s_cbranch_scc1 L_pad10
    s_branch L_pad11
L_overx2:
    ds_write_b128 v253, a[16:19] offset:8192
    ds_write_b128 v253, a[20:23] offset:10240
    ds_write_b128 v253, a[24:27] offset:12288
    ds_write_b128 v253, a[28:31] offset:14336
    ds_write_b128 v253, a[32:35] offset:16384
    s_mov_b64 exec, 0xffff
    buffer_load_dword v234, v250, s[24:27], s41 offen offset:0 sc1
    s_mov_b64 exec, -1
    ds_write_b128 v253, a[36:39] offset:18432
    ds_write_b128 v253, a[40:43] offset:20480
    ds_write_b128 v253, a[44:47] offset:22528
L_layer2:
    s_mov_b64 exec, 0xffff
L_spinx2:
    buffer_load_dword v235, v250, s[24:27], s41 offen offset:0 sc1
    s_waitcnt vmcnt(1)
    v_cmp_ne_u32 vcc, s1, v234
    s_nop 0
    s_cbranch_vccnz L_morex2
L_gox2:
    s_mov_b64 exec, -1
    buffer_load_dwordx4 v[0:3], v240, s[28:31], s39 offen offset:0 sc1
    buffer_load_dwordx4 v[4:7], v240, s[28:31], s39 offen offset:1024 sc1
    buffer_load_dwordx4 v[8:11], v240, s[28:31], s39 offen offset:2048 sc1
    buffer_load_dwordx4 v[12:15], v240, s[28:31], s39 offen offset:3072 sc1
    ds_write_b128 v253, a[48:51] offset:24576
    s_xor_b32 s58, s39, 4096
    buffer_load_dwordx4 v[16:19], v240, s[28:31], s58 offen offset:0 sc1
    ds_write_b128 v253, a[52:55] offset:26624
    buffer_load_dwordx4 v[20:23], v240, s[28:31], s58 offen offset:1024 sc1
    ds_write_b128 v253, a[56:59] offset:28672
    buffer_load_dwordx4 v[24:27], v240, s[28:31], s58 offen offset:2048 sc1
    ds_write_b128 v253, a[60:63] offset:30720
    buffer_load_dwordx4 v[28:31], v240, s[28:31], s58 offen offset:3072 sc1
    s_waitcnt lgkmcnt(0)
    s_barrier
    ds_read_b64_tr_b16 v[160:161], v241 offset:0
    ds_read_b64_tr_b16 v[162:163], v241 offset:1024
    ds_read_b64_tr_b16 v[164:165], v241 offset:32768
    ds_read_b64_tr_b16 v[166:167], v241 offset:33792
    ds_read_b64_tr_b16 v[168:169], v241 offset:256
    ds_read_b64_tr_b16 v[170:171], v241 offset:1280
    ds_read_b64_tr_b16 v[172:173], v241 offset:33024
    ds_read_b64_tr_b16 v[174:175], v241 offset:34048
    ds_read_b64_tr_b16 v[176:177], v241 offset:512
    ds_read_b64_tr_b16 v[178:179], v241 offset:1536
    ds_read_b64_tr_b16 v[180:181], v241 offset:33280
    ds_read_b64_tr_b16 v[182:183], v241 offset:34304
    ds_read_b128 v[200:203], v254 offset:0
    ds_read_b128 v[204:207], v254 offset:512
    s_waitcnt vmcnt(7) lgkmcnt(10)
    v_mfma_f32_32x32x16_bf16 v[128:143], v[160:163], v[0:3], 0
    s_xor_b32 s58, s39, 8192
    buffer_load_dwordx4 v[32:35], v240, s[28:31], s58 offen offset:0 sc1
    ds_read_b64_tr_b16 v[160:161], v241 offset:768
    ds_read_b64_tr_b16 v[162:163], v241 offset:1792
    v_mfma_f32_32x32x16_bf16 v[144:159], v[164:167], v[0:3], 0
    v_mov_b32 v227, 0
    ds_read_b64_tr_b16 v[164:165], v241 offset:33536
    ds_read_b64_tr_b16 v[166:167], v241 offset:34560
    v_mov_b32 v228, 0
    s_waitcnt vmcnt(7) lgkmcnt(10)
    v_mfma_f32_32x32x16_bf16 v[128:143], v[168:171], v[4:7], v[128:143]
    buffer_load_dwordx4 v[36:39], v240, s[28:31], s58 offen offset:1024 sc1
    buffer_load_dwordx4 v[192:195], v249, s[24:27], s40 offen sc1
    ds_read_b64_tr_b16 v[168:169], v241 offset:4096
    ds_read_b64_tr_b16 v[170:171], v241 offset:5120
    v_mfma_f32_32x32x16_bf16 v[144:159], v[172:175], v[4:7], v[144:159]
    ds_read_b64_tr_b16 v[172:173], v241 offset:36864
    ds_read_b64_tr_b16 v[174:175], v241 offset:37888
    s_waitcnt vmcnt(8) lgkmcnt(10)
    v_mfma_f32_32x32x16_bf16 v[128:143], v[176:179], v[8:11], v[128:143]
    buffer_load_dwordx4 v[40:43], v240, s[28:31], s58 offen offset:2048 sc1
    ds_read_b64_tr_b16 v[176:177], v241 offset:4352
    ds_read_b64_tr_b16 v[178:179], v241 offset:5376
    v_mfma_f32_32x32x16_bf16 v[144:159], v[180:183], v[8:11], v[144:159]
    ds_read_b64_tr_b16 v[180:181], v241 offset:37120
    ds_read_b64_tr_b16 v[182:183], v241 offset:38144
    s_waitcnt vmcnt(8) lgkmcnt(8)
    v_mfma_f32_32x32x16_bf16 v[128:143], v[160:163], v[12:15], v[128:143]
    buffer_load_dwordx4 v[44:47], v240, s[28:31], s58 offen offset:3072 sc1
    buffer_load_dwordx4 v[196:199], v249, s[24:27], s40 offen offset:512 sc1
    ds_read_b64_tr_b16 v[160:161], v241 offset:4608
    ds_read_b64_tr_b16 v[162:163], v241 offset:5632
    v_mfma_f32_32x32x16_bf16 v[144:159], v[164:167], v[12:15], v[144:159]
    v_add_f32_e64 v200, v200, v202
    ds_read_b64_tr_b16 v[164:165], v241 offset:37376
    ds_read_b64_tr_b16 v[166:167], v241 offset:38400
    v_add_f32 v201, v201, v203
    s_waitcnt vmcnt(9) lgkmcnt(8)
    v_mfma_f32_32x32x16_bf16 v[128:143], v[168:171], v[16:19], v[128:143]
    s_xor_b32 s58, s39, 12288
    buffer_load_dwordx4 v[48:51], v240, s[28:31], s58 offen offset:0 sc1
    ds_read_b64_tr_b16 v[168:169], v241 offset:4864
    ds_read_b64_tr_b16 v[170:171], v241 offset:5888
    v_mfma_f32_32x32x16_bf16 v[144:159], v[172:175], v[16:19], v[144:159]
    v_add_f32_e64 v200, v200, v201
    ds_read_b64_tr_b16 v[172:173], v241 offset:37632
    ds_read_b64_tr_b16 v[174:175], v241 offset:38656
    v_cvt_pk_bf16_f32 v201, v200, v200
    s_waitcnt vmcnt(9) lgkmcnt(8)
    v_mfma_f32_32x32x16_bf16 v[128:143], v[176:179], v[20:23], v[128:143]
    buffer_load_dwordx4 v[52:55], v240, s[28:31], s58 offen offset:1024 sc1
    ds_read_b64_tr_b16 v[176:177], v241 offset:8192
    ds_read_b64_tr_b16 v[178:179], v241 offset:9216
    v_mfma_f32_32x32x16_bf16 v[144:159], v[180:183], v[20:23], v[144:159]
    v_and_b32 v201, 0xffff0000, v201
    ds_read_b64_tr_b16 v[180:181], v241 offset:40960
    ds_read_b64_tr_b16 v[182:183], v241 offset:41984
    v_sub_f32 v200, v200, v201
    s_waitcnt vmcnt(9) lgkmcnt(8)
    v_mfma_f32_32x32x16_bf16 v[128:143], v[160:163], v[24:27], v[128:143]
    buffer_load_dwordx4 v[56:59], v240, s[28:31], s58 offen offset:2048 sc1
    ds_read_b64_tr_b16 v[160:161], v241 offset:8448
    ds_read_b64_tr_b16 v[162:163], v241 offset:9472
    v_mfma_f32_32x32x16_bf16 v[144:159], v[164:167], v[24:27], v[144:159]
    v_cvt_pk_bf16_f32 v224, v201, v200
    ds_read_b64_tr_b16 v[164:165], v241 offset:41216
    ds_read_b64_tr_b16 v[166:167], v241 offset:42240
    v_add_f32 v204, v204, v206
    s_waitcnt vmcnt(9) lgkmcnt(8)
    v_mfma_f32_32x32x16_bf16 v[128:143], v[168:171], v[28:31], v[128:143]
    buffer_load_dwordx4 v[60:63], v240, s[28:31], s58 offen offset:3072 sc1
    ds_read_b64_tr_b16 v[168:169], v241 offset:8704
    ds_read_b64_tr_b16 v[170:171], v241 offset:9728
    v_mfma_f32_32x32x16_bf16 v[144:159], v[172:175], v[28:31], v[144:159]
    v_add_f32 v205, v205, v207
    ds_read_b64_tr_b16 v[172:173], v241 offset:41472
    ds_read_b64_tr_b16 v[174:175], v241 offset:42496
    v_add_f32 v204, v204, v205
    s_waitcnt vmcnt(9) lgkmcnt(8)
    v_mfma_f32_32x32x16_bf16 v[128:143], v[176:179], v[32:35], v[128:143]
    s_xor_b32 s58, s39, 16384
    buffer_load_dwordx4 v[64:67], v240, s[28:31], s58 offen offset:0 sc1
    ds_read_b64_tr_b16 v[176:177], v241 offset:8960
    ds_read_b64_tr_b16 v[178:179], v241 offset:9984
    v_mfma_f32_32x32x16_bf16 v[144:159], v[180:183], v[32:35], v[144:159]
    v_cvt_pk_bf16_f32 v205, v204, v204
    ds_read_b64_tr_b16 v[180:181], v241 offset:41728
    ds_read_b64_tr_b16 v[182:183], v241 offset:42752
    v_and_b32 v205, 0xffff0000, v205
    s_waitcnt vmcnt(9) lgkmcnt(8)
    v_mfma_f32_32x32x16_bf16 v[128:143], v[160:163], v[36:39], v[128:143]
    buffer_load_dwordx4 v[68:71], v240, s[28:31], s58 offen offset:1024 sc1
    ds_read_b64_tr_b16 v[160:161], v241 offset:12288
    ds_read_b64_tr_b16 v[162:163], v241 offset:13312
    v_mfma_f32_32x32x16_bf16 v[144:159], v[164:167], v[36:39], v[144:159]
    v_sub_f32 v204, v204, v205
    ds_read_b64_tr_b16 v[164:165], v241 offset:45056
    ds_read_b64_tr_b16 v[166:167], v241 offset:46080
    v_cvt_pk_bf16_f32 v225, v205, v204
    s_waitcnt vmcnt(8) lgkmcnt(8)
    v_mfma_f32_32x32x16_bf16 v[128:143], v[168:171], v[40:43], v[128:143]
    buffer_load_dwordx4 v[72:75], v240, s[28:31], s58 offen offset:2048 sc1
    ds_read_b64_tr_b16 v[168:169], v241 offset:12544
    ds_read_b64_tr_b16 v[170:171], v241 offset:13568
    v_mfma_f32_32x32x16_bf16 v[144:159], v[172:175], v[40:43], v[144:159]
    ds_read_b64_tr_b16 v[172:173], v241 offset:45312
    ds_read_b64_tr_b16 v[174:175], v241 offset:46336
    s_waitcnt vmcnt(8) lgkmcnt(8)
    v_mfma_f32_32x32x16_bf16 v[128:143], v[176:179], v[44:47], v[128:143]
    buffer_load_dwordx4 v[76:79], v240, s[28:31], s58 offen offset:3072 sc1
    ds_read_b64_tr_b16 v[176:177], v241 offset:12800
    ds_read_b64_tr_b16 v[178:179], v241 offset:13824
    v_mfma_f32_32x32x16_bf16 v[144:159], v[180:183], v[44:47], v[144:159]
    ds_read_b64_tr_b16 v[180:181], v241 offset:45568
    ds_read_b64_tr_b16 v[182:183], v241 offset:46592
    s_waitcnt vmcnt(7) lgkmcnt(8)
    v_mfma_f32_32x32x16_bf16 v[128:143], v[160:163], v[48:51], v[128:143]
    s_xor_b32 s58, s39, 20480
    buffer_load_dwordx4 v[80:83], v240, s[28:31], s58 offen offset:0 sc1
    ds_read_b64_tr_b16 v[160:161], v241 offset:13056
    ds_read_b64_tr_b16 v[162:163], v241 offset:14080
    v_mfma_f32_32x32x16_bf16 v[144:159], v[164:167], v[48:51], v[144:159]
    ds_read_b64_tr_b16 v[164:165], v241 offset:45824
    ds_read_b64_tr_b16 v[166:167], v241 offset:46848
L_sums2:
    v_bitop3_b32 v230, v192, v193, v194 bitop3:0xfe
    v_bitop3_b32 v230, v230, v195, v196 bitop3:0xfe
    v_bitop3_b32 v230, v230, v197, v198 bitop3:0xfe
    v_bitop3_b32 v230, v230, v199, 1 bitop3:0xa8
    v_cmp_ne_u32 vcc, 0, v230
    s_nop 0
    s_cbranch_vccnz L_sumsre2
    s_waitcnt vmcnt(7) lgkmcnt(8)
    v_mfma_f32_32x32x16_bf16 v[128:143], v[168:171], v[52:55], v[128:143]
    buffer_load_dwordx4 v[84:87], v240, s[28:31], s58 offen offset:1024 sc1
    ds_read_b64_tr_b16 v[168:169], v241 offset:16384
    ds_read_b64_tr_b16 v[170:171], v241 offset:17408
    v_mfma_f32_32x32x16_bf16 v[144:159], v[172:175], v[52:55], v[144:159]
    v_add_f32 v192, v192, v194
    ds_read_b64_tr_b16 v[172:173], v241 offset:49152
    ds_read_b64_tr_b16 v[174:175], v241 offset:50176
    v_add_f32 v193, v193, v195
    s_waitcnt vmcnt(7) lgkmcnt(8)
    v_mfma_f32_32x32x16_bf16 v[128:143], v[176:179], v[56:59], v[128:143]
    buffer_load_dwordx4 v[88:91], v240, s[28:31], s58 offen offset:2048 sc1
    ds_read_b64_tr_b16 v[176:177], v241 offset:16640
    ds_read_b64_tr_b16 v[178:179], v241 offset:17664
    v_mfma_f32_32x32x16_bf16 v[144:159], v[180:183], v[56:59], v[144:159]
    v_add_f32_e64 v196, v196, v198
    ds_read_b64_tr_b16 v[180:181], v241 offset:49408
    ds_read_b64_tr_b16 v[182:183], v241 offset:50432
    v_add_f32 v197, v197, v199
    s_waitcnt vmcnt(7) lgkmcnt(8)
    v_mfma_f32_32x32x16_bf16 v[128:143], v[160:163], v[60:63], v[128:143]
    buffer_load_dwordx4 v[92:95], v240, s[28:31], s58 offen offset:3072 sc1
    ds_read_b64_tr_b16 v[160:161], v241 offset:16896
    ds_read_b64_tr_b16 v[162:163], v241 offset:17920
    v_mfma_f32_32x32x16_bf16 v[144:159], v[164:167], v[60:63], v[144:159]
    v_add_f32_e64 v192, v192, v196
    ds_read_b64_tr_b16 v[164:165], v241 offset:49664
    ds_read_b64_tr_b16 v[166:167], v241 offset:50688
    v_add_f32 v193, v193, v197
    s_waitcnt vmcnt(7) lgkmcnt(8)
    v_mfma_f32_32x32x16_bf16 v[128:143], v[168:171], v[64:67], v[128:143]
    s_xor_b32 s58, s39, 24576
    buffer_load_dwordx4 v[96:99], v240, s[28:31], s58 offen offset:0 sc1
    ds_read_b64_tr_b16 v[168:169], v241 offset:17152
    ds_read_b64_tr_b16 v[170:171], v241 offset:18176
    v_mfma_f32_32x32x16_bf16 v[144:159], v[172:175], v[64:67], v[144:159]
    v_add_f32_e64 v192, v192, v193
    ds_read_b64_tr_b16 v[172:173], v241 offset:49920
    ds_read_b64_tr_b16 v[174:175], v241 offset:50944
    v_mul_f32 v192, 0x3b000000, v192
    s_waitcnt vmcnt(7) lgkmcnt(8)
    v_mfma_f32_32x32x16_bf16 v[128:143], v[176:179], v[68:71], v[128:143]
    buffer_load_dwordx4 v[100:103], v240, s[28:31], s58 offen offset:1024 sc1
    ds_read_b64_tr_b16 v[176:177], v241 offset:20480
    ds_read_b64_tr_b16 v[178:179], v241 offset:21504
    v_mfma_f32_32x32x16_bf16 v[144:159], v[180:183], v[68:71], v[144:159]
    v_mov_b32 v193, v192
    ds_read_b64_tr_b16 v[180:181], v241 offset:53248
    ds_read_b64_tr_b16 v[182:183], v241 offset:54272
    v_permlane32_swap_b32 v192, v193
    s_waitcnt vmcnt(7) lgkmcnt(8)
    v_mfma_f32_32x32x16_bf16 v[128:143], v[160:163], v[72:75], v[128:143]
    buffer_load_dwordx4 v[104:107], v240, s[28:31], s58 offen offset:2048 sc1
    ds_read_b64_tr_b16 v[160:161], v241 offset:20736
    ds_read_b64_tr_b16 v[162:163], v241 offset:21760
    v_mfma_f32_32x32x16_bf16 v[144:159], v[164:167], v[72:75], v[144:159]
    v_fma_f32 v193, -v192, v192, v193
    ds_read_b64_tr_b16 v[164:165], v241 offset:53504
    ds_read_b64_tr_b16 v[166:167], v241 offset:54528
    v_max_f32 v193, 0, v193
    s_waitcnt vmcnt(7) lgkmcnt(8)
    v_mfma_f32_32x32x16_bf16 v[128:143], v[168:171], v[76:79], v[128:143]
    buffer_load_dwordx4 v[108:111], v240, s[28:31], s58 offen offset:3072 sc1
    ds_read_b64_tr_b16 v[168:169], v241 offset:20992
    ds_read_b64_tr_b16 v[170:171], v241 offset:22016
    v_mfma_f32_32x32x16_bf16 v[144:159], v[172:175], v[76:79], v[144:159]
    v_cvt_pk_bf16_f32 v246, -v192, -v192
    ds_read_b64_tr_b16 v[172:173], v241 offset:53760
    ds_read_b64_tr_b16 v[174:175], v241 offset:54784
    v_cvt_pk_bf16_f32 v193, v193, v193
    s_waitcnt vmcnt(7) lgkmcnt(8)
    v_mfma_f32_32x32x16_bf16 v[128:143], v[176:179], v[80:83], v[128:143]
    s_xor_b32 s58, s39, 28672
    buffer_load_dwordx4 v[112:115], v240, s[28:31], s58 offen offset:0 sc1
    ds_read_b64_tr_b16 v[176:177], v241 offset:21248
    ds_read_b64_tr_b16 v[178:179], v241 offset:22272
    v_mfma_f32_32x32x16_bf16 v[144:159], v[180:183], v[80:83], v[144:159]
    v_and_b32 v193, 0xffff0000, v193
    ds_read_b64_tr_b16 v[180:181], v241 offset:54016
    ds_read_b64_tr_b16 v[182:183], v241 offset:55040
    v_add_f32 v193, 0x3727c5ac, v193
    s_waitcnt vmcnt(7) lgkmcnt(8)
    v_mfma_f32_32x32x16_bf16 v[128:143], v[160:163], v[84:87], v[128:143]
    buffer_load_dwordx4 v[116:119], v240, s[28:31], s58 offen offset:1024 sc1
    ds_read_b64_tr_b16 v[160:161], v241 offset:24576
    ds_read_b64_tr_b16 v[162:163], v241 offset:25600
    v_mfma_f32_32x32x16_bf16 v[144:159], v[164:167], v[84:87], v[144:159]
    v_cvt_pk_bf16_f32 v193, v193, v193
    ds_read_b64_tr_b16 v[164:165], v241 offset:57344
    ds_read_b64_tr_b16 v[166:167], v241 offset:58368
    v_and_b32 v193, 0xffff0000, v193
    s_waitcnt vmcnt(7) lgkmcnt(8)
    v_mfma_f32_32x32x16_bf16 v[128:143], v[168:171], v[88:91], v[128:143]
    buffer_load_dwordx4 v[120:123], v240, s[28:31], s58 offen offset:2048 sc1
    ds_read_b64_tr_b16 v[168:169], v241 offset:24832
    ds_read_b64_tr_b16 v[170:171], v241 offset:25856
    v_mfma_f32_32x32x16_bf16 v[144:159], v[172:175], v[88:91], v[144:159]
    v_sqrt_f32 v193, v193
    ds_read_b64_tr_b16 v[172:173], v241 offset:57600
    ds_read_b64_tr_b16 v[174:175], v241 offset:58624
    v_cndmask_b32 v246, v246, 0, s[68:69]
    s_waitcnt vmcnt(7) lgkmcnt(8)
    v_mfma_f32_32x32x16_bf16 v[128:143], v[176:179], v[92:95], v[128:143]
    buffer_load_dwordx4 v[124:127], v240, s[28:31], s58 offen offset:3072 sc1
    ds_read_b64_tr_b16 v[176:177], v241 offset:25088
    ds_read_b64_tr_b16 v[178:179], v241 offset:26112
    v_mfma_f32_32x32x16_bf16 v[144:159], v[180:183], v[92:95], v[144:159]
    v_cvt_pk_bf16_f32 v193, v193, v193
    ds_read_b64_tr_b16 v[180:181], v241 offset:57856
    ds_read_b64_tr_b16 v[182:183], v241 offset:58880
    v_and_b32 v193, 0xffff0000, v193
    s_waitcnt vmcnt(7) lgkmcnt(8)
    v_mfma_f32_32x32x16_bf16 v[128:143], v[160:163], v[96:99], v[128:143]
    ds_read_b64_tr_b16 v[160:161], v241 offset:25344
    ds_read_b64_tr_b16 v[162:163], v241 offset:26368
    v_mfma_f32_32x32x16_bf16 v[144:159], v[164:167], v[96:99], v[144:159]
    v_rcp_f32_e64 v245, v193
    ds_read_b64_tr_b16 v[164:165], v241 offset:58112
    ds_read_b64_tr_b16 v[166:167], v241 offset:59136
    v_mov_b32 v226, v246
    s_waitcnt vmcnt(6) lgkmcnt(8)
    v_mfma_f32_32x32x16_bf16 v[128:143], v[168:171], v[100:103], v[128:143]
    ds_read_b64_tr_b16 v[168:169], v241 offset:28672
    ds_read_b64_tr_b16 v[170:171], v241 offset:29696
    v_mfma_f32_32x32x16_bf16 v[144:159], v[172:175], v[100:103], v[144:159]
    v_mul_f32 v244, 0x3fb8aa3b, v245
    ds_read_b64_tr_b16 v[172:173], v241 offset:61440
    ds_read_b64_tr_b16 v[174:175], v241 offset:62464
    v_mov_b32 v229, v246
    s_waitcnt vmcnt(5) lgkmcnt(8)
    v_mfma_f32_32x32x16_bf16 v[128:143], v[176:179], v[104:107], v[128:143]
    ds_read_b64_tr_b16 v[176:177], v241 offset:28928
    ds_read_b64_tr_b16 v[178:179], v241 offset:29952
    v_mfma_f32_32x32x16_bf16 v[144:159], v[180:183], v[104:107], v[144:159]
    ds_read_b64_tr_b16 v[180:181], v241 offset:61696
    ds_read_b64_tr_b16 v[182:183], v241 offset:62720
    s_waitcnt vmcnt(4) lgkmcnt(8)
    v_mfma_f32_32x32x8_bf16 v[128:143], v[224:225], v[226:227], v[128:143]
    v_mfma_f32_32x32x8_bf16 v[144:159], v[224:225], v[228:229], v[144:159]
    v_mfma_f32_32x32x16_bf16 v[128:143], v[160:163], v[108:111], v[128:143]
    ds_read_b64_tr_b16 v[160:161], v241 offset:29184
    ds_read_b64_tr_b16 v[162:163], v241 offset:30208
    v_mfma_f32_32x32x16_bf16 v[144:159], v[164:167], v[108:111], v[144:159]
    ds_read_b64_tr_b16 v[164:165], v241 offset:61952
    ds_read_b64_tr_b16 v[166:167], v241 offset:62976
    s_waitcnt vmcnt(3) lgkmcnt(8)
    v_mfma_f32_32x32x16_bf16 v[128:143], v[168:171], v[112:115], v[128:143]
    ds_read_b64_tr_b16 v[168:169], v241 offset:29440
    ds_read_b64_tr_b16 v[170:171], v241 offset:30464
    v_mfma_f32_32x32x16_bf16 v[144:159], v[172:175], v[112:115], v[144:159]
    ds_read_b64_tr_b16 v[172:173], v241 offset:62208
    ds_read_b64_tr_b16 v[174:175], v241 offset:63232
    s_waitcnt vmcnt(2) lgkmcnt(8)
    v_mfma_f32_32x32x16_bf16 v[128:143], v[176:179], v[116:119], v[128:143]
    v_mfma_f32_32x32x16_bf16 v[144:159], v[180:183], v[116:119], v[144:159]
    s_waitcnt vmcnt(1) lgkmcnt(4)
    v_mfma_f32_32x32x16_bf16 v[128:143], v[160:163], v[120:123], v[128:143]
    v_mfma_f32_32x32x16_bf16 v[144:159], v[164:167], v[120:123], v[144:159]
    s_waitcnt vmcnt(0) lgkmcnt(0)
    v_mfma_f32_32x32x16_bf16 v[128:143], v[168:171], v[124:127], v[128:143]
    s_nop 5
    v_mfma_f32_32x32x16_bf16 v[144:159], v[172:175], v[124:127], v[144:159]
    s_nop 3
    s_nop 0
    v_pk_mul_f32 v[128:129], v[128:129], v[244:245] op_sel_hi:[1,0]
    v_pk_mul_f32 v[130:131], v[130:131], v[244:245] op_sel_hi:[1,0]
    v_pk_mul_f32 v[132:133], v[132:133], v[244:245] op_sel_hi:[1,0]
    v_pk_mul_f32 v[134:135], v[134:135], v[244:245] op_sel_hi:[1,0]
    v_pk_mul_f32 v[136:137], v[136:137], v[244:245] op_sel_hi:[1,0]
    v_pk_mul_f32 v[138:139], v[138:139], v[244:245] op_sel_hi:[1,0]
    v_pk_mul_f32 v[140:141], v[140:141], v[244:245] op_sel_hi:[1,0]
    v_pk_mul_f32 v[142:143], v[142:143], v[244:245] op_sel_hi:[1,0]
    v_exp_f32_e64 v192, v128 clamp
    v_max_f32 v128, s66, v128
    v_exp_f32_e64 v193, v129 clamp
    v_max_f32 v129, s66, v129
    v_exp_f32_e64 v194, v130 clamp
    v_max_f32 v130, s66, v130
    v_exp_f32_e64 v195, v131 clamp
    v_max_f32 v131, s66, v131
    v_exp_f32_e64 v196, v132 clamp
    v_max_f32 v132, s66, v132
    v_exp_f32_e64 v197, v133 clamp
    v_max_f32 v133, s66, v133
    v_exp_f32_e64 v198, v134 clamp
    v_max_f32 v134, s66, v134
    v_exp_f32_e64 v199, v135 clamp
    v_max_f32 v135, s66, v135
    v_exp_f32_e64 v200, v136 clamp
    v_max_f32 v136, s66, v136
    v_exp_f32_e64 v201, v137 clamp
    v_max_f32 v137, s66, v137
    v_exp_f32_e64 v202, v138 clamp
    v_max_f32 v138, s66, v138
    v_exp_f32_e64 v203, v139 clamp
    v_max_f32 v139, s66, v139
    v_exp_f32_e64 v204, v140 clamp
    v_max_f32 v140, s66, v140
    v_exp_f32_e64 v205, v141 clamp
    v_max_f32 v141, s66, v141
    v_exp_f32_e64 v206, v142 clamp
    v_max_f32 v142, s66, v142
    v_exp_f32_e64 v207, v143 clamp
    v_max_f32 v143, s66, v143
    v_pk_fma_f32 v[128:129], v[128:129], s[64:65], v[192:193]
    v_pk_fma_f32 v[130:131], v[130:131], s[64:65], v[194:195]
    v_pk_fma_f32 v[132:133], v[132:133], s[64:65], v[196:197]
    v_pk_fma_f32 v[134:135], v[134:135], s[64:65], v[198:199]
    v_cvt_pk_bf16_f32 v224, v128, v129
    v_cvt_pk_bf16_f32 v225, v130, v131
    v_cvt_pk_bf16_f32 v226, v132, v133
    v_cvt_pk_bf16_f32 v227, v134, v135
    ds_write_b128 v242, v[224:227] offset:0
    v_pk_fma_f32 v[136:137], v[136:137], s[64:65], v[200:201]
    v_pk_fma_f32 v[138:139], v[138:139], s[64:65], v[202:203]
    v_pk_fma_f32 v[140:141], v[140:141], s[64:65], v[204:205]
    v_pk_fma_f32 v[142:143], v[142:143], s[64:65], v[206:207]
    v_cvt_pk_bf16_f32 v228, v136, v137
    v_cvt_pk_bf16_f32 v229, v138, v139
    v_cvt_pk_bf16_f32 v230, v140, v141
    v_cvt_pk_bf16_f32 v231, v142, v143
    ds_write_b128 v242, v[228:231] offset:128
    v_pk_mul_f32 v[144:145], v[144:145], v[244:245] op_sel:[0,1]
    v_pk_mul_f32 v[146:147], v[146:147], v[244:245] op_sel:[0,1]
    v_pk_mul_f32 v[148:149], v[148:149], v[244:245] op_sel:[0,1]
    v_pk_mul_f32 v[150:151], v[150:151], v[244:245] op_sel:[0,1]
    v_cvt_pk_bf16_f32 v144, v144, v145
    v_cvt_pk_bf16_f32 v145, v146, v147
    v_cvt_pk_bf16_f32 v146, v148, v149
    v_cvt_pk_bf16_f32 v147, v150, v151
    ds_write_b128 v242, v[144:147] offset:16384
    v_pk_mul_f32 v[152:153], v[152:153], v[244:245] op_sel:[0,1]
    v_pk_mul_f32 v[154:155], v[154:155], v[244:245] op_sel:[0,1]
    v_pk_mul_f32 v[156:157], v[156:157], v[244:245] op_sel:[0,1]
    v_pk_mul_f32 v[158:159], v[158:159], v[244:245] op_sel:[0,1]
    v_cvt_pk_bf16_f32 v148, v152, v153
    v_cvt_pk_bf16_f32 v149, v154, v155
    v_cvt_pk_bf16_f32 v150, v156, v157
    v_cvt_pk_bf16_f32 v151, v158, v159
    ds_write_b128 v242, v[148:151] offset:16512
    v_mov_b32 v128, 0x3f803f80
    v_mov_b32 v129, 0x3f803f80
    v_mov_b32 v130, 0x3f803f80
    v_mov_b32 v131, 0x3f803f80
    s_waitcnt lgkmcnt(0)
    s_barrier
    s_cmp_lt_u32 s36, 2
    s_cbranch_scc0 L_stub_37
    ds_read_b64_tr_b16 v[192:193], v184 offset:0
    ds_read_b64_tr_b16 v[194:195], v184 offset:512
    ds_read_b64_tr_b16 v[224:225], v185 offset:0
    ds_read_b64_tr_b16 v[226:227], v185 offset:512
    ds_read_b64_tr_b16 v[196:197], v184 offset:1024
    ds_read_b64_tr_b16 v[198:199], v184 offset:1536
    ds_read_b64_tr_b16 v[228:229], v185 offset:1024
    ds_read_b64_tr_b16 v[230:231], v185 offset:1536
    s_waitcnt lgkmcnt(4)
    v_mfma_f32_16x16x32_bf16 v[152:155], v[192:195], v[224:227], 0
    ds_read_b64_tr_b16 v[200:201], v184 offset:2048
    ds_read_b64_tr_b16 v[202:203], v184 offset:2560
    v_mfma_f32_16x16x32_bf16 v[156:159], v[192:195], v[128:131], 0
    ds_read_b64_tr_b16 v[232:233], v185 offset:2048
    ds_read_b64_tr_b16 v[234:235], v185 offset:2560
    s_waitcnt lgkmcnt(4)
    v_mfma_f32_16x16x32_bf16 v[152:155], v[196:199], v[228:231], v[152:155]
    ds_read_b64_tr_b16 v[204:205], v184 offset:3072
    ds_read_b64_tr_b16 v[206:207], v184 offset:3584
    v_mfma_f32_16x16x32_bf16 v[156:159], v[196:199], v[128:131], v[156:159]
    ds_read_b64_tr_b16 v[236:237], v185 offset:3072
    ds_read_b64_tr_b16 v[238:239], v185 offset:3584
    s_waitcnt lgkmcnt(4)
    v_mfma_f32_16x16x32_bf16 v[152:155], v[200:203], v[232:235], v[152:155]
    v_mfma_f32_16x16x32_bf16 v[156:159], v[200:203], v[128:131], v[156:159]
    s_waitcnt lgkmcnt(0)
    v_mfma_f32_16x16x32_bf16 v[152:155], v[204:207], v[236:239], v[152:155]
    v_mfma_f32_16x16x32_bf16 v[156:159], v[204:207], v[128:131], v[156:159]
    s_nop 5
    s_nop 0
    v_cvt_pk_bf16_f32 v148, v152, v153
    v_cvt_pk_bf16_f32 v149, v154, v155
    v_cvt_pk_bf16_f32 v150, v152, v153
    v_cvt_pk_bf16_f32 v151, v154, v155
    v_min_u32 v156, -2, v156
    v_permlane16_swap_b32 v148, v150
    v_permlane16_swap_b32 v149, v151
    v_min_u32 v148, -2, v148
    s_mov_b64 exec, s[96:97]
    buffer_store_dwordx4 v[148:151], v186, s[24:27], s49 offen sc1
    s_mov_b64 exec, s[10:11]
    buffer_store_dwordx4 v[156:159], v187, s[24:27], s49 offen sc1
L_back_38:
    s_mov_b64 exec, -1
    v_add_u32 v147, 0x10000, v241
    ds_read_b64_tr_b16 v[160:161], v147 offset:0
    ds_read_b64_tr_b16 v[162:163], v147 offset:1024
    ds_read_b64_tr_b16 v[164:165], v147 offset:256
    ds_read_b64_tr_b16 v[166:167], v147 offset:1280
    ds_read_b64_tr_b16 v[168:169], v147 offset:512
    ds_read_b64_tr_b16 v[170:171], v147 offset:1536
    ds_read_b64_tr_b16 v[172:173], v147 offset:768
    ds_read_b64_tr_b16 v[174:175], v147 offset:1792
    ds_read_b64_tr_b16 v[176:177], v147 offset:4096
    ds_read_b64_tr_b16 v[178:179], v147 offset:5120
    ds_read_b64_tr_b16 v[180:181], v147 offset:4352
    ds_read_b64_tr_b16 v[182:183], v147 offset:5376
    ds_read_b128 v[196:199], v254 offset:1024
    s_waitcnt lgkmcnt(11)
    v_mfma_f32_32x32x16_bf16 v[128:143], v[160:163], v[0:3], 0
    ds_read_b64_tr_b16 v[160:161], v147 offset:4608
    ds_read_b64_tr_b16 v[162:163], v147 offset:5632
    s_waitcnt lgkmcnt(11)
    v_mfma_f32_32x32x16_bf16 v[128:143], v[164:167], v[4:7], v[128:143]
    ds_read_b64_tr_b16 v[164:165], v147 offset:4864
    ds_read_b64_tr_b16 v[166:167], v147 offset:5888
    ds_write_b128 v252, a[128:131] offset:0
    s_waitcnt lgkmcnt(12)
    v_mfma_f32_32x32x16_bf16 v[128:143], v[168:171], v[8:11], v[128:143]
    ds_read_b64_tr_b16 v[168:169], v147 offset:8192
    ds_read_b64_tr_b16 v[170:171], v147 offset:9216
    s_waitcnt lgkmcnt(12)
    v_mfma_f32_32x32x16_bf16 v[128:143], v[172:175], v[12:15], v[128:143]
    ds_read_b64_tr_b16 v[172:173], v147 offset:8448
    ds_read_b64_tr_b16 v[174:175], v147 offset:9472
    s_waitcnt lgkmcnt(12)
    v_mfma_f32_32x32x16_bf16 v[128:143], v[176:179], v[16:19], v[128:143]
    ds_read_b64_tr_b16 v[176:177], v147 offset:8704
    ds_read_b64_tr_b16 v[178:179], v147 offset:9728
    ds_write_b128 v252, a[132:135] offset:1024
    s_waitcnt lgkmcnt(13)
    v_mfma_f32_32x32x16_bf16 v[128:143], v[180:183], v[20:23], v[128:143]
    ds_read_b64_tr_b16 v[180:181], v147 offset:8960
    ds_read_b64_tr_b16 v[182:183], v147 offset:9984
    s_waitcnt lgkmcnt(12)
    v_mfma_f32_32x32x16_bf16 v[128:143], v[160:163], v[24:27], v[128:143]
    ds_read_b64_tr_b16 v[160:161], v147 offset:12288
    ds_read_b64_tr_b16 v[162:163], v147 offset:13312
    v_add_f32 v196, v196, v198
    v_add_f32 v197, v197, v199
    s_waitcnt lgkmcnt(12)
    v_mfma_f32_32x32x16_bf16 v[128:143], v[164:167], v[28:31], v[128:143]
    ds_read_b64_tr_b16 v[164:165], v147 offset:12544
    ds_read_b64_tr_b16 v[166:167], v147 offset:13568
    v_add_f32 v196, v196, v197
    v_cvt_pk_bf16_f32 v197, v196, v196
    s_waitcnt lgkmcnt(11)
    v_mfma_f32_32x32x16_bf16 v[128:143], v[168:171], v[32:35], v[128:143]
    ds_read_b64_tr_b16 v[168:169], v147 offset:12800
    ds_read_b64_tr_b16 v[170:171], v147 offset:13824
    ds_write_b128 v252, a[136:139] offset:2048
    v_and_b32 v197, 0xffff0000, v197
    v_sub_f32 v196, v196, v197
    s_waitcnt lgkmcnt(12)
    v_mfma_f32_32x32x16_bf16 v[128:143], v[172:175], v[36:39], v[128:143]
    ds_read_b64_tr_b16 v[172:173], v147 offset:13056
    ds_read_b64_tr_b16 v[174:175], v147 offset:14080
    v_cvt_pk_bf16_f32 v200, v197, v196
    v_mov_b32 v201, 0
    s_waitcnt lgkmcnt(12)
    v_mfma_f32_32x32x16_bf16 v[128:143], v[176:179], v[40:43], v[128:143]
    ds_read_b64_tr_b16 v[176:177], v147 offset:16384
    ds_read_b64_tr_b16 v[178:179], v147 offset:17408
L_pad5:
    s_cbranch_execz L_back_8
    v_mov_b32 v202, v246
    v_mov_b32 v203, 0
    s_waitcnt lgkmcnt(11)
    v_mfma_f32_32x32x16_bf16 v[128:143], v[180:183], v[44:47], v[128:143]
    ds_read_b64_tr_b16 v[180:181], v147 offset:16640
    ds_read_b64_tr_b16 v[182:183], v147 offset:17664
    s_waitcnt lgkmcnt(11)
    v_mfma_f32_32x32x8_bf16 v[128:143], v[200:201], v[202:203], v[128:143]
    v_mfma_f32_32x32x16_bf16 v[128:143], v[160:163], v[48:51], v[128:143]
    ds_read_b64_tr_b16 v[160:161], v147 offset:16896
    ds_read_b64_tr_b16 v[162:163], v147 offset:17920
    ds_write_b128 v252, a[140:143] offset:3072
    s_waitcnt lgkmcnt(12)
    v_mfma_f32_32x32x16_bf16 v[128:143], v[164:167], v[52:55], v[128:143]
    ds_read_b64_tr_b16 v[164:165], v147 offset:17152
    ds_read_b64_tr_b16 v[166:167], v147 offset:18176
    s_waitcnt lgkmcnt(12)
    v_mfma_f32_32x32x16_bf16 v[128:143], v[168:171], v[56:59], v[128:143]
    ds_read_b64_tr_b16 v[168:169], v147 offset:20480
    ds_read_b64_tr_b16 v[170:171], v147 offset:21504
    s_waitcnt lgkmcnt(11)
    v_mfma_f32_32x32x16_bf16 v[128:143], v[172:175], v[60:63], v[128:143]
    ds_read_b64_tr_b16 v[172:173], v147 offset:20736
    ds_read_b64_tr_b16 v[174:175], v147 offset:21760
    s_waitcnt lgkmcnt(11)
    v_mfma_f32_32x32x16_bf16 v[128:143], v[176:179], v[64:67], v[128:143]
    ds_read_b64_tr_b16 v[176:177], v147 offset:20992
    ds_read_b64_tr_b16 v[178:179], v147 offset:22016
    ds_write_b128 v252, a[144:147] offset:4096
    s_waitcnt lgkmcnt(12)
    v_mfma_f32_32x32x16_bf16 v[128:143], v[180:183], v[68:71], v[128:143]
    ds_read_b64_tr_b16 v[180:181], v147 offset:21248
    ds_read_b64_tr_b16 v[182:183], v147 offset:22272
    s_waitcnt lgkmcnt(12)
    v_mfma_f32_32x32x16_bf16 v[128:143], v[160:163], v[72:75], v[128:143]
    ds_read_b64_tr_b16 v[160:161], v147 offset:24576
    ds_read_b64_tr_b16 v[162:163], v147 offset:25600
    s_waitcnt lgkmcnt(11)
    v_mfma_f32_32x32x16_bf16 v[128:143], v[164:167], v[76:79], v[128:143]
    ds_read_b64_tr_b16 v[164:165], v147 offset:24832
    ds_read_b64_tr_b16 v[166:167], v147 offset:25856
    ds_write_b128 v252, a[148:151] offset:5120
    s_waitcnt lgkmcnt(12)
    v_mfma_f32_32x32x16_bf16 v[128:143], v[168:171], v[80:83], v[128:143]
    ds_read_b64_tr_b16 v[168:169], v147 offset:25088
    ds_read_b64_tr_b16 v[170:171], v147 offset:26112
    s_waitcnt lgkmcnt(12)
    v_mfma_f32_32x32x16_bf16 v[128:143], v[172:175], v[84:87], v[128:143]
    ds_read_b64_tr_b16 v[172:173], v147 offset:25344
    ds_read_b64_tr_b16 v[174:175], v147 offset:26368
    s_waitcnt lgkmcnt(12)
    v_mfma_f32_32x32x16_bf16 v[128:143], v[176:179], v[88:91], v[128:143]
    s_cmp_lt_u32 s36, 2
    s_cbranch_scc0 L_skip_39
    s_add_u32 s56, s49, 524288
    buffer_load_dwordx4 v[32:35], v240, s[24:27], s56 offen sc1
    s_add_u32 s56, s49, 0
    buffer_load_dwordx4 v[0:3], v240, s[24:27], s56 offen sc1
    s_add_u32 s56, s49, 65536
    buffer_load_dwordx4 v[4:7], v240, s[24:27], s56 offen sc1
L_skip_39:
    ds_read_b64_tr_b16 v[176:177], v147 offset:28672
    ds_read_b64_tr_b16 v[178:179], v147 offset:29696
    s_waitcnt lgkmcnt(11)
    v_mfma_f32_32x32x16_bf16 v[128:143], v[180:183], v[92:95], v[128:143]
    ds_read_b64_tr_b16 v[180:181], v147 offset:28928
    ds_read_b64_tr_b16 v[182:183], v147 offset:29952
    ds_write_b128 v252, a[152:155] offset:6144
    s_waitcnt lgkmcnt(12)
    v_mfma_f32_32x32x16_bf16 v[128:143], v[160:163], v[96:99], v[128:143]
    ds_read_b64_tr_b16 v[160:161], v147 offset:29184
    ds_read_b64_tr_b16 v[162:163], v147 offset:30208
    s_waitcnt lgkmcnt(12)
    v_mfma_f32_32x32x16_bf16 v[128:143], v[164:167], v[100:103], v[128:143]
    s_cmp_lt_u32 s36, 2
    s_cbranch_scc0 L_skip_40
    s_add_u32 s56, s49, 131072
    buffer_load_dwordx4 v[8:11], v240, s[24:27], s56 offen sc1
    s_add_u32 s56, s49, 196608
    buffer_load_dwordx4 v[12:15], v240, s[24:27], s56 offen sc1
    s_add_u32 s56, s49, 262144
    buffer_load_dwordx4 v[16:19], v240, s[24:27], s56 offen sc1
L_skip_40:
    ds_read_b64_tr_b16 v[164:165], v147 offset:29440
    ds_read_b64_tr_b16 v[166:167], v147 offset:30464
    s_waitcnt lgkmcnt(11)
    v_mfma_f32_32x32x16_bf16 v[128:143], v[168:171], v[104:107], v[128:143]
    s_waitcnt lgkmcnt(9)
    v_mfma_f32_32x32x16_bf16 v[128:143], v[172:175], v[108:111], v[128:143]
    ds_write_b128 v252, a[156:159] offset:7168
    v_and_b32 v36, 0x1f0, v240
    v_add_u32 v36, 0x27a60, v36
    ds_read_b128 v[36:39], v36
    s_waitcnt lgkmcnt(9)
    v_mfma_f32_32x32x16_bf16 v[128:143], v[176:179], v[112:115], v[128:143]
    s_cmp_lt_u32 s36, 2
    s_cbranch_scc0 L_skip_41
    s_add_u32 s56, s49, 327680
    buffer_load_dwordx4 v[20:23], v240, s[24:27], s56 offen sc1
    s_add_u32 s56, s49, 393216
    buffer_load_dwordx4 v[24:27], v240, s[24:27], s56 offen sc1
    s_add_u32 s56, s49, 458752
    buffer_load_dwordx4 v[28:31], v240, s[24:27], s56 offen sc1
L_skip_41:
    s_waitcnt lgkmcnt(7)
    v_mfma_f32_32x32x16_bf16 v[128:143], v[180:183], v[116:119], v[128:143]
    s_waitcnt lgkmcnt(4)
    v_mfma_f32_32x32x16_bf16 v[128:143], v[160:163], v[120:123], v[128:143]
    s_waitcnt lgkmcnt(2)
    v_mfma_f32_32x32x16_bf16 v[128:143], v[164:167], v[124:127], v[128:143]
    s_nop 10
    s_nop 0
    v_pk_mul_f32 v[128:129], v[128:129], v[244:245] op_sel_hi:[1,0]
    v_pk_mul_f32 v[130:131], v[130:131], v[244:245] op_sel_hi:[1,0]
    v_pk_mul_f32 v[132:133], v[132:133], v[244:245] op_sel_hi:[1,0]
    v_pk_mul_f32 v[134:135], v[134:135], v[244:245] op_sel_hi:[1,0]
    v_pk_mul_f32 v[136:137], v[136:137], v[244:245] op_sel_hi:[1,0]
    v_pk_mul_f32 v[138:139], v[138:139], v[244:245] op_sel_hi:[1,0]
    v_pk_mul_f32 v[140:141], v[140:141], v[244:245] op_sel_hi:[1,0]
    v_pk_mul_f32 v[142:143], v[142:143], v[244:245] op_sel_hi:[1,0]
    v_exp_f32_e64 v192, v128 clamp
    v_max_f32 v128, s66, v128
    v_exp_f32_e64 v193, v129 clamp
    v_max_f32 v129, s66, v129
    v_exp_f32_e64 v194, v130 clamp
    v_max_f32 v130, s66, v130
    v_exp_f32_e64 v195, v131 clamp
    v_max_f32 v131, s66, v131
    v_exp_f32_e64 v196, v132 clamp
    v_max_f32 v132, s66, v132
    v_exp_f32_e64 v197, v133 clamp
    v_max_f32 v133, s66, v133
    v_exp_f32_e64 v198, v134 clamp
    v_max_f32 v134, s66, v134
    v_exp_f32_e64 v199, v135 clamp
    v_max_f32 v135, s66, v135
    v_exp_f32_e64 v200, v136 clamp
    v_max_f32 v136, s66, v136
    v_exp_f32_e64 v201, v137 clamp
    v_max_f32 v137, s66, v137
    v_exp_f32_e64 v202, v138 clamp
    v_max_f32 v138, s66, v138
    v_exp_f32_e64 v203, v139 clamp
    v_max_f32 v139, s66, v139
    v_exp_f32_e64 v204, v140 clamp
    v_max_f32 v140, s66, v140
    v_exp_f32_e64 v205, v141 clamp
    v_max_f32 v141, s66, v141
    v_exp_f32_e64 v206, v142 clamp
    v_max_f32 v142, s66, v142
    v_exp_f32_e64 v207, v143 clamp
    v_max_f32 v143, s66, v143
    v_pk_fma_f32 v[128:129], v[128:129], s[64:65], v[192:193]
    v_pk_fma_f32 v[130:131], v[130:131], s[64:65], v[194:195]
    v_pk_fma_f32 v[132:133], v[132:133], s[64:65], v[196:197]
    v_pk_fma_f32 v[134:135], v[134:135], s[64:65], v[198:199]
    v_cvt_pk_bf16_f32 v224, v128, v129
    v_cvt_pk_bf16_f32 v225, v130, v131
    v_cvt_pk_bf16_f32 v226, v132, v133
    v_cvt_pk_bf16_f32 v227, v134, v135
    v_pk_fma_f32 v[136:137], v[136:137], s[64:65], v[200:201]
    v_pk_fma_f32 v[138:139], v[138:139], s[64:65], v[202:203]
    v_pk_fma_f32 v[140:141], v[140:141], s[64:65], v[204:205]
    v_pk_fma_f32 v[142:143], v[142:143], s[64:65], v[206:207]
    v_cvt_pk_bf16_f32 v228, v136, v137
    v_cvt_pk_bf16_f32 v229, v138, v139
    v_cvt_pk_bf16_f32 v230, v140, v141
    v_cvt_pk_bf16_f32 v231, v142, v143
    v_mov_b32 v166, 0x358637bd
    v_xor_b32 v176, 32, v251
    v_xor_b32 v177, 64, v251
    v_xor_b32 v178, 96, v251
    s_add_u32 s1, s50, 48
    v_mov_b32 v179, s1
    s_waitcnt lgkmcnt(0)
    s_cmp_lt_u32 s36, 2
    s_cbranch_scc0 L_stub_42
L_chk2:
    s_waitcnt vmcnt(6)
    v_mfma_f32_16x16x32_bf16 v[40:43], v[36:39], v[0:3], 0
    v_max3_u32 v44, v32, v0, v4
    v_permlane16_swap_b32 v32, v33
    v_mfma_f32_16x16x32_bf16 v[40:43], v[36:39], v[4:7], v[40:43]
    v_permlane16_swap_b32 v34, v35
    s_waitcnt vmcnt(4)
    v_mfma_f32_16x16x32_bf16 v[40:43], v[36:39], v[8:11], v[40:43]
    v_add_f32 v32, v32, v33
    v_add_f32_e64 v34, v34, v35
    v_mfma_f32_16x16x32_bf16 v[40:43], v[36:39], v[12:15], v[40:43]
    v_max3_u32 v44, v44, v8, v12
    v_permlane32_swap_b32 v32, v34
    s_waitcnt vmcnt(2)
    v_mfma_f32_16x16x32_bf16 v[40:43], v[36:39], v[16:19], v[40:43]
    v_add_f32_e64 v32, v32, v34
    v_max3_u32 v44, v44, v16, v20
    v_mfma_f32_16x16x32_bf16 v[40:43], v[36:39], v[20:23], v[40:43]
    v_add_f32 v32, v32, v32 row_ror:4
    s_waitcnt vmcnt(0)
    v_mfma_f32_16x16x32_bf16 v[40:43], v[36:39], v[24:27], v[40:43]
    v_add_f32 v32, v32, v32 row_ror:8
    v_max3_u32 v44, v44, v24, v28
    v_mfma_f32_16x16x32_bf16 v[40:43], v[36:39], v[28:31], v[40:43]
    v_cmp_eq_u32 vcc, -1, v44
    v_cvt_pk_bf16_f32 v32, v32, v32
    ds_write_b16 v189, v32
    s_cbranch_vccnz L_again2
    s_nop 3
    v_cvt_pk_bf16_f32 v40, v40, v41
    v_cvt_pk_bf16_f32 v41, v42, v43
    ds_write_b64 v188, v[40:41]
L_pad10:
L_pad11:
L_back_43:
    s_mov_b64 exec, -1
    s_waitcnt vmcnt(0)
    s_waitcnt lgkmcnt(0)
    s_barrier
    ds_read_b128 v[0:3], v243 offset:0
    ds_read_b128 v[4:7], v243 offset:592
    ds_read_b128 v[16:19], v190 offset:0
    s_waitcnt lgkmcnt(2)
    v_mfma_f32_32x32x16_bf16 v[144:159], v[0:3], v[224:227], 0
    ds_read_b128 v[20:23], v190 offset:16
    s_waitcnt lgkmcnt(2)
    v_mfma_f32_32x32x16_bf16 v[144:159], v[4:7], v[228:231], v[144:159]
    s_waitcnt lgkmcnt(0)
    v_dot2c_f32_bf16 v166, v16, v224
    v_dot2c_f32_bf16 v166, v17, v225
    v_dot2c_f32_bf16 v166, v18, v226
    v_dot2c_f32_bf16 v166, v19, v227
    v_dot2c_f32_bf16 v166, v20, v228
    v_dot2c_f32_bf16 v166, v21, v229
    v_dot2c_f32_bf16 v166, v22, v230
    v_dot2c_f32_bf16 v166, v23, v231
    s_nop 2
    v_rcp_f32_e64 v166, v166
    s_cmp_eq_u32 s51, 0
    s_cbranch_scc0 L_glob_44
    v_pk_mul_f32 v[144:145], v[144:145], v[166:167] op_sel_hi:[1,0]
    v_pk_mul_f32 v[146:147], v[146:147], v[166:167] op_sel_hi:[1,0]
    v_pk_mul_f32 v[148:149], v[148:149], v[166:167] op_sel_hi:[1,0]
    v_pk_mul_f32 v[150:151], v[150:151], v[166:167] op_sel_hi:[1,0]
    v_cvt_pk_bf16_f32 v192, v144, v145
    v_cvt_pk_bf16_f32 v193, v146, v147
    v_cvt_pk_bf16_f32 v194, v148, v149
    v_cvt_pk_bf16_f32 v195, v150, v151
    buffer_store_dwordx4 v[192:195], v191, s[24:27], s42 offen offset:0
    v_pk_mul_f32 v[152:153], v[152:153], v[166:167] op_sel_hi:[1,0]
    v_pk_mul_f32 v[154:155], v[154:155], v[166:167] op_sel_hi:[1,0]
    v_pk_mul_f32 v[156:157], v[156:157], v[166:167] op_sel_hi:[1,0]
    v_pk_mul_f32 v[158:159], v[158:159], v[166:167] op_sel_hi:[1,0]
    v_cvt_pk_bf16_f32 v196, v152, v153
    v_cvt_pk_bf16_f32 v197, v154, v155
    v_cvt_pk_bf16_f32 v198, v156, v157
    v_cvt_pk_bf16_f32 v199, v158, v159
    buffer_store_dwordx4 v[196:199], v191, s[24:27], s42 offen offset:256
L_join_45:
    ds_write_b128 v252, a[160:163] offset:8192
    ds_write_b128 v252, a[164:167] offset:9216
    ds_write_b128 v252, a[168:171] offset:10240
    ds_write_b128 v252, a[172:175] offset:11264
    ds_write_b128 v252, a[176:179] offset:12288
    ds_write_b128 v252, a[180:183] offset:13312
    s_mov_b64 exec, 1
    s_cmp_eq_u32 s51, 0
    s_cbranch_scc0 L_glob_46
    s_waitcnt vmcnt(0)
    buffer_store_dword v179, off, s[24:27], s43
L_join_47:
    s_mov_b64 exec, -1
    s_branch L_overo2
L_moreo2:
    buffer_load_dword v234, v250, s[24:27], s45 offen offset:0 sc1
    s_sub_u32 s59, s59, 1
    s_cbranch_scc1 L_timeout
    s_waitcnt vmcnt(1)
    v_cmp_ne_u32_e64 vcc, s1, v235
    s_nop 0
    s_cbranch_vccz L_goo2
    s_branch L_spino2
L_overo2:
    ds_write_b128 v252, a[184:187] offset:14336
    ds_write_b128 v252, a[188:191] offset:15360
    ds_read_b64_tr_b16 v[64:65], v251 offset:0
    ds_read_b64_tr_b16 v[66:67], v251 offset:512
    ds_read_b64_tr_b16 v[68:69], v176 offset:16384
    ds_read_b64_tr_b16 v[70:71], v176 offset:16896
    ds_read_b64_tr_b16 v[72:73], v177 offset:32768
    ds_read_b64_tr_b16 v[74:75], v177 offset:33280
    ds_read_b64_tr_b16 v[76:77], v178 offset:49152
    ds_read_b64_tr_b16 v[78:79], v178 offset:49664
    s_mov_b64 exec, 0xffff
    buffer_load_dword v234, v250, s[24:27], s45 offen offset:0 sc1
    s_mov_b64 exec, -1
    ds_read_b64_tr_b16 v[80:81], v251 offset:1024
    ds_read_b64_tr_b16 v[82:83], v251 offset:1536
    ds_read_b64_tr_b16 v[84:85], v176 offset:17408
    ds_read_b64_tr_b16 v[86:87], v176 offset:17920
    ds_read_b64_tr_b16 v[88:89], v177 offset:33792
    ds_read_b64_tr_b16 v[90:91], v177 offset:34304
    ds_read_b64_tr_b16 v[92:93], v178 offset:50176
    ds_read_b64_tr_b16 v[94:95], v178 offset:50688
    ds_read_b64_tr_b16 v[96:97], v251 offset:2048
    ds_read_b64_tr_b16 v[98:99], v251 offset:2560
    ds_read_b64_tr_b16 v[100:101], v176 offset:18432
    ds_read_b64_tr_b16 v[102:103], v176 offset:18944
    ds_read_b64_tr_b16 v[104:105], v177 offset:34816
    ds_read_b64_tr_b16 v[106:107], v177 offset:35328
    ds_read_b64_tr_b16 v[108:109], v178 offset:51200
    ds_read_b64_tr_b16 v[110:111], v178 offset:51712
    ds_read_b64_tr_b16 v[112:113], v251 offset:3072
    ds_read_b64_tr_b16 v[114:115], v251 offset:3584
    ds_read_b64_tr_b16 v[116:117], v176 offset:19456
    ds_read_b64_tr_b16 v[118:119], v176 offset:19968
    s_mov_b64 exec, 0xffff
L_spino2:
    buffer_load_dword v235, v250, s[24:27], s45 offen offset:0 sc1
    s_waitcnt vmcnt(1)
    v_cmp_ne_u32 vcc, s1, v234
    s_nop 0
    s_cbranch_vccnz L_moreo2
L_goo2:
    s_mov_b64 exec, -1
    buffer_load_dwordx4 v[0:3], v240, s[24:27], s44 offen offset:0 sc1
    buffer_load_dwordx4 v[4:7], v240, s[24:27], s44 offen offset:1024 sc1
    buffer_load_dwordx4 v[8:11], v240, s[24:27], s44 offen offset:2048 sc1
    buffer_load_dwordx4 v[12:15], v240, s[24:27], s44 offen offset:3072 sc1
    s_waitcnt lgkmcnt(15)
    s_barrier
    ds_read_b64_tr_b16 v[120:121], v177 offset:35840
    ds_read_b64_tr_b16 v[122:123], v177 offset:36352
    ds_read_b64_tr_b16 v[124:125], v178 offset:52224
    ds_read_b64_tr_b16 v[126:127], v178 offset:52736
    ds_read_b64_tr_b16 v[128:129], v251 offset:4096
    ds_read_b64_tr_b16 v[130:131], v251 offset:4608
    ds_read_b64_tr_b16 v[132:133], v176 offset:20480
    s_xor_b32 s58, s44, 4096
    buffer_load_dwordx4 v[16:19], v240, s[24:27], s58 offen offset:0 sc1
    ds_read_b64_tr_b16 v[134:135], v176 offset:20992
    ds_read_b64_tr_b16 v[136:137], v177 offset:36864
    ds_read_b64_tr_b16 v[138:139], v177 offset:37376
    ds_read_b64_tr_b16 v[140:141], v178 offset:53248
    ds_read_b64_tr_b16 v[142:143], v178 offset:53760
    ds_read_b64_tr_b16 v[144:145], v251 offset:5120
    ds_read_b64_tr_b16 v[146:147], v251 offset:5632
    buffer_load_dwordx4 v[20:23], v240, s[24:27], s58 offen offset:1024 sc1
    ds_read_b64_tr_b16 v[148:149], v176 offset:21504
    ds_read_b64_tr_b16 v[150:151], v176 offset:22016
    ds_read_b64_tr_b16 v[152:153], v177 offset:37888
    ds_read_b64_tr_b16 v[154:155], v177 offset:38400
    ds_read_b64_tr_b16 v[156:157], v178 offset:54272
    ds_read_b64_tr_b16 v[158:159], v178 offset:54784
    ds_read_b64_tr_b16 v[160:161], v251 offset:6144
    buffer_load_dwordx4 v[24:27], v240, s[24:27], s58 offen offset:2048 sc1
    ds_read_b64_tr_b16 v[162:163], v251 offset:6656
    ds_read_b64_tr_b16 v[164:165], v176 offset:22528
    ds_read_b64_tr_b16 v[166:167], v176 offset:23040
    ds_read_b64_tr_b16 v[168:169], v177 offset:38912
    ds_read_b64_tr_b16 v[170:171], v177 offset:39424
    ds_read_b64_tr_b16 v[172:173], v178 offset:55296
    ds_read_b64_tr_b16 v[174:175], v178 offset:55808
    buffer_load_dwordx4 v[28:31], v240, s[24:27], s58 offen offset:3072 sc1
    s_waitcnt vmcnt(7)
    v_mfma_f32_16x16x32_bf16 v[208:211], v[64:67], v[0:3], v[208:211]
    s_xor_b32 s58, s44, 8192
    buffer_load_dwordx4 v[32:35], v240, s[24:27], s58 offen offset:0 sc1
    v_mfma_f32_16x16x32_bf16 v[212:215], v[68:71], v[0:3], v[212:215]
    ds_read_b64_tr_b16 v[64:65], v251 offset:7168
    ds_read_b64_tr_b16 v[66:67], v251 offset:7680
    v_mfma_f32_16x16x32_bf16 v[216:219], v[72:75], v[0:3], v[216:219]
    ds_read_b64_tr_b16 v[68:69], v176 offset:23552
    v_mfma_f32_16x16x32_bf16 v[220:223], v[76:79], v[0:3], v[220:223]
    ds_read_b64_tr_b16 v[70:71], v176 offset:24064
    s_waitcnt vmcnt(7) lgkmcnt(15)
    v_mfma_f32_16x16x32_bf16 v[208:211], v[80:83], v[4:7], v[208:211]
    buffer_load_dwordx4 v[36:39], v240, s[24:27], s58 offen offset:1024 sc1
    v_mfma_f32_16x16x32_bf16 v[212:215], v[84:87], v[4:7], v[212:215]
    ds_read_b64_tr_b16 v[72:73], v177 offset:39936
    ds_read_b64_tr_b16 v[74:75], v177 offset:40448
    v_mfma_f32_16x16x32_bf16 v[216:219], v[88:91], v[4:7], v[216:219]
    ds_read_b64_tr_b16 v[76:77], v178 offset:56320
    v_mfma_f32_16x16x32_bf16 v[220:223], v[92:95], v[4:7], v[220:223]
    ds_read_b64_tr_b16 v[78:79], v178 offset:56832
    s_waitcnt vmcnt(7)
    v_mfma_f32_16x16x32_bf16 v[208:211], v[96:99], v[8:11], v[208:211]
    buffer_load_dwordx4 v[40:43], v240, s[24:27], s58 offen offset:2048 sc1
    v_mfma_f32_16x16x32_bf16 v[212:215], v[100:103], v[8:11], v[212:215]
    ds_read_b64_tr_b16 v[80:81], v251 offset:8192
    ds_read_b64_tr_b16 v[82:83], v251 offset:8704
    v_mfma_f32_16x16x32_bf16 v[216:219], v[104:107], v[8:11], v[216:219]
    ds_read_b64_tr_b16 v[84:85], v176 offset:24576
    v_mfma_f32_16x16x32_bf16 v[220:223], v[108:111], v[8:11], v[220:223]
    ds_read_b64_tr_b16 v[86:87], v176 offset:25088
    s_waitcnt vmcnt(7)
    v_mfma_f32_16x16x32_bf16 v[208:211], v[112:115], v[12:15], v[208:211]
    buffer_load_dwordx4 v[44:47], v240, s[24:27], s58 offen offset:3072 sc1
    v_mfma_f32_16x16x32_bf16 v[212:215], v[116:119], v[12:15], v[212:215]
    ds_read_b64_tr_b16 v[88:89], v177 offset:40960
    ds_read_b64_tr_b16 v[90:91], v177 offset:41472
    v_mfma_f32_16x16x32_bf16 v[216:219], v[120:123], v[12:15], v[216:219]
    ds_read_b64_tr_b16 v[92:93], v178 offset:57344
    v_mfma_f32_16x16x32_bf16 v[220:223], v[124:127], v[12:15], v[220:223]
    ds_read_b64_tr_b16 v[94:95], v178 offset:57856
    s_waitcnt vmcnt(7)
    v_mfma_f32_16x16x32_bf16 v[208:211], v[128:131], v[16:19], v[208:211]
    s_xor_b32 s58, s44, 12288
    buffer_load_dwordx4 v[48:51], v240, s[24:27], s58 offen offset:0 sc1
    v_mfma_f32_16x16x32_bf16 v[212:215], v[132:135], v[16:19], v[212:215]
    ds_read_b64_tr_b16 v[96:97], v251 offset:9216
    ds_read_b64_tr_b16 v[98:99], v251 offset:9728
    v_mfma_f32_16x16x32_bf16 v[216:219], v[136:139], v[16:19], v[216:219]
    ds_read_b64_tr_b16 v[100:101], v176 offset:25600
    v_mfma_f32_16x16x32_bf16 v[220:223], v[140:143], v[16:19], v[220:223]
    ds_read_b64_tr_b16 v[102:103], v176 offset:26112
    s_waitcnt vmcnt(7) lgkmcnt(15)
    v_mfma_f32_16x16x32_bf16 v[208:211], v[144:147], v[20:23], v[208:211]
    buffer_load_dwordx4 v[52:55], v240, s[24:27], s58 offen offset:1024 sc1
    v_mfma_f32_16x16x32_bf16 v[212:215], v[148:151], v[20:23], v[212:215]
    ds_read_b64_tr_b16 v[104:105], v177 offset:41984
    ds_read_b64_tr_b16 v[106:107], v177 offset:42496
    v_mfma_f32_16x16x32_bf16 v[216:219], v[152:155], v[20:23], v[216:219]
    ds_read_b64_tr_b16 v[108:109], v178 offset:58368
    v_mfma_f32_16x16x32_bf16 v[220:223], v[156:159], v[20:23], v[220:223]
    ds_read_b64_tr_b16 v[110:111], v178 offset:58880
    s_waitcnt vmcnt(7)
    v_mfma_f32_16x16x32_bf16 v[208:211], v[160:163], v[24:27], v[208:211]
    buffer_load_dwordx4 v[56:59], v240, s[24:27], s58 offen offset:2048 sc1
    v_mfma_f32_16x16x32_bf16 v[212:215], v[164:167], v[24:27], v[212:215]
    ds_read_b64_tr_b16 v[112:113], v251 offset:10240
    ds_read_b64_tr_b16 v[114:115], v251 offset:10752
    v_mfma_f32_16x16x32_bf16 v[216:219], v[168:171], v[24:27], v[216:219]
    ds_read_b64_tr_b16 v[116:117], v176 offset:26624
    v_mfma_f32_16x16x32_bf16 v[220:223], v[172:175], v[24:27], v[220:223]
    ds_read_b64_tr_b16 v[118:119], v176 offset:27136
    s_waitcnt vmcnt(7) lgkmcnt(15)
    v_mfma_f32_16x16x32_bf16 v[208:211], v[64:67], v[28:31], v[208:211]
    buffer_load_dwordx4 v[60:63], v240, s[24:27], s58 offen offset:3072 sc1
    v_mfma_f32_16x16x32_bf16 v[212:215], v[68:71], v[28:31], v[212:215]
    ds_read_b64_tr_b16 v[120:121], v177 offset:43008
    ds_read_b64_tr_b16 v[122:123], v177 offset:43520
    v_mfma_f32_16x16x32_bf16 v[216:219], v[72:75], v[28:31], v[216:219]
    ds_read_b64_tr_b16 v[124:125], v178 offset:59392
    v_mfma_f32_16x16x32_bf16 v[220:223], v[76:79], v[28:31], v[220:223]
    ds_read_b64_tr_b16 v[126:127], v178 offset:59904
    s_waitcnt vmcnt(7) lgkmcnt(15)
    v_mfma_f32_16x16x32_bf16 v[208:211], v[80:83], v[32:35], v[208:211]
    ds_read_b64_tr_b16 v[128:129], v251 offset:11264
    ds_read_b64_tr_b16 v[130:131], v251 offset:11776
    v_mfma_f32_16x16x32_bf16 v[212:215], v[84:87], v[32:35], v[212:215]
    ds_read_b64_tr_b16 v[132:133], v176 offset:27648
    ds_read_b64_tr_b16 v[134:135], v176 offset:28160
    v_mfma_f32_16x16x32_bf16 v[216:219], v[88:91], v[32:35], v[216:219]
    ds_read_b64_tr_b16 v[136:137], v177 offset:44032
    ds_read_b64_tr_b16 v[138:139], v177 offset:44544
    v_mfma_f32_16x16x32_bf16 v[220:223], v[92:95], v[32:35], v[220:223]
    ds_read_b64_tr_b16 v[140:141], v178 offset:60416
    s_waitcnt vmcnt(6) lgkmcnt(15)
    v_mfma_f32_16x16x32_bf16 v[208:211], v[96:99], v[36:39], v[208:211]
    ds_read_b64_tr_b16 v[142:143], v178 offset:60928
    ds_read_b64_tr_b16 v[144:145], v251 offset:12288
    v_mfma_f32_16x16x32_bf16 v[212:215], v[100:103], v[36:39], v[212:215]
    ds_read_b64_tr_b16 v[146:147], v251 offset:12800
    ds_read_b64_tr_b16 v[148:149], v176 offset:28672
    v_mfma_f32_16x16x32_bf16 v[216:219], v[104:107], v[36:39], v[216:219]
    ds_read_b64_tr_b16 v[150:151], v176 offset:29184
    ds_read_b64_tr_b16 v[152:153], v177 offset:45056
    v_mfma_f32_16x16x32_bf16 v[220:223], v[108:111], v[36:39], v[220:223]
    ds_read_b64_tr_b16 v[154:155], v177 offset:45568
    s_waitcnt vmcnt(5) lgkmcnt(14)
    v_mfma_f32_16x16x32_bf16 v[208:211], v[112:115], v[40:43], v[208:211]
    ds_read_b64_tr_b16 v[156:157], v178 offset:61440
    ds_read_b64_tr_b16 v[158:159], v178 offset:61952
    v_mfma_f32_16x16x32_bf16 v[212:215], v[116:119], v[40:43], v[212:215]
    ds_read_b64_tr_b16 v[160:161], v251 offset:13312
    ds_read_b64_tr_b16 v[162:163], v251 offset:13824
    v_mfma_f32_16x16x32_bf16 v[216:219], v[120:123], v[40:43], v[216:219]
    ds_read_b64_tr_b16 v[164:165], v176 offset:29696
    ds_read_b64_tr_b16 v[166:167], v176 offset:30208
    v_mfma_f32_16x16x32_bf16 v[220:223], v[124:127], v[40:43], v[220:223]
    ds_read_b64_tr_b16 v[168:169], v177 offset:46080
    s_waitcnt vmcnt(4) lgkmcnt(13)
    v_mfma_f32_16x16x32_bf16 v[208:211], v[128:131], v[44:47], v[208:211]
    ds_read_b64_tr_b16 v[170:171], v177 offset:46592
    ds_read_b64_tr_b16 v[172:173], v178 offset:62464
    v_mfma_f32_16x16x32_bf16 v[212:215], v[132:135], v[44:47], v[212:215]
    ds_read_b64_tr_b16 v[174:175], v178 offset:62976
    ds_read_b64_tr_b16 v[64:65], v251 offset:14336
    v_mfma_f32_16x16x32_bf16 v[216:219], v[136:139], v[44:47], v[216:219]
    ds_read_b64_tr_b16 v[66:67], v251 offset:14848
    ds_read_b64_tr_b16 v[68:69], v176 offset:30720
    v_mfma_f32_16x16x32_bf16 v[220:223], v[140:143], v[44:47], v[220:223]
    ds_read_b64_tr_b16 v[70:71], v176 offset:31232
    s_waitcnt vmcnt(3) lgkmcnt(12)
    v_mfma_f32_16x16x32_bf16 v[208:211], v[144:147], v[48:51], v[208:211]
    ds_read_b64_tr_b16 v[72:73], v177 offset:47104
    ds_read_b64_tr_b16 v[74:75], v177 offset:47616
    v_mfma_f32_16x16x32_bf16 v[212:215], v[148:151], v[48:51], v[212:215]
    ds_read_b64_tr_b16 v[76:77], v178 offset:63488
    ds_read_b64_tr_b16 v[78:79], v178 offset:64000
    v_mfma_f32_16x16x32_bf16 v[216:219], v[152:155], v[48:51], v[216:219]
    ds_read_b64_tr_b16 v[80:81], v251 offset:15360
    ds_read_b64_tr_b16 v[82:83], v251 offset:15872
    v_mfma_f32_16x16x32_bf16 v[220:223], v[156:159], v[48:51], v[220:223]
    ds_read_b64_tr_b16 v[84:85], v176 offset:31744
    s_waitcnt vmcnt(2) lgkmcnt(11)
    v_mfma_f32_16x16x32_bf16 v[208:211], v[160:163], v[52:55], v[208:211]
    ds_read_b64_tr_b16 v[86:87], v176 offset:32256
    ds_read_b64_tr_b16 v[88:89], v177 offset:48128
    v_mfma_f32_16x16x32_bf16 v[212:215], v[164:167], v[52:55], v[212:215]
    ds_read_b64_tr_b16 v[90:91], v177 offset:48640
    ds_read_b64_tr_b16 v[92:93], v178 offset:64512
    v_mfma_f32_16x16x32_bf16 v[216:219], v[168:171], v[52:55], v[216:219]
    ds_read_b64_tr_b16 v[94:95], v178 offset:65024
    v_mfma_f32_16x16x32_bf16 v[220:223], v[172:175], v[52:55], v[220:223]
    s_waitcnt vmcnt(1) lgkmcnt(8)
    v_mfma_f32_16x16x32_bf16 v[208:211], v[64:67], v[56:59], v[208:211]
    v_mfma_f32_16x16x32_bf16 v[212:215], v[68:71], v[56:59], v[212:215]
    v_mfma_f32_16x16x32_bf16 v[216:219], v[72:75], v[56:59], v[216:219]
    v_mfma_f32_16x16x32_bf16 v[220:223], v[76:79], v[56:59], v[220:223]
    s_waitcnt vmcnt(0) lgkmcnt(0)
    v_mfma_f32_16x16x32_bf16 v[208:211], v[80:83], v[60:63], v[208:211]
    v_mfma_f32_16x16x32_bf16 v[212:215], v[84:87], v[60:63], v[212:215]
    v_mfma_f32_16x16x32_bf16 v[216:219], v[88:91], v[60:63], v[216:219]
    v_mfma_f32_16x16x32_bf16 v[220:223], v[92:95], v[60:63], v[220:223]
    s_cmp_eq_u32 s51, 0
    s_cbranch_scc0 L_glob_48
    s_nop 1
    s_nop 0
    v_cvt_pk_bf16_f32 v128, v208, v209
    v_cvt_pk_bf16_f32 v129, v210, v211
    v_cvt_pk_bf16_f32 v130, v212, v213
    v_cvt_pk_bf16_f32 v131, v214, v215
    buffer_store_dwordx4 v[128:131], v247, s[28:31], s46 offen offset:0
    v_cvt_pk_bf16_f32 v132, v216, v217
    v_cvt_pk_bf16_f32 v133, v218, v219
    v_cvt_pk_bf16_f32 v134, v220, v221
    v_cvt_pk_bf16_f32 v135, v222, v223
    buffer_store_dwordx4 v[132:135], v247, s[28:31], s46 offen offset:512
L_join_49:
    v_pk_add_f32 v[136:137], v[208:209], v[210:211]
    v_pk_mul_f32 v[138:139], v[208:209], v[208:209]
    v_pk_fma_f32 v[138:139], v[210:211], v[210:211], v[138:139]
    v_pk_add_f32 v[136:137], v[136:137], v[212:213]
    v_pk_fma_f32 v[138:139], v[212:213], v[212:213], v[138:139]
    v_pk_add_f32 v[136:137], v[136:137], v[214:215]
    v_pk_fma_f32 v[138:139], v[214:215], v[214:215], v[138:139]
    v_pk_add_f32 v[136:137], v[136:137], v[216:217]
    v_pk_fma_f32 v[138:139], v[216:217], v[216:217], v[138:139]
    v_pk_add_f32 v[136:137], v[136:137], v[218:219]
    v_pk_fma_f32 v[138:139], v[218:219], v[218:219], v[138:139]
    v_pk_add_f32 v[136:137], v[136:137], v[220:221]
    v_pk_fma_f32 v[138:139], v[220:221], v[220:221], v[138:139]
    v_pk_add_f32 v[136:137], v[136:137], v[222:223]
    v_pk_fma_f32 v[138:139], v[222:223], v[222:223], v[138:139]
    v_add_f32 v136, v136, v137
    v_add_f32 v138, v138, v139
    s_nop 1
    v_permlane32_swap_b32 v136, v138
    v_add_f32 v136, v136, v138
    v_mov_b32 v137, v136
    s_cmp_eq_u32 s51, 0
    s_cbranch_scc0 L_glob_50
    v_permlane16_swap_b32 v136, v137
    s_mov_b64 exec, s[96:97]
    v_add_f32 v136, v136, v137
    v_or_b32 v136, 1, v136
    buffer_store_dword v136, v248, s[24:27], s47 offen
L_join_51:
    s_mov_b64 exec, -1
    s_barrier
    ds_write_b128 v253, a[64:67] offset:0
    ds_write_b128 v253, a[68:71] offset:2048
    ds_write_b128 v253, a[72:75] offset:4096
    ds_write_b128 v253, a[76:79] offset:6144
    s_add_u32 s49, s49, 589824
    s_mov_b64 exec, 1
    s_cmp_eq_u32 s51, 0
    s_cbranch_scc0 L_glob_52
    s_waitcnt vmcnt(1)
    buffer_store_dword v179, off, s[24:27], s48
L_join_53:
    s_mov_b64 exec, -1
    s_branch L_overx3
L_morex3:
    buffer_load_dword v234, v250, s[24:27], s41 offen offset:0 sc1
    s_sub_u32 s59, s59, 1
    s_cbranch_scc1 L_timeout
    s_waitcnt vmcnt(1)
    v_cmp_ne_u32_e64 vcc, s1, v235
    s_nop 0
    s_cbranch_vccz L_gox3
    s_branch L_spinx3
L_overx3:
    ds_write_b128 v253, a[80:83] offset:8192
    ds_write_b128 v253, a[84:87] offset:10240
    ds_write_b128 v253, a[88:91] offset:12288
    ds_write_b128 v253, a[92:95] offset:14336
    ds_write_b128 v253, a[96:99] offset:16384
    s_mov_b64 exec, 0xffff
    buffer_load_dword v234, v250, s[24:27], s41 offen offset:0 sc1
    s_mov_b64 exec, -1
    ds_write_b128 v253, a[100:103] offset:18432
    ds_write_b128 v253, a[104:107] offset:20480
    ds_write_b128 v253, a[108:111] offset:22528
L_layer3:
    s_mov_b64 exec, 0xffff
L_spinx3:
L_pad6:
    s_cbranch_execz L_back_18
    buffer_load_dword v235, v250, s[24:27], s41 offen offset:0 sc1
    s_waitcnt vmcnt(1)
    v_cmp_ne_u32_e64 vcc, s1, v234
    s_nop 0
    s_cbranch_vccnz L_morex3
L_gox3:
    s_mov_b64 exec, -1
    buffer_load_dwordx4 v[0:3], v240, s[28:31], s39 offen offset:0 sc1
    buffer_load_dwordx4 v[4:7], v240, s[28:31], s39 offen offset:1024 sc1
    buffer_load_dwordx4 v[8:11], v240, s[28:31], s39 offen offset:2048 sc1
    buffer_load_dwordx4 v[12:15], v240, s[28:31], s39 offen offset:3072 sc1
    ds_write_b128 v253, a[112:115] offset:24576
    s_xor_b32 s58, s39, 4096
    buffer_load_dwordx4 v[16:19], v240, s[28:31], s58 offen offset:0 sc1
    ds_write_b128 v253, a[116:119] offset:26624
    buffer_load_dwordx4 v[20:23], v240, s[28:31], s58 offen offset:1024 sc1
    ds_write_b128 v253, a[120:123] offset:28672
    buffer_load_dwordx4 v[24:27], v240, s[28:31], s58 offen offset:2048 sc1
    ds_write_b128 v253, a[124:127] offset:30720
    buffer_load_dwordx4 v[28:31], v240, s[28:31], s58 offen offset:3072 sc1
    s_waitcnt lgkmcnt(0)
    s_barrier
    ds_read_b64_tr_b16 v[160:161], v241 offset:0
    ds_read_b64_tr_b16 v[162:163], v241 offset:1024
    ds_read_b64_tr_b16 v[164:165], v241 offset:32768
    ds_read_b64_tr_b16 v[166:167], v241 offset:33792
    ds_read_b64_tr_b16 v[168:169], v241 offset:256
    ds_read_b64_tr_b16 v[170:171], v241 offset:1280
    ds_read_b64_tr_b16 v[172:173], v241 offset:33024
    ds_read_b64_tr_b16 v[174:175], v241 offset:34048
    ds_read_b64_tr_b16 v[176:177], v241 offset:512
    ds_read_b64_tr_b16 v[178:179], v241 offset:1536
    ds_read_b64_tr_b16 v[180:181], v241 offset:33280
    ds_read_b64_tr_b16 v[182:183], v241 offset:34304
    ds_read_b128 v[200:203], v254 offset:1536
    ds_read_b128 v[204:207], v254 offset:2048
    s_waitcnt vmcnt(7) lgkmcnt(10)
    v_mfma_f32_32x32x16_bf16 v[128:143], v[160:163], v[0:3], 0
    s_xor_b32 s58, s39, 8192
    buffer_load_dwordx4 v[32:35], v240, s[28:31], s58 offen offset:0 sc1
    ds_read_b64_tr_b16 v[160:161], v241 offset:768
    ds_read_b64_tr_b16 v[162:163], v241 offset:1792
    v_mfma_f32_32x32x16_bf16 v[144:159], v[164:167], v[0:3], 0
    v_mov_b32 v227, 0
    ds_read_b64_tr_b16 v[164:165], v241 offset:33536
    ds_read_b64_tr_b16 v[166:167], v241 offset:34560
    v_mov_b32 v228, 0
    s_waitcnt vmcnt(7) lgkmcnt(10)
    v_mfma_f32_32x32x16_bf16 v[128:143], v[168:171], v[4:7], v[128:143]
    buffer_load_dwordx4 v[36:39], v240, s[28:31], s58 offen offset:1024 sc1
    buffer_load_dwordx4 v[192:195], v249, s[24:27], s40 offen sc1
    ds_read_b64_tr_b16 v[168:169], v241 offset:4096
    ds_read_b64_tr_b16 v[170:171], v241 offset:5120
    v_mfma_f32_32x32x16_bf16 v[144:159], v[172:175], v[4:7], v[144:159]
    ds_read_b64_tr_b16 v[172:173], v241 offset:36864
    ds_read_b64_tr_b16 v[174:175], v241 offset:37888
    s_waitcnt vmcnt(8) lgkmcnt(10)
    v_mfma_f32_32x32x16_bf16 v[128:143], v[176:179], v[8:11], v[128:143]
    buffer_load_dwordx4 v[40:43], v240, s[28:31], s58 offen offset:2048 sc1
    ds_read_b64_tr_b16 v[176:177], v241 offset:4352
    ds_read_b64_tr_b16 v[178:179], v241 offset:5376
    v_mfma_f32_32x32x16_bf16 v[144:159], v[180:183], v[8:11], v[144:159]
    ds_read_b64_tr_b16 v[180:181], v241 offset:37120
    ds_read_b64_tr_b16 v[182:183], v241 offset:38144
    s_waitcnt vmcnt(8) lgkmcnt(8)
    v_mfma_f32_32x32x16_bf16 v[128:143], v[160:163], v[12:15], v[128:143]
    buffer_load_dwordx4 v[44:47], v240, s[28:31], s58 offen offset:3072 sc1
    buffer_load_dwordx4 v[196:199], v249, s[24:27], s40 offen offset:512 sc1
    ds_read_b64_tr_b16 v[160:161], v241 offset:4608
    ds_read_b64_tr_b16 v[162:163], v241 offset:5632
    v_mfma_f32_32x32x16_bf16 v[144:159], v[164:167], v[12:15], v[144:159]
    v_add_f32_e64 v200, v200, v202
    ds_read_b64_tr_b16 v[164:165], v241 offset:37376
    ds_read_b64_tr_b16 v[166:167], v241 offset:38400
    v_add_f32 v201, v201, v203
    s_waitcnt vmcnt(9) lgkmcnt(8)
    v_mfma_f32_32x32x16_bf16 v[128:143], v[168:171], v[16:19], v[128:143]
    s_xor_b32 s58, s39, 12288
    buffer_load_dwordx4 v[48:51], v240, s[28:31], s58 offen offset:0 sc1
    ds_read_b64_tr_b16 v[168:169], v241 offset:4864
    ds_read_b64_tr_b16 v[170:171], v241 offset:5888
    v_mfma_f32_32x32x16_bf16 v[144:159], v[172:175], v[16:19], v[144:159]
    v_add_f32_e64 v200, v200, v201
    ds_read_b64_tr_b16 v[172:173], v241 offset:37632
    ds_read_b64_tr_b16 v[174:175], v241 offset:38656
    v_cvt_pk_bf16_f32 v201, v200, v200
    s_waitcnt vmcnt(9) lgkmcnt(8)
    v_mfma_f32_32x32x16_bf16 v[128:143], v[176:179], v[20:23], v[128:143]
    buffer_load_dwordx4 v[52:55], v240, s[28:31], s58 offen offset:1024 sc1
    ds_read_b64_tr_b16 v[176:177], v241 offset:8192
    ds_read_b64_tr_b16 v[178:179], v241 offset:9216
    v_mfma_f32_32x32x16_bf16 v[144:159], v[180:183], v[20:23], v[144:159]
    v_and_b32 v201, 0xffff0000, v201
    ds_read_b64_tr_b16 v[180:181], v241 offset:40960
    ds_read_b64_tr_b16 v[182:183], v241 offset:41984
    v_sub_f32 v200, v200, v201
    s_waitcnt vmcnt(9) lgkmcnt(8)
    v_mfma_f32_32x32x16_bf16 v[128:143], v[160:163], v[24:27], v[128:143]
    buffer_load_dwordx4 v[56:59], v240, s[28:31], s58 offen offset:2048 sc1
    ds_read_b64_tr_b16 v[160:161], v241 offset:8448
    ds_read_b64_tr_b16 v[162:163], v241 offset:9472
    v_mfma_f32_32x32x16_bf16 v[144:159], v[164:167], v[24:27], v[144:159]
    v_cvt_pk_bf16_f32 v224, v201, v200
    ds_read_b64_tr_b16 v[164:165], v241 offset:41216
    ds_read_b64_tr_b16 v[166:167], v241 offset:42240
    v_add_f32 v204, v204, v206
    s_waitcnt vmcnt(9) lgkmcnt(8)
    v_mfma_f32_32x32x16_bf16 v[128:143], v[168:171], v[28:31], v[128:143]
    buffer_load_dwordx4 v[60:63], v240, s[28:31], s58 offen offset:3072 sc1
    ds_read_b64_tr_b16 v[168:169], v241 offset:8704
    ds_read_b64_tr_b16 v[170:171], v241 offset:9728
    v_mfma_f32_32x32x16_bf16 v[144:159], v[172:175], v[28:31], v[144:159]
    v_add_f32 v205, v205, v207
    ds_read_b64_tr_b16 v[172:173], v241 offset:41472
    ds_read_b64_tr_b16 v[174:175], v241 offset:42496
    v_add_f32 v204, v204, v205
    s_waitcnt vmcnt(9) lgkmcnt(8)
    v_mfma_f32_32x32x16_bf16 v[128:143], v[176:179], v[32:35], v[128:143]
    s_xor_b32 s58, s39, 16384
    buffer_load_dwordx4 v[64:67], v240, s[28:31], s58 offen offset:0 sc1
    ds_read_b64_tr_b16 v[176:177], v241 offset:8960
    ds_read_b64_tr_b16 v[178:179], v241 offset:9984
    v_mfma_f32_32x32x16_bf16 v[144:159], v[180:183], v[32:35], v[144:159]
    v_cvt_pk_bf16_f32 v205, v204, v204
    ds_read_b64_tr_b16 v[180:181], v241 offset:41728
    ds_read_b64_tr_b16 v[182:183], v241 offset:42752
    v_and_b32 v205, 0xffff0000, v205
    s_waitcnt vmcnt(9) lgkmcnt(8)
    v_mfma_f32_32x32x16_bf16 v[128:143], v[160:163], v[36:39], v[128:143]
    buffer_load_dwordx4 v[68:71], v240, s[28:31], s58 offen offset:1024 sc1
    ds_read_b64_tr_b16 v[160:161], v241 offset:12288
    ds_read_b64_tr_b16 v[162:163], v241 offset:13312
    v_mfma_f32_32x32x16_bf16 v[144:159], v[164:167], v[36:39], v[144:159]
    v_sub_f32 v204, v204, v205
    ds_read_b64_tr_b16 v[164:165], v241 offset:45056
    ds_read_b64_tr_b16 v[166:167], v241 offset:46080
    v_cvt_pk_bf16_f32 v225, v205, v204
    s_waitcnt vmcnt(8) lgkmcnt(8)
    v_mfma_f32_32x32x16_bf16 v[128:143], v[168:171], v[40:43], v[128:143]
    buffer_load_dwordx4 v[72:75], v240, s[28:31], s58 offen offset:2048 sc1
    ds_read_b64_tr_b16 v[168:169], v241 offset:12544
    ds_read_b64_tr_b16 v[170:171], v241 offset:13568
    v_mfma_f32_32x32x16_bf16 v[144:159], v[172:175], v[40:43], v[144:159]
    ds_read_b64_tr_b16 v[172:173], v241 offset:45312
    ds_read_b64_tr_b16 v[174:175], v241 offset:46336
    s_waitcnt vmcnt(8) lgkmcnt(8)
    v_mfma_f32_32x32x16_bf16 v[128:143], v[176:179], v[44:47], v[128:143]
    buffer_load_dwordx4 v[76:79], v240, s[28:31], s58 offen offset:3072 sc1
    ds_read_b64_tr_b16 v[176:177], v241 offset:12800
    ds_read_b64_tr_b16 v[178:179], v241 offset:13824
    v_mfma_f32_32x32x16_bf16 v[144:159], v[180:183], v[44:47], v[144:159]
    ds_read_b64_tr_b16 v[180:181], v241 offset:45568
    ds_read_b64_tr_b16 v[182:183], v241 offset:46592
    s_waitcnt vmcnt(7) lgkmcnt(8)
    v_mfma_f32_32x32x16_bf16 v[128:143], v[160:163], v[48:51], v[128:143]
    s_xor_b32 s58, s39, 20480
    buffer_load_dwordx4 v[80:83], v240, s[28:31], s58 offen offset:0 sc1
    ds_read_b64_tr_b16 v[160:161], v241 offset:13056
    ds_read_b64_tr_b16 v[162:163], v241 offset:14080
    v_mfma_f32_32x32x16_bf16 v[144:159], v[164:167], v[48:51], v[144:159]
    ds_read_b64_tr_b16 v[164:165], v241 offset:45824
    ds_read_b64_tr_b16 v[166:167], v241 offset:46848
L_sums3:
    v_bitop3_b32 v230, v192, v193, v194 bitop3:0x80
    v_bitop3_b32 v230, v230, v195, v196 bitop3:0x80
    v_bitop3_b32 v230, v230, v197, v198 bitop3:0x80
    v_bitop3_b32 v230, v230, v199, 1 bitop3:0x80
    v_cmp_ne_u32 vcc, 1, v230
    s_nop 0
    s_cbranch_vccnz L_sumsre3
    s_waitcnt vmcnt(7) lgkmcnt(8)
    v_mfma_f32_32x32x16_bf16 v[128:143], v[168:171], v[52:55], v[128:143]
    buffer_load_dwordx4 v[84:87], v240, s[28:31], s58 offen offset:1024 sc1
    ds_read_b64_tr_b16 v[168:169], v241 offset:16384
    ds_read_b64_tr_b16 v[170:171], v241 offset:17408
    v_mfma_f32_32x32x16_bf16 v[144:159], v[172:175], v[52:55], v[144:159]
    v_add_f32 v192, v192, v194
    ds_read_b64_tr_b16 v[172:173], v241 offset:49152
    ds_read_b64_tr_b16 v[174:175], v241 offset:50176
    v_add_f32 v193, v193, v195
    s_waitcnt vmcnt(7) lgkmcnt(8)
    v_mfma_f32_32x32x16_bf16 v[128:143], v[176:179], v[56:59], v[128:143]
    buffer_load_dwordx4 v[88:91], v240, s[28:31], s58 offen offset:2048 sc1
    ds_read_b64_tr_b16 v[176:177], v241 offset:16640
    ds_read_b64_tr_b16 v[178:179], v241 offset:17664
    v_mfma_f32_32x32x16_bf16 v[144:159], v[180:183], v[56:59], v[144:159]
    v_add_f32_e64 v196, v196, v198
    ds_read_b64_tr_b16 v[180:181], v241 offset:49408
    ds_read_b64_tr_b16 v[182:183], v241 offset:50432
    v_add_f32 v197, v197, v199
    s_waitcnt vmcnt(7) lgkmcnt(8)
    v_mfma_f32_32x32x16_bf16 v[128:143], v[160:163], v[60:63], v[128:143]
    buffer_load_dwordx4 v[92:95], v240, s[28:31], s58 offen offset:3072 sc1
    ds_read_b64_tr_b16 v[160:161], v241 offset:16896
    ds_read_b64_tr_b16 v[162:163], v241 offset:17920
    v_mfma_f32_32x32x16_bf16 v[144:159], v[164:167], v[60:63], v[144:159]
    v_add_f32_e64 v192, v192, v196
    ds_read_b64_tr_b16 v[164:165], v241 offset:49664
    ds_read_b64_tr_b16 v[166:167], v241 offset:50688
    v_add_f32 v193, v193, v197
    s_waitcnt vmcnt(7) lgkmcnt(8)
    v_mfma_f32_32x32x16_bf16 v[128:143], v[168:171], v[64:67], v[128:143]
    s_xor_b32 s58, s39, 24576
    buffer_load_dwordx4 v[96:99], v240, s[28:31], s58 offen offset:0 sc1
    ds_read_b64_tr_b16 v[168:169], v241 offset:17152
    ds_read_b64_tr_b16 v[170:171], v241 offset:18176
    v_mfma_f32_32x32x16_bf16 v[144:159], v[172:175], v[64:67], v[144:159]
    v_add_f32_e64 v192, v192, v193
    ds_read_b64_tr_b16 v[172:173], v241 offset:49920
    ds_read_b64_tr_b16 v[174:175], v241 offset:50944
    v_mul_f32 v192, 0x3b000000, v192
    s_waitcnt vmcnt(7) lgkmcnt(8)
    v_mfma_f32_32x32x16_bf16 v[128:143], v[176:179], v[68:71], v[128:143]
    buffer_load_dwordx4 v[100:103], v240, s[28:31], s58 offen offset:1024 sc1
    ds_read_b64_tr_b16 v[176:177], v241 offset:20480
    ds_read_b64_tr_b16 v[178:179], v241 offset:21504
    v_mfma_f32_32x32x16_bf16 v[144:159], v[180:183], v[68:71], v[144:159]
    v_mov_b32 v193, v192
    ds_read_b64_tr_b16 v[180:181], v241 offset:53248
    ds_read_b64_tr_b16 v[182:183], v241 offset:54272
    v_permlane32_swap_b32 v192, v193
    s_waitcnt vmcnt(7) lgkmcnt(8)
    v_mfma_f32_32x32x16_bf16 v[128:143], v[160:163], v[72:75], v[128:143]
    buffer_load_dwordx4 v[104:107], v240, s[28:31], s58 offen offset:2048 sc1
    ds_read_b64_tr_b16 v[160:161], v241 offset:20736
    ds_read_b64_tr_b16 v[162:163], v241 offset:21760
    v_mfma_f32_32x32x16_bf16 v[144:159], v[164:167], v[72:75], v[144:159]
    v_fma_f32 v193, -v192, v192, v193
    ds_read_b64_tr_b16 v[164:165], v241 offset:53504
    ds_read_b64_tr_b16 v[166:167], v241 offset:54528
    v_max_f32 v193, 0, v193
    s_waitcnt vmcnt(7) lgkmcnt(8)
    v_mfma_f32_32x32x16_bf16 v[128:143], v[168:171], v[76:79], v[128:143]
    buffer_load_dwordx4 v[108:111], v240, s[28:31], s58 offen offset:3072 sc1
    ds_read_b64_tr_b16 v[168:169], v241 offset:20992
    ds_read_b64_tr_b16 v[170:171], v241 offset:22016
    v_mfma_f32_32x32x16_bf16 v[144:159], v[172:175], v[76:79], v[144:159]
    v_cvt_pk_bf16_f32 v246, -v192, -v192
    ds_read_b64_tr_b16 v[172:173], v241 offset:53760
    ds_read_b64_tr_b16 v[174:175], v241 offset:54784
    v_cvt_pk_bf16_f32 v193, v193, v193
    s_waitcnt vmcnt(7) lgkmcnt(8)
    v_mfma_f32_32x32x16_bf16 v[128:143], v[176:179], v[80:83], v[128:143]
    s_xor_b32 s58, s39, 28672
    buffer_load_dwordx4 v[112:115], v240, s[28:31], s58 offen offset:0 sc1
    ds_read_b64_tr_b16 v[176:177], v241 offset:21248
    ds_read_b64_tr_b16 v[178:179], v241 offset:22272
    v_mfma_f32_32x32x16_bf16 v[144:159], v[180:183], v[80:83], v[144:159]
    v_and_b32 v193, 0xffff0000, v193
    ds_read_b64_tr_b16 v[180:181], v241 offset:54016
    ds_read_b64_tr_b16 v[182:183], v241 offset:55040
    v_add_f32 v193, 0x3727c5ac, v193
    s_waitcnt vmcnt(7) lgkmcnt(8)
    v_mfma_f32_32x32x16_bf16 v[128:143], v[160:163], v[84:87], v[128:143]
    buffer_load_dwordx4 v[116:119], v240, s[28:31], s58 offen offset:1024 sc1
    ds_read_b64_tr_b16 v[160:161], v241 offset:24576
    ds_read_b64_tr_b16 v[162:163], v241 offset:25600
    v_mfma_f32_32x32x16_bf16 v[144:159], v[164:167], v[84:87], v[144:159]
    v_cvt_pk_bf16_f32 v193, v193, v193
    ds_read_b64_tr_b16 v[164:165], v241 offset:57344
    ds_read_b64_tr_b16 v[166:167], v241 offset:58368
    v_and_b32 v193, 0xffff0000, v193
    s_waitcnt vmcnt(7) lgkmcnt(8)
    v_mfma_f32_32x32x16_bf16 v[128:143], v[168:171], v[88:91], v[128:143]
    buffer_load_dwordx4 v[120:123], v240, s[28:31], s58 offen offset:2048 sc1
    ds_read_b64_tr_b16 v[168:169], v241 offset:24832
    ds_read_b64_tr_b16 v[170:171], v241 offset:25856
    v_mfma_f32_32x32x16_bf16 v[144:159], v[172:175], v[88:91], v[144:159]
    v_sqrt_f32 v193, v193
    ds_read_b64_tr_b16 v[172:173], v241 offset:57600
    ds_read_b64_tr_b16 v[174:175], v241 offset:58624
    v_cndmask_b32 v246, v246, 0, s[68:69]
    s_waitcnt vmcnt(7) lgkmcnt(8)
    v_mfma_f32_32x32x16_bf16 v[128:143], v[176:179], v[92:95], v[128:143]
    buffer_load_dwordx4 v[124:127], v240, s[28:31], s58 offen offset:3072 sc1
    ds_read_b64_tr_b16 v[176:177], v241 offset:25088
    ds_read_b64_tr_b16 v[178:179], v241 offset:26112
    v_mfma_f32_32x32x16_bf16 v[144:159], v[180:183], v[92:95], v[144:159]
    v_cvt_pk_bf16_f32 v193, v193, v193
    ds_read_b64_tr_b16 v[180:181], v241 offset:57856
    ds_read_b64_tr_b16 v[182:183], v241 offset:58880
    v_and_b32 v193, 0xffff0000, v193
    s_waitcnt vmcnt(7) lgkmcnt(8)
    v_mfma_f32_32x32x16_bf16 v[128:143], v[160:163], v[96:99], v[128:143]
    ds_read_b64_tr_b16 v[160:161], v241 offset:25344
    ds_read_b64_tr_b16 v[162:163], v241 offset:26368
    v_mfma_f32_32x32x16_bf16 v[144:159], v[164:167], v[96:99], v[144:159]
    v_rcp_f32_e64 v245, v193
    ds_read_b64_tr_b16 v[164:165], v241 offset:58112
    ds_read_b64_tr_b16 v[166:167], v241 offset:59136
    v_mov_b32 v226, v246
    s_waitcnt vmcnt(6) lgkmcnt(8)
    v_mfma_f32_32x32x16_bf16 v[128:143], v[168:171], v[100:103], v[128:143]
    ds_read_b64_tr_b16 v[168:169], v241 offset:28672
    ds_read_b64_tr_b16 v[170:171], v241 offset:29696
    v_mfma_f32_32x32x16_bf16 v[144:159], v[172:175], v[100:103], v[144:159]
    v_mul_f32 v244, 0x3fb8aa3b, v245
    ds_read_b64_tr_b16 v[172:173], v241 offset:61440
    ds_read_b64_tr_b16 v[174:175], v241 offset:62464
    v_mov_b32 v229, v246
    s_waitcnt vmcnt(5) lgkmcnt(8)
    v_mfma_f32_32x32x16_bf16 v[128:143], v[176:179], v[104:107], v[128:143]
    ds_read_b64_tr_b16 v[176:177], v241 offset:28928
    ds_read_b64_tr_b16 v[178:179], v241 offset:29952
    v_mfma_f32_32x32x16_bf16 v[144:159], v[180:183], v[104:107], v[144:159]
    ds_read_b64_tr_b16 v[180:181], v241 offset:61696
    ds_read_b64_tr_b16 v[182:183], v241 offset:62720
    s_waitcnt vmcnt(4) lgkmcnt(8)
    v_mfma_f32_32x32x8_bf16 v[128:143], v[224:225], v[226:227], v[128:143]
    v_mfma_f32_32x32x8_bf16 v[144:159], v[224:225], v[228:229], v[144:159]
    v_mfma_f32_32x32x16_bf16 v[128:143], v[160:163], v[108:111], v[128:143]
    ds_read_b64_tr_b16 v[160:161], v241 offset:29184
    ds_read_b64_tr_b16 v[162:163], v241 offset:30208
    v_mfma_f32_32x32x16_bf16 v[144:159], v[164:167], v[108:111], v[144:159]
    ds_read_b64_tr_b16 v[164:165], v241 offset:61952
    ds_read_b64_tr_b16 v[166:167], v241 offset:62976
    s_waitcnt vmcnt(3) lgkmcnt(8)
    v_mfma_f32_32x32x16_bf16 v[128:143], v[168:171], v[112:115], v[128:143]
    ds_read_b64_tr_b16 v[168:169], v241 offset:29440
    ds_read_b64_tr_b16 v[170:171], v241 offset:30464
    v_mfma_f32_32x32x16_bf16 v[144:159], v[172:175], v[112:115], v[144:159]
    ds_read_b64_tr_b16 v[172:173], v241 offset:62208
    ds_read_b64_tr_b16 v[174:175], v241 offset:63232
    s_waitcnt vmcnt(2) lgkmcnt(8)
    v_mfma_f32_32x32x16_bf16 v[128:143], v[176:179], v[116:119], v[128:143]
    ds_read_b128 v[232:235], v243 offset:2368
    v_mfma_f32_32x32x16_bf16 v[144:159], v[180:183], v[116:119], v[144:159]
    ds_read_b128 v[236:239], v243 offset:2960
    s_waitcnt vmcnt(1) lgkmcnt(6)
    v_mfma_f32_32x32x16_bf16 v[128:143], v[160:163], v[120:123], v[128:143]
    v_mfma_f32_32x32x16_bf16 v[144:159], v[164:167], v[120:123], v[144:159]
    s_waitcnt vmcnt(0) lgkmcnt(2)
    v_mfma_f32_32x32x16_bf16 v[128:143], v[168:171], v[124:127], v[128:143]
    s_nop 5
    v_mfma_f32_32x32x16_bf16 v[144:159], v[172:175], v[124:127], v[144:159]
    s_waitcnt lgkmcnt(0)
    s_nop 3
    v_cvt_pk_bf16_f32 v224, v128, v129
    v_cvt_pk_bf16_f32 v225, v130, v131
    v_cvt_pk_bf16_f32 v226, v132, v133
    v_cvt_pk_bf16_f32 v227, v134, v135
    v_cvt_pk_bf16_f32 v228, v136, v137
    v_cvt_pk_bf16_f32 v229, v138, v139
    v_mfma_f32_32x32x16_bf16 v[192:207], v[232:235], v[224:227], 0
    v_cvt_pk_bf16_f32 v230, v140, v141
    v_cvt_pk_bf16_f32 v231, v142, v143
    v_mul_f32 v144, v144, v245
    v_mul_f32 v145, v145, v245
    v_mul_f32 v146, v146, v245
    v_mul_f32 v147, v147, v245
    v_mfma_f32_32x32x16_bf16 v[192:207], v[236:239], v[228:231], v[192:207]
    v_mul_f32 v148, v148, v245
    v_mul_f32 v149, v149, v245
    v_mul_f32 v150, v150, v245
    v_mul_f32 v151, v151, v245
    v_cvt_pk_bf16_f32 v144, v144, v145
    v_cvt_pk_bf16_f32 v145, v146, v147
    v_cvt_pk_bf16_f32 v146, v148, v149
    v_cvt_pk_bf16_f32 v147, v150, v151
    ds_write_b128 v242, v[144:147] offset:16384
    v_mul_f32 v152, v152, v245
    v_mul_f32 v153, v153, v245
    v_mul_f32 v154, v154, v245
    v_mul_f32 v155, v155, v245
    v_mul_f32 v156, v156, v245
    v_mul_f32 v157, v157, v245
    v_mul_f32 v158, v158, v245
    v_mul_f32 v159, v159, v245
    v_cvt_pk_bf16_f32 v148, v152, v153
    v_cvt_pk_bf16_f32 v149, v154, v155
    v_cvt_pk_bf16_f32 v150, v156, v157
    v_cvt_pk_bf16_f32 v151, v158, v159
    ds_write_b128 v242, v[148:151] offset:16512
    v_max3_f32 v160, v192, v193, v194
    v_min3_f32 v161, v192, v193, v194
    v_max3_f32 v160, v160, v195, v196
    v_min3_f32 v161, v161, v195, v196
    v_max3_f32 v160, v160, v197, v198
    v_min3_f32 v161, v161, v197, v198
    v_max3_f32 v160, v160, v199, v200
    v_min3_f32 v161, v161, v199, v200
    v_max3_f32 v160, v160, v201, v202
    v_min3_f32 v161, v161, v201, v202
    v_max3_f32 v160, v160, v203, v204
    v_min3_f32 v161, v161, v203, v204
    v_max3_f32 v160, v160, v205, v206
    v_min3_f32 v161, v161, v205, v206
    v_max_f32 v160, v160, v207
    v_min_f32 v161, v161, v207
    v_pk_mul_f32 v[160:161], v[160:161], v[244:245] op_sel_hi:[1,0]
    v_pk_fma_f32 v[128:129], v[192:193], v[244:245], v[160:161] op_sel_hi:[1,0,0] neg_lo:[0,0,1] neg_hi:[0,0,1]
    v_pk_fma_f32 v[130:131], v[194:195], v[244:245], v[160:161] op_sel_hi:[1,0,0] neg_lo:[0,0,1] neg_hi:[0,0,1]
    v_pk_fma_f32 v[132:133], v[196:197], v[244:245], v[160:161] op_sel_hi:[1,0,0] neg_lo:[0,0,1] neg_hi:[0,0,1]
    v_pk_fma_f32 v[134:135], v[198:199], v[244:245], v[160:161] op_sel_hi:[1,0,0] neg_lo:[0,0,1] neg_hi:[0,0,1]
    v_pk_fma_f32 v[136:137], v[200:201], v[244:245], v[160:161] op_sel_hi:[1,0,0] neg_lo:[0,0,1] neg_hi:[0,0,1]
    v_pk_fma_f32 v[138:139], v[202:203], v[244:245], v[160:161] op_sel_hi:[1,0,0] neg_lo:[0,0,1] neg_hi:[0,0,1]
    v_pk_fma_f32 v[140:141], v[204:205], v[244:245], v[160:161] op_sel_hi:[1,0,0] neg_lo:[0,0,1] neg_hi:[0,0,1]
    v_pk_fma_f32 v[142:143], v[206:207], v[244:245], v[160:161] op_sel_hi:[1,0,0] neg_lo:[0,0,1] neg_hi:[0,0,1]
    v_exp_f32 v128, v128
    v_exp_f32 v129, v129
    v_exp_f32 v130, v130
    v_exp_f32 v131, v131
    v_exp_f32 v132, v132
    v_exp_f32 v133, v133
    v_exp_f32 v134, v134
    v_exp_f32 v135, v135
    v_exp_f32 v136, v136
    v_exp_f32 v137, v137
    v_exp_f32 v138, v138
    v_exp_f32 v139, v139
    v_exp_f32 v140, v140
    v_exp_f32 v141, v141
    v_exp_f32 v142, v142
    v_exp_f32 v143, v143
    v_pk_add_f32 v[162:163], v[128:129], v[130:131]
    v_pk_add_f32 v[162:163], v[162:163], v[132:133]
    v_pk_add_f32 v[162:163], v[162:163], v[134:135]
    v_pk_add_f32 v[162:163], v[162:163], v[136:137]
    v_pk_add_f32 v[162:163], v[162:163], v[138:139]
    v_pk_add_f32 v[162:163], v[162:163], v[140:141]
    v_pk_add_f32 v[162:163], v[162:163], v[142:143]
    v_add_f32 v162, v162, v163
    v_rcp_f32_e64 v162, v162
    s_nop 0
    v_pk_mul_f32 v[128:129], v[128:129], v[162:163] op_sel_hi:[1,0]
    v_pk_mul_f32 v[130:131], v[130:131], v[162:163] op_sel_hi:[1,0]
    v_pk_mul_f32 v[132:133], v[132:133], v[162:163] op_sel_hi:[1,0]
    v_pk_mul_f32 v[134:135], v[134:135], v[162:163] op_sel_hi:[1,0]
    v_cvt_pk_bf16_f32 v224, v128, v129
    v_cvt_pk_bf16_f32 v225, v130, v131
    v_cvt_pk_bf16_f32 v226, v132, v133
    v_cvt_pk_bf16_f32 v227, v134, v135
    ds_write_b128 v242, v[224:227] offset:0
    v_pk_mul_f32 v[136:137], v[136:137], v[162:163] op_sel_hi:[1,0]
    v_pk_mul_f32 v[138:139], v[138:139], v[162:163] op_sel_hi:[1,0]
    v_pk_mul_f32 v[140:141], v[140:141], v[162:163] op_sel_hi:[1,0]
    v_pk_mul_f32 v[142:143], v[142:143], v[162:163] op_sel_hi:[1,0]
    v_cvt_pk_bf16_f32 v228, v136, v137
    v_cvt_pk_bf16_f32 v229, v138, v139
    v_cvt_pk_bf16_f32 v230, v140, v141
    v_cvt_pk_bf16_f32 v231, v142, v143
    ds_write_b128 v242, v[228:231] offset:128
    v_pk_fma_f32 v[192:193], v[192:193], v[244:245], v[160:161] op_sel:[0,0,1] op_sel_hi:[1,0,1] neg_lo:[1,0,0] neg_hi:[1,0,0]
    v_pk_fma_f32 v[194:195], v[194:195], v[244:245], v[160:161] op_sel:[0,0,1] op_sel_hi:[1,0,1] neg_lo:[1,0,0] neg_hi:[1,0,0]
    v_pk_fma_f32 v[196:197], v[196:197], v[244:245], v[160:161] op_sel:[0,0,1] op_sel_hi:[1,0,1] neg_lo:[1,0,0] neg_hi:[1,0,0]
    v_pk_fma_f32 v[198:199], v[198:199], v[244:245], v[160:161] op_sel:[0,0,1] op_sel_hi:[1,0,1] neg_lo:[1,0,0] neg_hi:[1,0,0]
    v_pk_fma_f32 v[200:201], v[200:201], v[244:245], v[160:161] op_sel:[0,0,1] op_sel_hi:[1,0,1] neg_lo:[1,0,0] neg_hi:[1,0,0]
    v_pk_fma_f32 v[202:203], v[202:203], v[244:245], v[160:161] op_sel:[0,0,1] op_sel_hi:[1,0,1] neg_lo:[1,0,0] neg_hi:[1,0,0]
    v_pk_fma_f32 v[204:205], v[204:205], v[244:245], v[160:161] op_sel:[0,0,1] op_sel_hi:[1,0,1] neg_lo:[1,0,0] neg_hi:[1,0,0]
    v_pk_fma_f32 v[206:207], v[206:207], v[244:245], v[160:161] op_sel:[0,0,1] op_sel_hi:[1,0,1] neg_lo:[1,0,0] neg_hi:[1,0,0]
    v_exp_f32 v192, v192
    v_exp_f32 v193, v193
    v_exp_f32 v194, v194
    v_exp_f32 v195, v195
    v_exp_f32 v196, v196
    v_exp_f32 v197, v197
    v_exp_f32 v198, v198
    v_exp_f32 v199, v199
    v_exp_f32 v200, v200
    v_exp_f32 v201, v201
    v_exp_f32 v202, v202
    v_exp_f32 v203, v203
    v_exp_f32 v204, v204
    v_exp_f32 v205, v205
    v_exp_f32 v206, v206
    v_exp_f32 v207, v207
    v_pk_add_f32 v[164:165], v[192:193], v[194:195]
    v_pk_add_f32 v[164:165], v[164:165], v[196:197]
    v_pk_add_f32 v[164:165], v[164:165], v[198:199]
    v_pk_add_f32 v[164:165], v[164:165], v[200:201]
    v_pk_add_f32 v[164:165], v[164:165], v[202:203]
    v_pk_add_f32 v[164:165], v[164:165], v[204:205]
    v_pk_add_f32 v[164:165], v[164:165], v[206:207]
    v_add_f32 v164, v164, v165
    v_rcp_f32_e64 v164, v164
    s_nop 0
    v_pk_mul_f32 v[192:193], v[192:193], v[164:165] op_sel_hi:[1,0]
    v_pk_mul_f32 v[194:195], v[194:195], v[164:165] op_sel_hi:[1,0]
    v_pk_mul_f32 v[196:197], v[196:197], v[164:165] op_sel_hi:[1,0]
    v_pk_mul_f32 v[198:199], v[198:199], v[164:165] op_sel_hi:[1,0]
    v_cvt_pk_bf16_f32 v232, v192, v193
    v_cvt_pk_bf16_f32 v233, v194, v195
    v_cvt_pk_bf16_f32 v234, v196, v197
    v_cvt_pk_bf16_f32 v235, v198, v199
    ds_write_b128 v242, v[232:235] offset:8192
    v_pk_mul_f32 v[200:201], v[200:201], v[164:165] op_sel_hi:[1,0]
    v_pk_mul_f32 v[202:203], v[202:203], v[164:165] op_sel_hi:[1,0]
    v_pk_mul_f32 v[204:205], v[204:205], v[164:165] op_sel_hi:[1,0]
    v_pk_mul_f32 v[206:207], v[206:207], v[164:165] op_sel_hi:[1,0]
    v_cvt_pk_bf16_f32 v236, v200, v201
    v_cvt_pk_bf16_f32 v237, v202, v203
    v_cvt_pk_bf16_f32 v238, v204, v205
    v_cvt_pk_bf16_f32 v239, v206, v207
    ds_write_b128 v242, v[236:239] offset:8320
    v_mov_b32 v128, 0x3f803f80
    v_mov_b32 v129, 0x3f803f80
    v_mov_b32 v130, 0x3f803f80
    v_mov_b32 v131, 0x3f803f80
    s_waitcnt lgkmcnt(0)
    s_barrier
    ds_read_b64_tr_b16 v[192:193], v184 offset:0
    ds_read_b64_tr_b16 v[194:195], v184 offset:512
    ds_read_b64_tr_b16 v[224:225], v185 offset:0
    ds_read_b64_tr_b16 v[226:227], v185 offset:512
    ds_read_b64_tr_b16 v[196:197], v184 offset:1024
    ds_read_b64_tr_b16 v[198:199], v184 offset:1536
    ds_read_b64_tr_b16 v[228:229], v185 offset:1024
    ds_read_b64_tr_b16 v[230:231], v185 offset:1536
    s_waitcnt lgkmcnt(4)
    v_mfma_f32_16x16x32_bf16 v[152:155], v[192:195], v[224:227], 0
    ds_read_b64_tr_b16 v[200:201], v184 offset:2048
    ds_read_b64_tr_b16 v[202:203], v184 offset:2560
    v_mfma_f32_16x16x32_bf16 v[156:159], v[192:195], v[128:131], 0
    ds_read_b64_tr_b16 v[232:233], v185 offset:2048
    ds_read_b64_tr_b16 v[234:235], v185 offset:2560
    s_waitcnt lgkmcnt(4)
    v_mfma_f32_16x16x32_bf16 v[152:155], v[196:199], v[228:231], v[152:155]
    ds_read_b64_tr_b16 v[204:205], v184 offset:3072
    ds_read_b64_tr_b16 v[206:207], v184 offset:3584
    v_mfma_f32_16x16x32_bf16 v[156:159], v[196:199], v[128:131], v[156:159]
    ds_read_b64_tr_b16 v[236:237], v185 offset:3072
    ds_read_b64_tr_b16 v[238:239], v185 offset:3584
    s_waitcnt lgkmcnt(4)
    v_mfma_f32_16x16x32_bf16 v[152:155], v[200:203], v[232:235], v[152:155]
    v_mfma_f32_16x16x32_bf16 v[156:159], v[200:203], v[128:131], v[156:159]
    s_waitcnt lgkmcnt(0)
    v_mfma_f32_16x16x32_bf16 v[152:155], v[204:207], v[236:239], v[152:155]
    v_mfma_f32_16x16x32_bf16 v[156:159], v[204:207], v[128:131], v[156:159]
    s_nop 5
    s_nop 0
    v_cvt_pk_bf16_f32 v148, v152, v153
    v_cvt_pk_bf16_f32 v149, v154, v155
    v_cvt_pk_bf16_f32 v150, v152, v153
    v_cvt_pk_bf16_f32 v151, v154, v155
    v_min_u32 v156, -2, v156
    v_permlane16_swap_b32 v148, v150
    v_permlane16_swap_b32 v149, v151
    v_min_u32 v148, -2, v148
    s_mov_b64 exec, s[96:97]
    buffer_store_dwordx4 v[148:151], v186, s[24:27], s49 offen sc1
    s_mov_b64 exec, s[10:11]
    buffer_store_dwordx4 v[156:159], v187, s[24:27], s49 offen sc1
    s_mov_b64 exec, -1
    v_add_u32 v147, 0x18000, v241
    ds_read_b64_tr_b16 v[160:161], v147 offset:0
    ds_read_b64_tr_b16 v[162:163], v147 offset:1024
    ds_read_b64_tr_b16 v[164:165], v147 offset:256
    ds_read_b64_tr_b16 v[166:167], v147 offset:1280
    ds_read_b64_tr_b16 v[168:169], v147 offset:512
    ds_read_b64_tr_b16 v[170:171], v147 offset:1536
    ds_read_b64_tr_b16 v[172:173], v147 offset:768
    ds_read_b64_tr_b16 v[174:175], v147 offset:1792
    ds_read_b64_tr_b16 v[176:177], v147 offset:4096
    ds_read_b64_tr_b16 v[178:179], v147 offset:5120
    ds_read_b64_tr_b16 v[180:181], v147 offset:4352
    ds_read_b64_tr_b16 v[182:183], v147 offset:5376
    ds_read_b128 v[196:199], v254 offset:2560
    s_waitcnt lgkmcnt(11)
    v_mfma_f32_32x32x16_bf16 v[128:143], v[160:163], v[0:3], 0
    ds_read_b64_tr_b16 v[160:161], v147 offset:4608
    ds_read_b64_tr_b16 v[162:163], v147 offset:5632
    s_waitcnt lgkmcnt(11)
    v_mfma_f32_32x32x16_bf16 v[128:143], v[164:167], v[4:7], v[128:143]
    ds_read_b64_tr_b16 v[164:165], v147 offset:4864
    ds_read_b64_tr_b16 v[166:167], v147 offset:5888
    ds_write_b128 v252, a[192:195] offset:0
    s_waitcnt lgkmcnt(12)
    v_mfma_f32_32x32x16_bf16 v[128:143], v[168:171], v[8:11], v[128:143]
    ds_read_b64_tr_b16 v[168:169], v147 offset:8192
    ds_read_b64_tr_b16 v[170:171], v147 offset:9216
    s_waitcnt lgkmcnt(12)
    v_mfma_f32_32x32x16_bf16 v[128:143], v[172:175], v[12:15], v[128:143]
    ds_read_b64_tr_b16 v[172:173], v147 offset:8448
    ds_read_b64_tr_b16 v[174:175], v147 offset:9472
    s_waitcnt lgkmcnt(12)
    v_mfma_f32_32x32x16_bf16 v[128:143], v[176:179], v[16:19], v[128:143]
    ds_read_b64_tr_b16 v[176:177], v147 offset:8704
    ds_read_b64_tr_b16 v[178:179], v147 offset:9728
    ds_write_b128 v252, a[196:199] offset:1024
    s_waitcnt lgkmcnt(13)
    v_mfma_f32_32x32x16_bf16 v[128:143], v[180:183], v[20:23], v[128:143]
    ds_read_b64_tr_b16 v[180:181], v147 offset:8960
L_pad7:
    s_cbranch_execz L_back_38
    ds_read_b64_tr_b16 v[182:183], v147 offset:9984
    s_waitcnt lgkmcnt(12)
    v_mfma_f32_32x32x16_bf16 v[128:143], v[160:163], v[24:27], v[128:143]
    ds_read_b64_tr_b16 v[160:161], v147 offset:12288
    ds_read_b64_tr_b16 v[162:163], v147 offset:13312
    v_add_f32 v196, v196, v198
    v_add_f32 v197, v197, v199
    s_waitcnt lgkmcnt(12)
    v_mfma_f32_32x32x16_bf16 v[128:143], v[164:167], v[28:31], v[128:143]
    ds_read_b64_tr_b16 v[164:165], v147 offset:12544
    ds_read_b64_tr_b16 v[166:167], v147 offset:13568
    v_add_f32 v196, v196, v197
    v_cvt_pk_bf16_f32 v197, v196, v196
    s_waitcnt lgkmcnt(11)
    v_mfma_f32_32x32x16_bf16 v[128:143], v[168:171], v[32:35], v[128:143]
    ds_read_b64_tr_b16 v[168:169], v147 offset:12800
    ds_read_b64_tr_b16 v[170:171], v147 offset:13824
    ds_write_b128 v252, a[200:203] offset:2048
    v_and_b32 v197, 0xffff0000, v197
    v_sub_f32 v196, v196, v197
    s_waitcnt lgkmcnt(12)
    v_mfma_f32_32x32x16_bf16 v[128:143], v[172:175], v[36:39], v[128:143]
    ds_read_b64_tr_b16 v[172:173], v147 offset:13056
    ds_read_b64_tr_b16 v[174:175], v147 offset:14080
    v_cvt_pk_bf16_f32 v200, v197, v196
    v_mov_b32 v201, 0
    s_waitcnt lgkmcnt(12)
    v_mfma_f32_32x32x16_bf16 v[128:143], v[176:179], v[40:43], v[128:143]
    ds_read_b64_tr_b16 v[176:177], v147 offset:16384
    ds_read_b64_tr_b16 v[178:179], v147 offset:17408
    v_mov_b32 v202, v246
    v_mov_b32 v203, 0
    s_waitcnt lgkmcnt(11)
    v_mfma_f32_32x32x16_bf16 v[128:143], v[180:183], v[44:47], v[128:143]
    ds_read_b64_tr_b16 v[180:181], v147 offset:16640
    ds_read_b64_tr_b16 v[182:183], v147 offset:17664
    s_waitcnt lgkmcnt(11)
    v_mfma_f32_32x32x8_bf16 v[128:143], v[200:201], v[202:203], v[128:143]
    v_mfma_f32_32x32x16_bf16 v[128:143], v[160:163], v[48:51], v[128:143]
    ds_read_b64_tr_b16 v[160:161], v147 offset:16896
    ds_read_b64_tr_b16 v[162:163], v147 offset:17920
    ds_write_b128 v252, a[204:207] offset:3072
    s_waitcnt lgkmcnt(12)
    v_mfma_f32_32x32x16_bf16 v[128:143], v[164:167], v[52:55], v[128:143]
    ds_read_b64_tr_b16 v[164:165], v147 offset:17152
    ds_read_b64_tr_b16 v[166:167], v147 offset:18176
    s_waitcnt lgkmcnt(12)
    v_mfma_f32_32x32x16_bf16 v[128:143], v[168:171], v[56:59], v[128:143]
    ds_read_b64_tr_b16 v[168:169], v147 offset:20480
    ds_read_b64_tr_b16 v[170:171], v147 offset:21504
    s_waitcnt lgkmcnt(11)
    v_mfma_f32_32x32x16_bf16 v[128:143], v[172:175], v[60:63], v[128:143]
    ds_read_b64_tr_b16 v[172:173], v147 offset:20736
    ds_read_b64_tr_b16 v[174:175], v147 offset:21760
    s_waitcnt lgkmcnt(11)
    v_mfma_f32_32x32x16_bf16 v[128:143], v[176:179], v[64:67], v[128:143]
    ds_read_b64_tr_b16 v[176:177], v147 offset:20992
    ds_read_b64_tr_b16 v[178:179], v147 offset:22016
    ds_write_b128 v252, a[208:211] offset:4096
    s_waitcnt lgkmcnt(12)
    v_mfma_f32_32x32x16_bf16 v[128:143], v[180:183], v[68:71], v[128:143]
    ds_read_b64_tr_b16 v[180:181], v147 offset:21248
    ds_read_b64_tr_b16 v[182:183], v147 offset:22272
    s_waitcnt lgkmcnt(12)
    v_mfma_f32_32x32x16_bf16 v[128:143], v[160:163], v[72:75], v[128:143]
    ds_read_b64_tr_b16 v[160:161], v147 offset:24576
    ds_read_b64_tr_b16 v[162:163], v147 offset:25600
    s_waitcnt lgkmcnt(11)
    v_mfma_f32_32x32x16_bf16 v[128:143], v[164:167], v[76:79], v[128:143]
    ds_read_b64_tr_b16 v[164:165], v147 offset:24832
    ds_read_b64_tr_b16 v[166:167], v147 offset:25856
    ds_write_b128 v252, a[212:215] offset:5120
    s_waitcnt lgkmcnt(12)
    v_mfma_f32_32x32x16_bf16 v[128:143], v[168:171], v[80:83], v[128:143]
    s_add_u32 s56, s49, 524288
    buffer_load_dwordx4 v[32:35], v240, s[24:27], s56 offen sc1
    ds_read_b64_tr_b16 v[168:169], v147 offset:25088
    ds_read_b64_tr_b16 v[170:171], v147 offset:26112
    s_waitcnt lgkmcnt(12)
    v_mfma_f32_32x32x16_bf16 v[128:143], v[172:175], v[84:87], v[128:143]
    ds_read_b64_tr_b16 v[172:173], v147 offset:25344
    ds_read_b64_tr_b16 v[174:175], v147 offset:26368
    s_waitcnt lgkmcnt(12)
    v_mfma_f32_32x32x16_bf16 v[128:143], v[176:179], v[88:91], v[128:143]
    s_add_u32 s56, s49, 0
    buffer_load_dwordx4 v[0:3], v240, s[24:27], s56 offen sc1
    ds_read_b64_tr_b16 v[176:177], v147 offset:28672
    ds_read_b64_tr_b16 v[178:179], v147 offset:29696
    s_waitcnt lgkmcnt(11)
    v_mfma_f32_32x32x16_bf16 v[128:143], v[180:183], v[92:95], v[128:143]
    ds_read_b64_tr_b16 v[180:181], v147 offset:28928
    ds_read_b64_tr_b16 v[182:183], v147 offset:29952
    ds_write_b128 v252, a[216:219] offset:6144
    s_waitcnt lgkmcnt(12)
    v_mfma_f32_32x32x16_bf16 v[128:143], v[160:163], v[96:99], v[128:143]
    s_add_u32 s56, s49, 65536
    buffer_load_dwordx4 v[4:7], v240, s[24:27], s56 offen sc1
    ds_read_b64_tr_b16 v[160:161], v147 offset:29184
    ds_read_b64_tr_b16 v[162:163], v147 offset:30208
    s_waitcnt lgkmcnt(12)
    v_mfma_f32_32x32x16_bf16 v[128:143], v[164:167], v[100:103], v[128:143]
    ds_read_b64_tr_b16 v[164:165], v147 offset:29440
    ds_read_b64_tr_b16 v[166:167], v147 offset:30464
    s_waitcnt lgkmcnt(11)
    v_mfma_f32_32x32x16_bf16 v[128:143], v[168:171], v[104:107], v[128:143]
    s_add_u32 s56, s49, 131072
    buffer_load_dwordx4 v[8:11], v240, s[24:27], s56 offen sc1
    s_waitcnt lgkmcnt(9)
    v_mfma_f32_32x32x16_bf16 v[128:143], v[172:175], v[108:111], v[128:143]
    ds_write_b128 v252, a[220:223] offset:7168
    v_and_b32 v36, 0x1f0, v240
    v_add_u32 v36, 0x27a60, v36
    ds_read_b128 v[36:39], v36
    s_waitcnt lgkmcnt(9)
    v_mfma_f32_32x32x16_bf16 v[128:143], v[176:179], v[112:115], v[128:143]
    s_add_u32 s56, s49, 196608
    buffer_load_dwordx4 v[12:15], v240, s[24:27], s56 offen sc1
    ds_read_b128 v[232:235], v243 offset:2368
    s_waitcnt lgkmcnt(8)
    v_mfma_f32_32x32x16_bf16 v[128:143], v[180:183], v[116:119], v[128:143]
    ds_read_b128 v[236:239], v243 offset:2960
    s_waitcnt lgkmcnt(6)
    v_mfma_f32_32x32x16_bf16 v[128:143], v[160:163], v[120:123], v[128:143]
    s_add_u32 s56, s49, 262144
    buffer_load_dwordx4 v[16:19], v240, s[24:27], s56 offen sc1
    s_waitcnt lgkmcnt(4)
    v_mfma_f32_32x32x16_bf16 v[128:143], v[164:167], v[124:127], v[128:143]
    s_waitcnt lgkmcnt(0)
    s_nop 10
    v_cvt_pk_bf16_f32 v224, v128, v129
    v_cvt_pk_bf16_f32 v225, v130, v131
    v_cvt_pk_bf16_f32 v226, v132, v133
    v_cvt_pk_bf16_f32 v227, v134, v135
    v_cvt_pk_bf16_f32 v228, v136, v137
    v_cvt_pk_bf16_f32 v229, v138, v139
    v_mfma_f32_32x32x16_bf16 v[192:207], v[232:235], v[224:227], 0
    v_cvt_pk_bf16_f32 v230, v140, v141
    v_cvt_pk_bf16_f32 v231, v142, v143
    s_nop 1
    v_mfma_f32_32x32x16_bf16 v[192:207], v[236:239], v[228:231], v[192:207]
    s_add_u32 s56, s49, 327680
    buffer_load_dwordx4 v[20:23], v240, s[24:27], s56 offen sc1
    s_nop 9
    v_max3_f32 v160, v192, v193, v194
    v_min3_f32 v161, v192, v193, v194
    v_max3_f32 v160, v160, v195, v196
    v_min3_f32 v161, v161, v195, v196
    v_max3_f32 v160, v160, v197, v198
    v_min3_f32 v161, v161, v197, v198
    v_max3_f32 v160, v160, v199, v200
    v_min3_f32 v161, v161, v199, v200
    v_max3_f32 v160, v160, v201, v202
    v_min3_f32 v161, v161, v201, v202
    v_max3_f32 v160, v160, v203, v204
    v_min3_f32 v161, v161, v203, v204
    s_add_u32 s56, s49, 393216
    buffer_load_dwordx4 v[24:27], v240, s[24:27], s56 offen sc1
    v_max3_f32 v160, v160, v205, v206
    v_min3_f32 v161, v161, v205, v206
    v_max_f32 v160, v160, v207
    v_min_f32 v161, v161, v207
    v_pk_mul_f32 v[160:161], v[160:161], v[244:245] op_sel_hi:[1,0]
    v_pk_fma_f32 v[128:129], v[192:193], v[244:245], v[160:161] op_sel_hi:[1,0,0] neg_lo:[0,0,1] neg_hi:[0,0,1]
    v_pk_fma_f32 v[130:131], v[194:195], v[244:245], v[160:161] op_sel_hi:[1,0,0] neg_lo:[0,0,1] neg_hi:[0,0,1]
    v_pk_fma_f32 v[132:133], v[196:197], v[244:245], v[160:161] op_sel_hi:[1,0,0] neg_lo:[0,0,1] neg_hi:[0,0,1]
    v_pk_fma_f32 v[134:135], v[198:199], v[244:245], v[160:161] op_sel_hi:[1,0,0] neg_lo:[0,0,1] neg_hi:[0,0,1]
    v_pk_fma_f32 v[136:137], v[200:201], v[244:245], v[160:161] op_sel_hi:[1,0,0] neg_lo:[0,0,1] neg_hi:[0,0,1]
    v_pk_fma_f32 v[138:139], v[202:203], v[244:245], v[160:161] op_sel_hi:[1,0,0] neg_lo:[0,0,1] neg_hi:[0,0,1]
    v_pk_fma_f32 v[140:141], v[204:205], v[244:245], v[160:161] op_sel_hi:[1,0,0] neg_lo:[0,0,1] neg_hi:[0,0,1]
    s_add_u32 s56, s49, 458752
    buffer_load_dwordx4 v[28:31], v240, s[24:27], s56 offen sc1
    v_pk_fma_f32 v[142:143], v[206:207], v[244:245], v[160:161] op_sel_hi:[1,0,0] neg_lo:[0,0,1] neg_hi:[0,0,1]
    v_exp_f32 v128, v128
    v_exp_f32 v129, v129
    v_exp_f32 v130, v130
    v_exp_f32 v131, v131
    v_exp_f32 v132, v132
    v_exp_f32 v133, v133
    v_exp_f32 v134, v134
    v_exp_f32 v135, v135
    v_exp_f32 v136, v136
    v_exp_f32 v137, v137
    v_exp_f32 v138, v138
    v_exp_f32 v139, v139
    v_exp_f32 v140, v140
    v_exp_f32 v141, v141
    v_exp_f32 v142, v142
    v_exp_f32 v143, v143
    v_pk_add_f32 v[162:163], v[128:129], v[130:131]
    v_pk_add_f32 v[162:163], v[162:163], v[132:133]
    v_pk_add_f32 v[162:163], v[162:163], v[134:135]
    v_pk_add_f32 v[162:163], v[162:163], v[136:137]
    v_pk_add_f32 v[162:163], v[162:163], v[138:139]
    v_pk_add_f32 v[162:163], v[162:163], v[140:141]
    v_pk_add_f32 v[162:163], v[162:163], v[142:143]
    v_add_f32_e64 v162, v162, v163
    v_cvt_pk_bf16_f32 v224, v128, v129
    v_cvt_pk_bf16_f32 v225, v130, v131
    v_cvt_pk_bf16_f32 v226, v132, v133
    v_cvt_pk_bf16_f32 v227, v134, v135
    v_cvt_pk_bf16_f32 v228, v136, v137
    v_cvt_pk_bf16_f32 v229, v138, v139
    v_cvt_pk_bf16_f32 v230, v140, v141
    v_cvt_pk_bf16_f32 v231, v142, v143
    v_pk_fma_f32 v[192:193], v[192:193], v[244:245], v[160:161] op_sel:[0,0,1] op_sel_hi:[1,0,1] neg_lo:[1,0,0] neg_hi:[1,0,0]
    v_pk_fma_f32 v[194:195], v[194:195], v[244:245], v[160:161] op_sel:[0,0,1] op_sel_hi:[1,0,1] neg_lo:[1,0,0] neg_hi:[1,0,0]
    v_pk_fma_f32 v[196:197], v[196:197], v[244:245], v[160:161] op_sel:[0,0,1] op_sel_hi:[1,0,1] neg_lo:[1,0,0] neg_hi:[1,0,0]
    v_pk_fma_f32 v[198:199], v[198:199], v[244:245], v[160:161] op_sel:[0,0,1] op_sel_hi:[1,0,1] neg_lo:[1,0,0] neg_hi:[1,0,0]
    v_pk_fma_f32 v[200:201], v[200:201], v[244:245], v[160:161] op_sel:[0,0,1] op_sel_hi:[1,0,1] neg_lo:[1,0,0] neg_hi:[1,0,0]
    v_pk_fma_f32 v[202:203], v[202:203], v[244:245], v[160:161] op_sel:[0,0,1] op_sel_hi:[1,0,1] neg_lo:[1,0,0] neg_hi:[1,0,0]
    v_pk_fma_f32 v[204:205], v[204:205], v[244:245], v[160:161] op_sel:[0,0,1] op_sel_hi:[1,0,1] neg_lo:[1,0,0] neg_hi:[1,0,0]
    v_pk_fma_f32 v[206:207], v[206:207], v[244:245], v[160:161] op_sel:[0,0,1] op_sel_hi:[1,0,1] neg_lo:[1,0,0] neg_hi:[1,0,0]
    v_exp_f32 v192, v192
    v_exp_f32 v193, v193
    v_exp_f32 v194, v194
    v_exp_f32 v195, v195
    v_exp_f32 v196, v196
    v_exp_f32 v197, v197
    v_exp_f32 v198, v198
    v_exp_f32 v199, v199
    v_exp_f32 v200, v200
    v_exp_f32 v201, v201
    v_exp_f32 v202, v202
    v_exp_f32 v203, v203
    v_exp_f32 v204, v204
    v_exp_f32 v205, v205
    v_exp_f32 v206, v206
    v_exp_f32 v207, v207
    v_pk_add_f32 v[164:165], v[192:193], v[194:195]
    v_pk_add_f32 v[164:165], v[164:165], v[196:197]
    v_pk_add_f32 v[164:165], v[164:165], v[198:199]
    v_pk_add_f32 v[164:165], v[164:165], v[200:201]
    v_pk_add_f32 v[164:165], v[164:165], v[202:203]
    v_pk_add_f32 v[164:165], v[164:165], v[204:205]
    v_pk_add_f32 v[164:165], v[164:165], v[206:207]
    v_add_f32 v164, v164, v165
    v_rcp_f32 v164, v164
    v_mul_f32 v166, 0x358637bd, v162
    v_mul_f32_e64 v164, v164, v162
    v_pk_mul_f32 v[192:193], v[192:193], v[164:165] op_sel_hi:[1,0]
    v_pk_mul_f32 v[194:195], v[194:195], v[164:165] op_sel_hi:[1,0]
    v_pk_mul_f32 v[196:197], v[196:197], v[164:165] op_sel_hi:[1,0]
    v_pk_mul_f32 v[198:199], v[198:199], v[164:165] op_sel_hi:[1,0]
    v_cvt_pk_bf16_f32 v232, v192, v193
    v_cvt_pk_bf16_f32 v233, v194, v195
    v_cvt_pk_bf16_f32 v234, v196, v197
    v_cvt_pk_bf16_f32 v235, v198, v199
    v_pk_mul_f32 v[200:201], v[200:201], v[164:165] op_sel_hi:[1,0]
    v_pk_mul_f32 v[202:203], v[202:203], v[164:165] op_sel_hi:[1,0]
    v_pk_mul_f32 v[204:205], v[204:205], v[164:165] op_sel_hi:[1,0]
    v_pk_mul_f32 v[206:207], v[206:207], v[164:165] op_sel_hi:[1,0]
    v_cvt_pk_bf16_f32 v236, v200, v201
    v_cvt_pk_bf16_f32 v237, v202, v203
    v_cvt_pk_bf16_f32 v238, v204, v205
    v_cvt_pk_bf16_f32 v239, v206, v207
    v_xor_b32 v176, 32, v251
    v_xor_b32 v177, 64, v251
    v_xor_b32 v178, 96, v251
    s_add_u32 s1, s50, 64
    v_mov_b32_e64 v179, s1
L_chk3:
    s_waitcnt vmcnt(6)
    v_mfma_f32_16x16x32_bf16 v[40:43], v[36:39], v[0:3], 0
    v_max3_u32 v44, v32, v0, v4
    v_permlane16_swap_b32 v32, v33
    v_mfma_f32_16x16x32_bf16 v[40:43], v[36:39], v[4:7], v[40:43]
    v_permlane16_swap_b32 v34, v35
    s_waitcnt vmcnt(4)
    v_mfma_f32_16x16x32_bf16 v[40:43], v[36:39], v[8:11], v[40:43]
    v_add_f32 v32, v32, v33
    v_add_f32_e64 v34, v34, v35
    v_mfma_f32_16x16x32_bf16 v[40:43], v[36:39], v[12:15], v[40:43]
    v_max3_u32 v44, v44, v8, v12
    v_permlane32_swap_b32 v32, v34
    s_waitcnt vmcnt(2)
    v_mfma_f32_16x16x32_bf16 v[40:43], v[36:39], v[16:19], v[40:43]
    v_add_f32_e64 v32, v32, v34
    v_max3_u32 v44, v44, v16, v20
    v_mfma_f32_16x16x32_bf16 v[40:43], v[36:39], v[20:23], v[40:43]
    v_add_f32 v32, v32, v32 row_ror:4
    s_waitcnt vmcnt(0)
    v_mfma_f32_16x16x32_bf16 v[40:43], v[36:39], v[24:27], v[40:43]
    v_add_f32 v32, v32, v32 row_ror:8
    v_max3_u32 v44, v44, v24, v28
    v_mfma_f32_16x16x32_bf16 v[40:43], v[36:39], v[28:31], v[40:43]
    v_cmp_eq_u32 vcc, -1, v44
    v_cvt_pk_bf16_f32 v32, v32, v32
    ds_write_b16 v189, v32
    s_cbranch_vccnz L_again3
    s_nop 3
    v_cvt_pk_bf16_f32 v40, v40, v41
    v_cvt_pk_bf16_f32 v41, v42, v43
    ds_write_b64 v188, v[40:41]
    s_waitcnt lgkmcnt(0)
    s_barrier
    ds_read_b128 v[0:3], v243 offset:0
    ds_read_b128 v[4:7], v243 offset:592
    ds_read_b128 v[8:11], v243 offset:1184
    s_waitcnt lgkmcnt(2)
    v_mfma_f32_32x32x16_bf16 v[144:159], v[0:3], v[224:227], 0
    ds_read_b128 v[12:15], v243 offset:1776
    ds_read_b128 v[16:19], v190 offset:0
    s_waitcnt lgkmcnt(3)
    v_mfma_f32_32x32x16_bf16 v[144:159], v[4:7], v[228:231], v[144:159]
    ds_read_b128 v[20:23], v190 offset:16
    ds_read_b128 v[24:27], v190 offset:64
    s_waitcnt lgkmcnt(4)
    v_mfma_f32_32x32x16_bf16 v[144:159], v[8:11], v[232:235], v[144:159]
    ds_read_b128 v[28:31], v190 offset:80
    s_waitcnt lgkmcnt(4)
    v_mfma_f32_32x32x16_bf16 v[144:159], v[12:15], v[236:239], v[144:159]
    s_waitcnt lgkmcnt(0)
    v_dot2c_f32_bf16 v166, v16, v224
    v_dot2c_f32_bf16 v166, v17, v225
    v_dot2c_f32_bf16 v166, v18, v226
    v_dot2c_f32_bf16 v166, v19, v227
    v_dot2c_f32_bf16 v166, v20, v228
    v_dot2c_f32_bf16 v166, v21, v229
    v_dot2c_f32_bf16 v166, v22, v230
    v_dot2c_f32_bf16 v166, v23, v231
    v_dot2c_f32_bf16 v166, v24, v232
    v_dot2c_f32_bf16 v166, v25, v233
    v_dot2c_f32_bf16 v166, v26, v234
    v_dot2c_f32_bf16 v166, v27, v235
    v_dot2c_f32_bf16 v166, v28, v236
    v_dot2c_f32_bf16 v166, v29, v237
    v_dot2c_f32_bf16 v166, v30, v238
    v_dot2c_f32_bf16 v166, v31, v239
    s_nop 2
    v_rcp_f32_e64 v166, v166
    s_cmp_eq_u32 s51, 0
    s_cbranch_scc0 L_glob_54
    v_pk_mul_f32 v[144:145], v[144:145], v[166:167] op_sel_hi:[1,0]
    v_pk_mul_f32 v[146:147], v[146:147], v[166:167] op_sel_hi:[1,0]
    v_pk_mul_f32 v[148:149], v[148:149], v[166:167] op_sel_hi:[1,0]
    v_pk_mul_f32 v[150:151], v[150:151], v[166:167] op_sel_hi:[1,0]
    v_cvt_pk_bf16_f32 v192, v144, v145
    v_cvt_pk_bf16_f32 v193, v146, v147
    v_cvt_pk_bf16_f32 v194, v148, v149
    v_cvt_pk_bf16_f32 v195, v150, v151
    buffer_store_dwordx4 v[192:195], v191, s[24:27], s42 offen offset:0
    v_pk_mul_f32 v[152:153], v[152:153], v[166:167] op_sel_hi:[1,0]
    v_pk_mul_f32 v[154:155], v[154:155], v[166:167] op_sel_hi:[1,0]
    v_pk_mul_f32 v[156:157], v[156:157], v[166:167] op_sel_hi:[1,0]
    v_pk_mul_f32 v[158:159], v[158:159], v[166:167] op_sel_hi:[1,0]
    v_cvt_pk_bf16_f32 v196, v152, v153
    v_cvt_pk_bf16_f32 v197, v154, v155
    v_cvt_pk_bf16_f32 v198, v156, v157
    v_cvt_pk_bf16_f32 v199, v158, v159
    buffer_store_dwordx4 v[196:199], v191, s[24:27], s42 offen offset:256
L_join_55:
    ds_write_b128 v252, a[224:227] offset:8192
    ds_write_b128 v252, a[228:231] offset:9216
    ds_write_b128 v252, a[232:235] offset:10240
    ds_write_b128 v252, a[236:239] offset:11264
    ds_write_b128 v252, a[240:243] offset:12288
    ds_write_b128 v252, a[244:247] offset:13312
    s_mov_b64 exec, 1
    s_cmp_eq_u32 s51, 0
    s_cbranch_scc0 L_glob_56
    s_waitcnt vmcnt(0)
    buffer_store_dword v179, off, s[24:27], s43
L_join_57:
    s_mov_b64 exec, -1
    s_branch L_overo3
L_moreo3:
    buffer_load_dword v234, v250, s[24:27], s45 offen offset:0 sc1
    s_sub_u32 s59, s59, 1
    s_cbranch_scc1 L_timeout
    s_waitcnt vmcnt(1)
    v_cmp_ne_u32_e64 vcc, s1, v235
    s_nop 0
    s_cbranch_vccz L_goo3
    s_branch L_spino3
L_overo3:
    s_mul_i32 s55, s36, 2304
    s_add_u32 s55, s55, 131072
    v_bfe_u32 v227, v240, 4, 4
    v_mul_u32_u24 v224, 144, v227
    v_lshrrev_b32 v227, 8, v240
    v_lshl_add_u32 v224, v227, 3, v224
    v_add_u32 v224, s55, v224
    v_lshrrev_b32 v227, 7, v240
    v_lshl_add_u32 v225, v227, 4, v240
    v_add_u32 v225, s55, v225
    v_mul_u32_u24 v226, 896, v227
    v_add_u32_e64 v226, v226, v240
    ds_write_b128 v252, a[248:251] offset:14336
    ds_write_b128 v252, a[252:255] offset:15360
    ds_read_b64_tr_b16 v[64:65], v251 offset:0
    ds_read_b64_tr_b16 v[66:67], v251 offset:512
    ds_read_b64_tr_b16 v[68:69], v176 offset:16384
    ds_read_b64_tr_b16 v[70:71], v176 offset:16896
    ds_read_b64_tr_b16 v[72:73], v177 offset:32768
    ds_read_b64_tr_b16 v[74:75], v177 offset:33280
    ds_read_b64_tr_b16 v[76:77], v178 offset:49152
    ds_read_b64_tr_b16 v[78:79], v178 offset:49664
    s_mov_b64 exec, 0xffff
    buffer_load_dword v234, v250, s[24:27], s45 offen offset:0 sc1
    s_mov_b64 exec, -1
    ds_read_b64_tr_b16 v[80:81], v251 offset:1024
    ds_read_b64_tr_b16 v[82:83], v251 offset:1536
    ds_read_b64_tr_b16 v[84:85], v176 offset:17408
    ds_read_b64_tr_b16 v[86:87], v176 offset:17920
    ds_read_b64_tr_b16 v[88:89], v177 offset:33792
    ds_read_b64_tr_b16 v[90:91], v177 offset:34304
    ds_read_b64_tr_b16 v[92:93], v178 offset:50176
    ds_read_b64_tr_b16 v[94:95], v178 offset:50688
    ds_read_b64_tr_b16 v[96:97], v251 offset:2048
    ds_read_b64_tr_b16 v[98:99], v251 offset:2560
    ds_read_b64_tr_b16 v[100:101], v176 offset:18432
    ds_read_b64_tr_b16 v[102:103], v176 offset:18944
    ds_read_b64_tr_b16 v[104:105], v177 offset:34816
    ds_read_b64_tr_b16 v[106:107], v177 offset:35328
    ds_read_b64_tr_b16 v[108:109], v178 offset:51200
    ds_read_b64_tr_b16 v[110:111], v178 offset:51712
    ds_read_b64_tr_b16 v[112:113], v251 offset:3072
    ds_read_b64_tr_b16 v[114:115], v251 offset:3584
    ds_read_b64_tr_b16 v[116:117], v176 offset:19456
    ds_read_b64_tr_b16 v[118:119], v176 offset:19968
    s_mov_b64 exec, 0xffff
L_spino3:
    buffer_load_dword v235, v250, s[24:27], s45 offen offset:0 sc1
    s_waitcnt vmcnt(1)
    v_cmp_ne_u32 vcc, s1, v234
    s_nop 0
    s_cbranch_vccnz L_moreo3
L_goo3:
    s_mov_b64 exec, -1
    buffer_load_dwordx4 v[0:3], v240, s[24:27], s44 offen offset:0 sc1
    buffer_load_dwordx4 v[4:7], v240, s[24:27], s44 offen offset:1024 sc1
    buffer_load_dwordx4 v[8:11], v240, s[24:27], s44 offen offset:2048 sc1
    buffer_load_dwordx4 v[12:15], v240, s[24:27], s44 offen offset:3072 sc1
    s_waitcnt lgkmcnt(15)
    s_barrier
    ds_read_b64_tr_b16 v[120:121], v177 offset:35840
    ds_read_b64_tr_b16 v[122:123], v177 offset:36352
    ds_read_b64_tr_b16 v[124:125], v178 offset:52224
    ds_read_b64_tr_b16 v[126:127], v178 offset:52736
    ds_read_b64_tr_b16 v[128:129], v251 offset:4096
    ds_read_b64_tr_b16 v[130:131], v251 offset:4608
    ds_read_b64_tr_b16 v[132:133], v176 offset:20480
    s_xor_b32 s58, s44, 4096
    buffer_load_dwordx4 v[16:19], v240, s[24:27], s58 offen offset:0 sc1
    ds_read_b64_tr_b16 v[134:135], v176 offset:20992
    ds_read_b64_tr_b16 v[136:137], v177 offset:36864
    ds_read_b64_tr_b16 v[138:139], v177 offset:37376
    ds_read_b64_tr_b16 v[140:141], v178 offset:53248
    ds_read_b64_tr_b16 v[142:143], v178 offset:53760
    ds_read_b64_tr_b16 v[144:145], v251 offset:5120
    ds_read_b64_tr_b16 v[146:147], v251 offset:5632
    buffer_load_dwordx4 v[20:23], v240, s[24:27], s58 offen offset:1024 sc1
    ds_read_b64_tr_b16 v[148:149], v176 offset:21504
    ds_read_b64_tr_b16 v[150:151], v176 offset:22016
    ds_read_b64_tr_b16 v[152:153], v177 offset:37888
    ds_read_b64_tr_b16 v[154:155], v177 offset:38400
    ds_read_b64_tr_b16 v[156:157], v178 offset:54272
    ds_read_b64_tr_b16 v[158:159], v178 offset:54784
    ds_read_b64_tr_b16 v[160:161], v251 offset:6144
    buffer_load_dwordx4 v[24:27], v240, s[24:27], s58 offen offset:2048 sc1
    ds_read_b64_tr_b16 v[162:163], v251 offset:6656
    ds_read_b64_tr_b16 v[164:165], v176 offset:22528
    ds_read_b64_tr_b16 v[166:167], v176 offset:23040
    ds_read_b64_tr_b16 v[168:169], v177 offset:38912
    ds_read_b64_tr_b16 v[170:171], v177 offset:39424
    ds_read_b64_tr_b16 v[172:173], v178 offset:55296
    ds_read_b64_tr_b16 v[174:175], v178 offset:55808
    buffer_load_dwordx4 v[28:31], v240, s[24:27], s58 offen offset:3072 sc1
    s_waitcnt vmcnt(7)
    v_mfma_f32_16x16x32_bf16 v[208:211], v[64:67], v[0:3], v[208:211]
    s_xor_b32 s58, s44, 8192
    buffer_load_dwordx4 v[32:35], v240, s[24:27], s58 offen offset:0 sc1
    v_mfma_f32_16x16x32_bf16 v[212:215], v[68:71], v[0:3], v[212:215]
    ds_read_b64_tr_b16 v[64:65], v251 offset:7168
    ds_read_b64_tr_b16 v[66:67], v251 offset:7680
    v_mfma_f32_16x16x32_bf16 v[216:219], v[72:75], v[0:3], v[216:219]
    ds_read_b64_tr_b16 v[68:69], v176 offset:23552
    v_mfma_f32_16x16x32_bf16 v[220:223], v[76:79], v[0:3], v[220:223]
    ds_read_b64_tr_b16 v[70:71], v176 offset:24064
    s_waitcnt vmcnt(7) lgkmcnt(15)
    v_mfma_f32_16x16x32_bf16 v[208:211], v[80:83], v[4:7], v[208:211]
    buffer_load_dwordx4 v[36:39], v240, s[24:27], s58 offen offset:1024 sc1
    v_mfma_f32_16x16x32_bf16 v[212:215], v[84:87], v[4:7], v[212:215]
    ds_read_b64_tr_b16 v[72:73], v177 offset:39936
    ds_read_b64_tr_b16 v[74:75], v177 offset:40448
    v_mfma_f32_16x16x32_bf16 v[216:219], v[88:91], v[4:7], v[216:219]
    ds_read_b64_tr_b16 v[76:77], v178 offset:56320
    v_mfma_f32_16x16x32_bf16 v[220:223], v[92:95], v[4:7], v[220:223]
    ds_read_b64_tr_b16 v[78:79], v178 offset:56832
    s_waitcnt vmcnt(7)
    v_mfma_f32_16x16x32_bf16 v[208:211], v[96:99], v[8:11], v[208:211]
    buffer_load_dwordx4 v[40:43], v240, s[24:27], s58 offen offset:2048 sc1
    v_mfma_f32_16x16x32_bf16 v[212:215], v[100:103], v[8:11], v[212:215]
    ds_read_b64_tr_b16 v[80:81], v251 offset:8192
    ds_read_b64_tr_b16 v[82:83], v251 offset:8704
    v_mfma_f32_16x16x32_bf16 v[216:219], v[104:107], v[8:11], v[216:219]
    ds_read_b64_tr_b16 v[84:85], v176 offset:24576
    v_mfma_f32_16x16x32_bf16 v[220:223], v[108:111], v[8:11], v[220:223]
    ds_read_b64_tr_b16 v[86:87], v176 offset:25088
    s_waitcnt vmcnt(7)
    v_mfma_f32_16x16x32_bf16 v[208:211], v[112:115], v[12:15], v[208:211]
    buffer_load_dwordx4 v[44:47], v240, s[24:27], s58 offen offset:3072 sc1
    v_mfma_f32_16x16x32_bf16 v[212:215], v[116:119], v[12:15], v[212:215]
    ds_read_b64_tr_b16 v[88:89], v177 offset:40960
    ds_read_b64_tr_b16 v[90:91], v177 offset:41472
    v_mfma_f32_16x16x32_bf16 v[216:219], v[120:123], v[12:15], v[216:219]
    ds_read_b64_tr_b16 v[92:93], v178 offset:57344
    v_mfma_f32_16x16x32_bf16 v[220:223], v[124:127], v[12:15], v[220:223]
    ds_read_b64_tr_b16 v[94:95], v178 offset:57856
    s_waitcnt vmcnt(7)
    v_mfma_f32_16x16x32_bf16 v[208:211], v[128:131], v[16:19], v[208:211]
    s_xor_b32 s58, s44, 12288
    buffer_load_dwordx4 v[48:51], v240, s[24:27], s58 offen offset:0 sc1
    v_mfma_f32_16x16x32_bf16 v[212:215], v[132:135], v[16:19], v[212:215]
    ds_read_b64_tr_b16 v[96:97], v251 offset:9216
    ds_read_b64_tr_b16 v[98:99], v251 offset:9728
    v_mfma_f32_16x16x32_bf16 v[216:219], v[136:139], v[16:19], v[216:219]
    ds_read_b64_tr_b16 v[100:101], v176 offset:25600
    v_mfma_f32_16x16x32_bf16 v[220:223], v[140:143], v[16:19], v[220:223]
    ds_read_b64_tr_b16 v[102:103], v176 offset:26112
    s_waitcnt vmcnt(7) lgkmcnt(15)
    v_mfma_f32_16x16x32_bf16 v[208:211], v[144:147], v[20:23], v[208:211]
    buffer_load_dwordx4 v[52:55], v240, s[24:27], s58 offen offset:1024 sc1
    v_mfma_f32_16x16x32_bf16 v[212:215], v[148:151], v[20:23], v[212:215]
    ds_read_b64_tr_b16 v[104:105], v177 offset:41984
    ds_read_b64_tr_b16 v[106:107], v177 offset:42496
    v_mfma_f32_16x16x32_bf16 v[216:219], v[152:155], v[20:23], v[216:219]
    ds_read_b64_tr_b16 v[108:109], v178 offset:58368
    v_mfma_f32_16x16x32_bf16 v[220:223], v[156:159], v[20:23], v[220:223]
    ds_read_b64_tr_b16 v[110:111], v178 offset:58880
    s_waitcnt vmcnt(7)
    v_mfma_f32_16x16x32_bf16 v[208:211], v[160:163], v[24:27], v[208:211]
    buffer_load_dwordx4 v[56:59], v240, s[24:27], s58 offen offset:2048 sc1
    v_mfma_f32_16x16x32_bf16 v[212:215], v[164:167], v[24:27], v[212:215]
    ds_read_b64_tr_b16 v[112:113], v251 offset:10240
    ds_read_b64_tr_b16 v[114:115], v251 offset:10752
    v_mfma_f32_16x16x32_bf16 v[216:219], v[168:171], v[24:27], v[216:219]
    ds_read_b64_tr_b16 v[116:117], v176 offset:26624
    v_mfma_f32_16x16x32_bf16 v[220:223], v[172:175], v[24:27], v[220:223]
    ds_read_b64_tr_b16 v[118:119], v176 offset:27136
    s_waitcnt vmcnt(7) lgkmcnt(15)
    v_mfma_f32_16x16x32_bf16 v[208:211], v[64:67], v[28:31], v[208:211]
    buffer_load_dwordx4 v[60:63], v240, s[24:27], s58 offen offset:3072 sc1
    v_mfma_f32_16x16x32_bf16 v[212:215], v[68:71], v[28:31], v[212:215]
    ds_read_b64_tr_b16 v[120:121], v177 offset:43008
    ds_read_b64_tr_b16 v[122:123], v177 offset:43520
    v_mfma_f32_16x16x32_bf16 v[216:219], v[72:75], v[28:31], v[216:219]
    ds_read_b64_tr_b16 v[124:125], v178 offset:59392
    v_mfma_f32_16x16x32_bf16 v[220:223], v[76:79], v[28:31], v[220:223]
    ds_read_b64_tr_b16 v[126:127], v178 offset:59904
    s_waitcnt vmcnt(7) lgkmcnt(15)
    v_mfma_f32_16x16x32_bf16 v[208:211], v[80:83], v[32:35], v[208:211]
    ds_read_b64_tr_b16 v[128:129], v251 offset:11264
    ds_read_b64_tr_b16 v[130:131], v251 offset:11776
    v_mfma_f32_16x16x32_bf16 v[212:215], v[84:87], v[32:35], v[212:215]
    ds_read_b64_tr_b16 v[132:133], v176 offset:27648
    ds_read_b64_tr_b16 v[134:135], v176 offset:28160
    v_mfma_f32_16x16x32_bf16 v[216:219], v[88:91], v[32:35], v[216:219]
    ds_read_b64_tr_b16 v[136:137], v177 offset:44032
    ds_read_b64_tr_b16 v[138:139], v177 offset:44544
    v_mfma_f32_16x16x32_bf16 v[220:223], v[92:95], v[32:35], v[220:223]
    ds_read_b64_tr_b16 v[140:141], v178 offset:60416
    s_waitcnt vmcnt(6) lgkmcnt(15)
    v_mfma_f32_16x16x32_bf16 v[208:211], v[96:99], v[36:39], v[208:211]
    ds_read_b64_tr_b16 v[142:143], v178 offset:60928
    ds_read_b64_tr_b16 v[144:145], v251 offset:12288
    v_mfma_f32_16x16x32_bf16 v[212:215], v[100:103], v[36:39], v[212:215]
    ds_read_b64_tr_b16 v[146:147], v251 offset:12800
    ds_read_b64_tr_b16 v[148:149], v176 offset:28672
    v_mfma_f32_16x16x32_bf16 v[216:219], v[104:107], v[36:39], v[216:219]
    ds_read_b64_tr_b16 v[150:151], v176 offset:29184
    ds_read_b64_tr_b16 v[152:153], v177 offset:45056
    v_mfma_f32_16x16x32_bf16 v[220:223], v[108:111], v[36:39], v[220:223]
    ds_read_b64_tr_b16 v[154:155], v177 offset:45568
    s_waitcnt vmcnt(5) lgkmcnt(14)
    v_mfma_f32_16x16x32_bf16 v[208:211], v[112:115], v[40:43], v[208:211]
    ds_read_b64_tr_b16 v[156:157], v178 offset:61440
    ds_read_b64_tr_b16 v[158:159], v178 offset:61952
    v_mfma_f32_16x16x32_bf16 v[212:215], v[116:119], v[40:43], v[212:215]
    ds_read_b64_tr_b16 v[160:161], v251 offset:13312
    ds_read_b64_tr_b16 v[162:163], v251 offset:13824
    v_mfma_f32_16x16x32_bf16 v[216:219], v[120:123], v[40:43], v[216:219]
    ds_read_b64_tr_b16 v[164:165], v176 offset:29696
    ds_read_b64_tr_b16 v[166:167], v176 offset:30208
    v_mfma_f32_16x16x32_bf16 v[220:223], v[124:127], v[40:43], v[220:223]
    ds_read_b64_tr_b16 v[168:169], v177 offset:46080
    s_waitcnt vmcnt(4) lgkmcnt(13)
    v_mfma_f32_16x16x32_bf16 v[208:211], v[128:131], v[44:47], v[208:211]
    ds_read_b64_tr_b16 v[170:171], v177 offset:46592
    ds_read_b64_tr_b16 v[172:173], v178 offset:62464
    v_mfma_f32_16x16x32_bf16 v[212:215], v[132:135], v[44:47], v[212:215]
    ds_read_b64_tr_b16 v[174:175], v178 offset:62976
    ds_read_b64_tr_b16 v[64:65], v251 offset:14336
L_pad8:
    s_cbranch_execz L_back_38
    v_mfma_f32_16x16x32_bf16 v[216:219], v[136:139], v[44:47], v[216:219]
    ds_read_b64_tr_b16 v[66:67], v251 offset:14848
    ds_read_b64_tr_b16 v[68:69], v176 offset:30720
    v_mfma_f32_16x16x32_bf16 v[220:223], v[140:143], v[44:47], v[220:223]
    ds_read_b64_tr_b16 v[70:71], v176 offset:31232
    s_waitcnt vmcnt(3) lgkmcnt(12)
    v_mfma_f32_16x16x32_bf16 v[208:211], v[144:147], v[48:51], v[208:211]
    ds_read_b64_tr_b16 v[72:73], v177 offset:47104
    ds_read_b64_tr_b16 v[74:75], v177 offset:47616
    v_mfma_f32_16x16x32_bf16 v[212:215], v[148:151], v[48:51], v[212:215]
    ds_read_b64_tr_b16 v[76:77], v178 offset:63488
    ds_read_b64_tr_b16 v[78:79], v178 offset:64000
    v_mfma_f32_16x16x32_bf16 v[216:219], v[152:155], v[48:51], v[216:219]
    ds_read_b64_tr_b16 v[80:81], v251 offset:15360
    ds_read_b64_tr_b16 v[82:83], v251 offset:15872
    v_mfma_f32_16x16x32_bf16 v[220:223], v[156:159], v[48:51], v[220:223]
    ds_read_b64_tr_b16 v[84:85], v176 offset:31744
    s_waitcnt vmcnt(2) lgkmcnt(11)
    v_mfma_f32_16x16x32_bf16 v[208:211], v[160:163], v[52:55], v[208:211]
    ds_read_b64_tr_b16 v[86:87], v176 offset:32256
    ds_read_b64_tr_b16 v[88:89], v177 offset:48128
    v_mfma_f32_16x16x32_bf16 v[212:215], v[164:167], v[52:55], v[212:215]
    ds_read_b64_tr_b16 v[90:91], v177 offset:48640
    ds_read_b64_tr_b16 v[92:93], v178 offset:64512
    v_mfma_f32_16x16x32_bf16 v[216:219], v[168:171], v[52:55], v[216:219]
    ds_read_b64_tr_b16 v[94:95], v178 offset:65024
    v_mfma_f32_16x16x32_bf16 v[220:223], v[172:175], v[52:55], v[220:223]
    s_waitcnt vmcnt(1) lgkmcnt(8)
    v_mfma_f32_16x16x32_bf16 v[208:211], v[64:67], v[56:59], v[208:211]
    v_mfma_f32_16x16x32_bf16 v[212:215], v[68:71], v[56:59], v[212:215]
    v_mfma_f32_16x16x32_bf16 v[216:219], v[72:75], v[56:59], v[216:219]
    v_mfma_f32_16x16x32_bf16 v[220:223], v[76:79], v[56:59], v[220:223]
    s_waitcnt vmcnt(0) lgkmcnt(0)
    v_mfma_f32_16x16x32_bf16 v[208:211], v[80:83], v[60:63], v[208:211]
    v_mfma_f32_16x16x32_bf16 v[212:215], v[84:87], v[60:63], v[212:215]
    v_mfma_f32_16x16x32_bf16 v[216:219], v[88:91], v[60:63], v[216:219]
    v_mfma_f32_16x16x32_bf16 v[220:223], v[92:95], v[60:63], v[220:223]
    s_add_u32 s56, s67, 8192
    s_nop 3
    v_cvt_pk_bf16_f32 v128, v208, v209
    v_cvt_pk_bf16_f32 v129, v210, v211
    v_cvt_pk_bf16_f32 v130, v212, v213
    v_cvt_pk_bf16_f32 v131, v214, v215
    ds_write2_b64 v224, v[128:129], v[130:131] offset0:0 offset1:4
    v_cvt_pk_bf16_f32 v132, v216, v217
    v_cvt_pk_bf16_f32 v133, v218, v219
    v_cvt_pk_bf16_f32 v134, v220, v221
    v_cvt_pk_bf16_f32 v135, v222, v223
    ds_write2_b64 v224, v[132:133], v[134:135] offset0:8 offset1:12
    ds_read_b128 v[136:139], v225 offset:0
    ds_read_b128 v[140:143], v225 offset:1152
    s_waitcnt lgkmcnt(1)
    buffer_store_dwordx4 v[136:139], v226, s[28:31], s67 offen
    s_waitcnt lgkmcnt(0)
    buffer_store_dwordx4 v[140:143], v226, s[28:31], s56 offen
    s_cmp_eq_u32 s75, 0
    s_cbranch_scc0 L_skip_58
    s_add_u32 s53, s53, 1
    v_mov_b32 v0, s53
    s_mov_b64 exec, 1
    buffer_store_dword v0, off, s[24:27], 0 sc1
    s_mov_b64 exec, -1
L_skip_58:
L_timeout:
L_end:
    s_endpgm
L_again0:
L_pad9:
    s_cbranch_execz L_back_18
    s_sub_u32 s59, s59, 1
    s_cbranch_scc1 L_timeout
    s_add_u32 s56, s49, 524288
    buffer_load_dwordx4 v[32:35], v240, s[24:27], s56 offen sc1
    s_add_u32 s56, s49, 0
    buffer_load_dwordx4 v[0:3], v240, s[24:27], s56 offen sc1
    s_add_u32 s56, s49, 65536
    buffer_load_dwordx4 v[4:7], v240, s[24:27], s56 offen sc1
    s_add_u32 s56, s49, 131072
    buffer_load_dwordx4 v[8:11], v240, s[24:27], s56 offen sc1
    s_add_u32 s56, s49, 196608
    buffer_load_dwordx4 v[12:15], v240, s[24:27], s56 offen sc1
    s_add_u32 s56, s49, 262144
    buffer_load_dwordx4 v[16:19], v240, s[24:27], s56 offen sc1
    s_add_u32 s56, s49, 327680
    buffer_load_dwordx4 v[20:23], v240, s[24:27], s56 offen sc1
    s_add_u32 s56, s49, 393216
    buffer_load_dwordx4 v[24:27], v240, s[24:27], s56 offen sc1
    s_add_u32 s56, s49, 458752
    buffer_load_dwordx4 v[28:31], v240, s[24:27], s56 offen sc1
    s_waitcnt vmcnt(0)
    s_branch L_chk0
L_again1:
    s_sub_u32 s59, s59, 1
    s_cbranch_scc1 L_timeout
    s_add_u32 s56, s49, 524288
    buffer_load_dwordx4 v[32:35], v240, s[24:27], s56 offen sc1
    s_add_u32 s56, s49, 0
    buffer_load_dwordx4 v[0:3], v240, s[24:27], s56 offen sc1
    s_add_u32 s56, s49, 65536
    buffer_load_dwordx4 v[4:7], v240, s[24:27], s56 offen sc1
    s_add_u32 s56, s49, 131072
    buffer_load_dwordx4 v[8:11], v240, s[24:27], s56 offen sc1
    s_add_u32 s56, s49, 196608
    buffer_load_dwordx4 v[12:15], v240, s[24:27], s56 offen sc1
    s_add_u32 s56, s49, 262144
    buffer_load_dwordx4 v[16:19], v240, s[24:27], s56 offen sc1
    s_add_u32 s56, s49, 327680
    buffer_load_dwordx4 v[20:23], v240, s[24:27], s56 offen sc1
    s_add_u32 s56, s49, 393216
    buffer_load_dwordx4 v[24:27], v240, s[24:27], s56 offen sc1
    s_add_u32 s56, s49, 458752
    buffer_load_dwordx4 v[28:31], v240, s[24:27], s56 offen sc1
    s_branch L_chk1
L_again2:
    s_sub_u32 s59, s59, 1
    s_cbranch_scc1 L_timeout
    s_add_u32 s56, s49, 524288
    buffer_load_dwordx4 v[32:35], v240, s[24:27], s56 offen sc1
    s_add_u32 s56, s49, 0
    buffer_load_dwordx4 v[0:3], v240, s[24:27], s56 offen sc1
    s_add_u32 s56, s49, 65536
    buffer_load_dwordx4 v[4:7], v240, s[24:27], s56 offen sc1
    s_add_u32 s56, s49, 131072
    buffer_load_dwordx4 v[8:11], v240, s[24:27], s56 offen sc1
    s_add_u32 s56, s49, 196608
    buffer_load_dwordx4 v[12:15], v240, s[24:27], s56 offen sc1
    s_add_u32 s56, s49, 262144
    buffer_load_dwordx4 v[16:19], v240, s[24:27], s56 offen sc1
    s_add_u32 s56, s49, 327680
    buffer_load_dwordx4 v[20:23], v240, s[24:27], s56 offen sc1
    s_add_u32 s56, s49, 393216
    buffer_load_dwordx4 v[24:27], v240, s[24:27], s56 offen sc1
    s_add_u32 s56, s49, 458752
    buffer_load_dwordx4 v[28:31], v240, s[24:27], s56 offen sc1
    s_branch L_chk2
L_again3:
    s_sub_u32 s59, s59, 1
    s_cbranch_scc1 L_timeout
    s_add_u32 s56, s49, 524288
    buffer_load_dwordx4 v[32:35], v240, s[24:27], s56 offen sc1
    s_add_u32 s56, s49, 0
    buffer_load_dwordx4 v[0:3], v240, s[24:27], s56 offen sc1
    s_add_u32 s56, s49, 65536
    buffer_load_dwordx4 v[4:7], v240, s[24:27], s56 offen sc1
    s_add_u32 s56, s49, 131072
    buffer_load_dwordx4 v[8:11], v240, s[24:27], s56 offen sc1
    s_add_u32 s56, s49, 196608
    buffer_load_dwordx4 v[12:15], v240, s[24:27], s56 offen sc1
    s_add_u32 s56, s49, 262144
    buffer_load_dwordx4 v[16:19], v240, s[24:27], s56 offen sc1
    s_add_u32 s56, s49, 327680
    buffer_load_dwordx4 v[20:23], v240, s[24:27], s56 offen sc1
    s_add_u32 s56, s49, 393216
    buffer_load_dwordx4 v[24:27], v240, s[24:27], s56 offen sc1
    s_add_u32 s56, s49, 458752
    buffer_load_dwordx4 v[28:31], v240, s[24:27], s56 offen sc1
    s_branch L_chk3
L_glob_4:
    s_waitcnt vmcnt(0)
    buffer_store_dword v16, off, s[24:27], s3 sc1
    s_branch L_join_5
L_poll0:
    buffer_load_dword v34, v38, s[24:27], s57 offen sc1
    s_sub_u32 s59, s59, 1
    s_cbranch_scc1 L_timeout
    s_waitcnt vmcnt(0)
    v_cmp_ne_u32 vcc, s54, v34
    s_nop 0
    s_cbranch_vccz L_enter
    s_and_b32 s56, s59, 15
    s_cbranch_scc1 L_poll0
    v_mov_b32 v35, s54
    s_lshl2_add_u32 s55, s37, s77
    s_mov_b64 exec, 1
    buffer_store_dword v35, off, s[24:27], s55 sc1
    s_mov_b64 exec, -1
    buffer_load_dword v34, v250, s[24:27], s77 offen sc1
    s_waitcnt vmcnt(0)
    v_xor_b32 v34, s54, v34
    v_add_u32 v34, -1, v34
    v_cmp_gt_u32 vcc, 15, v34
    s_nop 0
    s_cbranch_vccz L_poll0
L_global:
    s_mov_b32 s51, 1
    s_add_u32 s48, s48, 24576
    s_add_u32 s41, s41, 24576
    s_mov_b32 s1, s50
    s_add_u32 s3, s3, 24576
    v_mov_b32 v16, s1
    s_mov_b64 exec, 1
    s_cmp_eq_u32 s51, 0
    s_cbranch_scc0 L_glob_4
    s_waitcnt vmcnt(0)
    buffer_store_dword v16, off, s[24:27], s3
L_join_5:
    s_mov_b64 exec, -1
L_poll_6:
    buffer_load_dword v34, v250, s[24:27], s41 offen sc1
    s_sub_u32 s59, s59, 1
    s_cbranch_scc1 L_timeout
    s_waitcnt vmcnt(0)
    v_cmp_ne_u32 vcc, s1, v34
    s_nop 0
    s_cbranch_vccnz L_poll_6
    s_branch L_enter
L_hello:
L_poll_12:
    buffer_load_dword v153, v182, s[24:27], s63 offen sc1
    s_sub_u32 s59, s59, 1
    s_cbranch_scc1 L_timeout
    s_waitcnt vmcnt(0)
    v_cmp_ne_u32 vcc, s1, v153
    s_nop 0
    s_cbranch_vccnz L_poll_12
    s_branch L_hello_ok
L_glob_19:
    s_waitcnt vmcnt(0)
    buffer_store_dword v179, off, s[24:27], s43 sc1
    s_branch L_join_20
L_glob_21:
    v_cvt_pk_bf16_f32 v128, v208, v209
    v_cvt_pk_bf16_f32 v129, v210, v211
    v_cvt_pk_bf16_f32 v130, v212, v213
    v_cvt_pk_bf16_f32 v131, v214, v215
    buffer_store_dwordx4 v[128:131], v247, s[28:31], s46 offen offset:0 sc1
    v_cvt_pk_bf16_f32 v132, v216, v217
    v_cvt_pk_bf16_f32 v133, v218, v219
    v_cvt_pk_bf16_f32 v134, v220, v221
    v_cvt_pk_bf16_f32 v135, v222, v223
    buffer_store_dwordx4 v[132:135], v247, s[28:31], s46 offen offset:512 sc1
    s_branch L_join_22
L_glob_23:
    v_permlane16_swap_b32 v136, v137
    s_mov_b64 exec, s[96:97]
    v_add_f32 v136, v136, v137
    v_or_b32 v136, 1, v136
    buffer_store_dword v136, v248, s[24:27], s47 offen sc1
    s_branch L_join_24
L_glob_25:
    s_waitcnt vmcnt(0)
    buffer_store_dword v179, off, s[24:27], s48 sc1
    s_branch L_join_26
L_glob_27:
    v_pk_mul_f32 v[144:145], v[144:145], v[166:167] op_sel_hi:[1,0]
    v_pk_mul_f32 v[146:147], v[146:147], v[166:167] op_sel_hi:[1,0]
    v_pk_mul_f32 v[148:149], v[148:149], v[166:167] op_sel_hi:[1,0]
    v_pk_mul_f32 v[150:151], v[150:151], v[166:167] op_sel_hi:[1,0]
    v_cvt_pk_bf16_f32 v192, v144, v145
    v_cvt_pk_bf16_f32 v193, v146, v147
    v_cvt_pk_bf16_f32 v194, v148, v149
    v_cvt_pk_bf16_f32 v195, v150, v151
    buffer_store_dwordx4 v[192:195], v191, s[24:27], s42 offen offset:0 sc1
    v_pk_mul_f32 v[152:153], v[152:153], v[166:167] op_sel_hi:[1,0]
    v_pk_mul_f32 v[154:155], v[154:155], v[166:167] op_sel_hi:[1,0]
    v_pk_mul_f32 v[156:157], v[156:157], v[166:167] op_sel_hi:[1,0]
    v_pk_mul_f32 v[158:159], v[158:159], v[166:167] op_sel_hi:[1,0]
    v_cvt_pk_bf16_f32 v196, v152, v153
    v_cvt_pk_bf16_f32 v197, v154, v155
    v_cvt_pk_bf16_f32 v198, v156, v157
    v_cvt_pk_bf16_f32 v199, v158, v159
    buffer_store_dwordx4 v[196:199], v191, s[24:27], s42 offen offset:256 sc1
    s_branch L_join_28
L_glob_29:
    s_waitcnt vmcnt(0)
    buffer_store_dword v179, off, s[24:27], s43 sc1
    s_branch L_join_30
L_glob_31:
    s_nop 1
    s_nop 0
    v_cvt_pk_bf16_f32 v128, v208, v209
    v_cvt_pk_bf16_f32 v129, v210, v211
    v_cvt_pk_bf16_f32 v130, v212, v213
    v_cvt_pk_bf16_f32 v131, v214, v215
    buffer_store_dwordx4 v[128:131], v247, s[28:31], s46 offen offset:0 sc1
    v_cvt_pk_bf16_f32 v132, v216, v217
    v_cvt_pk_bf16_f32 v133, v218, v219
    v_cvt_pk_bf16_f32 v134, v220, v221
    v_cvt_pk_bf16_f32 v135, v222, v223
    buffer_store_dwordx4 v[132:135], v247, s[28:31], s46 offen offset:512 sc1
    s_branch L_join_32
L_glob_33:
    v_permlane16_swap_b32 v136, v137
    s_mov_b64 exec, s[96:97]
    v_add_f32 v136, v136, v137
    v_and_b32 v136, -2, v136
    buffer_store_dword v136, v248, s[24:27], s47 offen sc1
    s_branch L_join_34
L_glob_35:
    s_waitcnt vmcnt(1)
    buffer_store_dword v179, off, s[24:27], s48 sc1
    s_branch L_join_36
L_sumsre2:
    s_sub_u32 s59, s59, 1
    s_cbranch_scc1 L_timeout
    buffer_load_dwordx4 v[192:195], v249, s[24:27], s40 offen offset:0 sc1
    buffer_load_dwordx4 v[196:199], v249, s[24:27], s40 offen offset:512 sc1
    s_waitcnt vmcnt(0)
    s_branch L_sums2
L_glob_44:
    v_pk_mul_f32 v[144:145], v[144:145], v[166:167] op_sel_hi:[1,0]
    v_pk_mul_f32 v[146:147], v[146:147], v[166:167] op_sel_hi:[1,0]
    v_pk_mul_f32 v[148:149], v[148:149], v[166:167] op_sel_hi:[1,0]
    v_pk_mul_f32 v[150:151], v[150:151], v[166:167] op_sel_hi:[1,0]
    v_cvt_pk_bf16_f32 v192, v144, v145
    v_cvt_pk_bf16_f32 v193, v146, v147
    v_cvt_pk_bf16_f32 v194, v148, v149
    v_cvt_pk_bf16_f32 v195, v150, v151
    buffer_store_dwordx4 v[192:195], v191, s[24:27], s42 offen offset:0 sc1
    v_pk_mul_f32 v[152:153], v[152:153], v[166:167] op_sel_hi:[1,0]
    v_pk_mul_f32 v[154:155], v[154:155], v[166:167] op_sel_hi:[1,0]
    v_pk_mul_f32 v[156:157], v[156:157], v[166:167] op_sel_hi:[1,0]
    v_pk_mul_f32 v[158:159], v[158:159], v[166:167] op_sel_hi:[1,0]
    v_cvt_pk_bf16_f32 v196, v152, v153
    v_cvt_pk_bf16_f32 v197, v154, v155
    v_cvt_pk_bf16_f32 v198, v156, v157
    v_cvt_pk_bf16_f32 v199, v158, v159
    buffer_store_dwordx4 v[196:199], v191, s[24:27], s42 offen offset:256 sc1
    s_branch L_join_45
L_glob_46:
    s_waitcnt vmcnt(0)
    buffer_store_dword v179, off, s[24:27], s43 sc1
    s_branch L_join_47
L_glob_48:
    s_nop 2
    v_cvt_pk_bf16_f32 v128, v208, v209
    v_cvt_pk_bf16_f32 v129, v210, v211
    v_cvt_pk_bf16_f32 v130, v212, v213
    v_cvt_pk_bf16_f32 v131, v214, v215
    buffer_store_dwordx4 v[128:131], v247, s[28:31], s46 offen offset:0 sc1
    v_cvt_pk_bf16_f32 v132, v216, v217
    v_cvt_pk_bf16_f32 v133, v218, v219
    v_cvt_pk_bf16_f32 v134, v220, v221
    v_cvt_pk_bf16_f32 v135, v222, v223
    buffer_store_dwordx4 v[132:135], v247, s[28:31], s46 offen offset:512 sc1
    s_branch L_join_49
L_glob_50:
    v_permlane16_swap_b32 v136, v137
    s_mov_b64 exec, s[96:97]
    v_add_f32 v136, v136, v137
    v_or_b32 v136, 1, v136
    buffer_store_dword v136, v248, s[24:27], s47 offen sc1
    s_branch L_join_51
L_glob_52:
    s_waitcnt vmcnt(1)
    buffer_store_dword v179, off, s[24:27], s48 sc1
    s_branch L_join_53
L_sumsre3:
    s_sub_u32 s59, s59, 1
    s_cbranch_scc1 L_timeout
    buffer_load_dwordx4 v[192:195], v249, s[24:27], s40 offen offset:0 sc1
    buffer_load_dwordx4 v[196:199], v249, s[24:27], s40 offen offset:512 sc1
    s_waitcnt vmcnt(0)
    s_branch L_sums3
L_glob_54:
    v_pk_mul_f32 v[144:145], v[144:145], v[166:167] op_sel_hi:[1,0]
    v_pk_mul_f32 v[146:147], v[146:147], v[166:167] op_sel_hi:[1,0]
    v_pk_mul_f32 v[148:149], v[148:149], v[166:167] op_sel_hi:[1,0]
    v_pk_mul_f32 v[150:151], v[150:151], v[166:167] op_sel_hi:[1,0]
    v_cvt_pk_bf16_f32 v192, v144, v145
    v_cvt_pk_bf16_f32 v193, v146, v147
    v_cvt_pk_bf16_f32 v194, v148, v149
    v_cvt_pk_bf16_f32 v195, v150, v151
    buffer_store_dwordx4 v[192:195], v191, s[24:27], s42 offen offset:0 sc1
    v_pk_mul_f32 v[152:153], v[152:153], v[166:167] op_sel_hi:[1,0]
    v_pk_mul_f32 v[154:155], v[154:155], v[166:167] op_sel_hi:[1,0]
    v_pk_mul_f32 v[156:157], v[156:157], v[166:167] op_sel_hi:[1,0]
    v_pk_mul_f32 v[158:159], v[158:159], v[166:167] op_sel_hi:[1,0]
    v_cvt_pk_bf16_f32 v196, v152, v153
    v_cvt_pk_bf16_f32 v197, v154, v155
    v_cvt_pk_bf16_f32 v198, v156, v157
    v_cvt_pk_bf16_f32 v199, v158, v159
    buffer_store_dwordx4 v[196:199], v191, s[24:27], s42 offen offset:256 sc1
    s_branch L_join_55
L_glob_56:
    s_waitcnt vmcnt(0)
    buffer_store_dword v179, off, s[24:27], s43 sc1
    s_branch L_join_57
L_codeend:
    s_endpgm
.section .rodata,"a"
.p2align 6
.amdhsa_kernel interleave_layers__linear_attn_block__linear_kernel_hedgehog__prompt_kernel
  .amdhsa_next_free_vgpr 512
  .amdhsa_next_free_sgpr 102
  .amdhsa_accum_offset 256
  .amdhsa_group_segment_fixed_size 0
  .amdhsa_kernarg_size 80
  .amdhsa_user_sgpr_count 2
  .amdhsa_user_sgpr_kernarg_segment_ptr 1
  .amdhsa_system_sgpr_workgroup_id_x 1
.end_amdhsa_kernel
```
